```python
import torch

def _softmax(x, axis=-1):
    return torch.softmax(x, dim=axis)
def _gelu(x):
    return torch.nn.functional.gelu(x, approximate="tanh")
def _silu(x):
    return torch.nn.functional.silu(x)
def _sigmoid(x):
    return torch.sigmoid(x)
def _layernorm(x, axis=-1, eps=1e-5):
    m = x.mean(dim=axis, keepdim=True)
    v = x.var(dim=axis, keepdim=True, unbiased=False)
    return (x - m) / torch.sqrt(v + eps)
def _scatter_add(tgt, idx, src, axis=0):
    return tgt.clone().index_add_(axis, idx, src)
def _segment_sum(src, seg, n):
    out = torch.zeros((n,) + src.shape[1:], dtype=src.dtype)
    return out.index_add_(0, seg, src)
def _pad(x, pw):
    flat = tuple(v for pair in reversed(pw) for v in pair)
    return torch.nn.functional.pad(x, flat)

kernel_name = 'gated_mix__mha_block__glu_gated_bilinear__prompt'

def setup_inputs():

    _w = (lambda a: (lambda t: t.to(torch.bfloat16) if t.is_floating_point() else t)(torch.as_tensor(a)))
    def _A_setup():
        B, S, D, H = 1, 2048, 576, 32
        return {
            "x": _w((lambda *s: torch.randn(*s, dtype=torch.bfloat16) * 0.05)(B, S, D)),
            "wqkv": _w((lambda *s: torch.randn(*s, dtype=torch.bfloat16) * 0.8)(D, 3 * D)),
            "wo": _w((lambda *s: torch.randn(*s, dtype=torch.bfloat16) * 0.05)(D, D)),
        }
    _A_in = _A_setup()

    def _B_setup():
        B, S, D, F = 1, 2048, 576, 4608
        return {
            "x": _w((lambda *s: torch.randn(*s, dtype=torch.bfloat16) * 0.05)(B, S, D)),
            "w_gate": _w((lambda *s: torch.randn(*s, dtype=torch.bfloat16) * 3.2)(D, F) * (D ** -0.5)),
            "w_up": _w((lambda *s: torch.randn(*s, dtype=torch.bfloat16) * 3.2)(D, F) * (D ** -0.5)),
            "w_down": _w((lambda *s: torch.randn(*s, dtype=torch.bfloat16) * 3.2)(F, D) * (F ** -0.5)),
        }
    _B_in = _B_setup()

    return {
        "A_x": _A_in["x"],
        "A_wqkv": _A_in["wqkv"],
        "A_wo": _A_in["wo"],
        "B_x": _B_in["x"],
        "B_w_gate": _B_in["w_gate"],
        "B_w_up": _B_in["w_up"],
        "B_w_down": _B_in["w_down"],
        "gate_w": _w((lambda *s: torch.randn(*s, dtype=torch.bfloat16) * 0.05)(576) * 16.0),
    }

def reference(A_x, A_wqkv, A_wo, B_x, B_w_gate, B_w_up, B_w_down, gate_w):
    def _A_ref(x, wqkv, wo):
        B, S, D = x.shape
        H = 32
        Dh = D // H
        qkv = (lambda x, *d: x.permute(*d))((x @ wqkv).reshape(B, S, 3, H, Dh), 2, 0, 3, 1, 4)
        q, k, v = qkv[0], qkv[1], qkv[2]
        scores = torch.einsum("bhqd,bhkd->bhqk", q, k) * (Dh ** -0.5)
        p = _softmax(scores, axis=-1)
        o = torch.einsum("bhqk,bhkd->bhqd", p, v)
        return (lambda x, *d: x.permute(*d))(o, 0, 2, 1, 3).reshape(B, S, D) @ wo

    def _B_ref(x, w_gate, w_up, w_down):
        g = torch.einsum("bsd,df->bsf", x, w_gate)
        u = torch.einsum("bsd,df->bsf", x, w_up)
        h = g * u
        return torch.einsum("bsf,fd->bsd", h, w_down)

    x = A_x
    g = _sigmoid((x * gate_w).sum(-1, keepdims=True))
    a = _A_ref(x, A_wqkv, A_wo)
    b = _B_ref(x, B_w_gate, B_w_up, B_w_down)
    return g * a + (1 - g) * b
```

```asm
; @launch kernel=gm_k1_kernel grid=(256,1,1) block=(512,1,1) lds=163840
; @launch kernel=gm_k2_kernel grid=(400,1,1) block=(512,1,1) lds=81920
; @launch kernel=gated_mix__mha_block__glu_gated_bilinear__prompt_kernel grid=(384,1,1) block=(256,1,1) lds=49152
.amdgcn_target "amdgcn-amd-amdhsa--gfx950"
.text
.globl gm_k1_kernel
.p2align 8
.type gm_k1_kernel,@function
gm_k1_kernel:
    s_cmp_ge_u32 s2, 256
    s_cbranch_scc1 L_gm_k1_kernel_end
    s_load_dwordx4 s[24:27], s[0:1], 0
    s_load_dwordx4 s[28:31], s[0:1], 32
    s_load_dwordx2 s[52:53], s[0:1], 48
    s_load_dwordx2 s[54:55], s[0:1], 16
    s_load_dwordx2 s[60:61], s[0:1], 80
    v_lshlrev_b32 v1, 4, v0
    s_lshl_b32 s33, s2, 13
    s_waitcnt lgkmcnt(0)
    s_mov_b32 s4, s24
    s_and_b32 s5, s25, 0xffff
    s_mov_b32 s6, 2359296
    s_mov_b32 s7, 0x20000
    s_mov_b32 s8, s28
    s_and_b32 s9, s29, 0xffff
    s_mov_b32 s10, 5308416
    s_mov_b32 s11, 0x20000
    s_mov_b32 s12, s30
    s_and_b32 s13, s31, 0xffff
    s_mov_b32 s14, 5308416
    s_mov_b32 s15, 0x20000
    s_mov_b32 s20, s26
    s_and_b32 s21, s27, 0xffff
    s_mov_b32 s22, 1990656
    s_mov_b32 s23, 0x20000
    s_mov_b32 s16, s60
    s_and_b32 s17, s61, 0xffff
    s_mov_b32 s18, 268435456
    s_mov_b32 s19, 0x20000
    buffer_load_dword v15, v1, s[4:7], s33 offen
    buffer_load_dword v15, v1, s[20:23], s33 offen
    buffer_load_dword v15, v1, s[8:11], s33 offen
    buffer_load_dword v15, v1, s[12:15], s33 offen
    s_add_u32 s34, s33, 2097152
    buffer_load_dword v15, v1, s[4:7], s34 offen
    buffer_load_dword v15, v1, s[8:11], s34 offen
    buffer_load_dword v15, v1, s[12:15], s34 offen
    s_add_u32 s34, s33, 4194304
    buffer_load_dword v15, v1, s[8:11], s34 offen
    buffer_load_dword v15, v1, s[12:15], s34 offen
    v_lshrrev_b32 v1, 6, v0
    v_and_b32 v0, 63, v0
    s_nop 0
    v_readfirstlane_b32 s36, v1
    s_and_b32 s33, s2, 7
    s_lshl_b32 s33, s33, 2
    s_lshr_b32 s34, s2, 3
    s_and_b32 s32, s34, 7
    s_lshr_b32 s34, s34, 3
    s_add_u32 s33, s33, s34
    s_lshl_b32 s37, s32, 8
    s_and_b32 s49, s36, 1
    s_lshr_b32 s50, s36, 1
    s_add_u32 s47, s36, 0
    s_mov_b32 s84, 0
    s_lshl_b32 s94, s47, 10
    s_mov_b32 s64, s4
    s_mov_b32 s65, s5
    s_mov_b32 s66, s6
    s_mov_b32 s67, s7
    s_mov_b32 s89, 64
    v_lshrrev_b32 v8, 2, v0
    s_lshl_b32 s48, s47, 4
    s_add_u32 s48, s48, s37
    v_add_u32 v8, s48, v8
    v_mul_u32_u24 v2, 1152, v8
    v_and_b32 v9, 3, v0
    v_lshrrev_b32 v10, 5, v0
    v_lshlrev_b32 v10, 1, v10
    v_xor_b32 v9, v9, v10
    v_lshl_add_u32 v2, v9, 4, v2
    s_add_u32 s47, s36, 8
    s_mov_b32 s85, 0
    s_lshl_b32 s95, s47, 10
    s_mov_b32 s68, s4
    s_mov_b32 s69, s5
    s_mov_b32 s70, s6
    s_mov_b32 s71, s7
    s_mov_b32 s90, 64
    v_lshrrev_b32 v8, 2, v0
    s_lshl_b32 s48, s47, 4
    s_add_u32 s48, s48, s37
    v_add_u32 v8, s48, v8
    v_mul_u32_u24 v3, 1152, v8
    v_and_b32 v9, 3, v0
    v_lshrrev_b32 v10, 5, v0
    v_lshlrev_b32 v10, 1, v10
    v_xor_b32 v9, v9, v10
    v_lshl_add_u32 v3, v9, 4, v3
    s_add_u32 s47, s36, 16
    s_mov_b32 s86, 0
    s_lshl_b32 s96, s47, 10
    s_cmp_lt_u32 s47, 34
    s_cbranch_scc0 L_gm_k1_kernel_q2
    s_sub_u32 s47, s47, 16
    s_sub_u32 s48, s47, 9
    s_cmp_lt_u32 s47, 9
    s_cselect_b32 s72, s8, s12
    s_cselect_b32 s73, s9, s13
    s_cselect_b32 s74, s10, s14
    s_cselect_b32 s75, s11, s15
    s_cselect_b32 s47, s47, s48
    s_mov_b32 s91, 294912
    s_lshl_b32 s47, s47, 6
    v_add_u32 v8, s47, v0
    v_mul_u32_u24 v9, 0xe39, v8
    v_lshrrev_b32 v9, 16, v9
    v_mul_u32_u24 v10, 18, v9
    v_sub_u32 v10, v8, v10
    v_bfe_u32 v11, v9, 3, 1
    v_lshlrev_b32 v11, 3, v11
    v_xor_b32 v11, v10, v11
    v_cmp_gt_u32 vcc, 16, v10
    s_nop 1
    v_cndmask_b32 v10, v10, v11, vcc
    v_mul_u32_u24 v9, 9216, v9
    v_lshl_add_u32 v9, v10, 4, v9
    s_mul_i32 s48, s33, 288
    v_add_u32 v4, s48, v9
    s_branch L_gm_k1_kernel_d2
L_gm_k1_kernel_q2:
    s_sub_u32 s47, s47, 34
    s_mov_b32 s72, s20
    s_mov_b32 s73, s21
    s_mov_b32 s74, s22
    s_mov_b32 s75, s23
    s_mov_b32 s91, 110592
    s_lshl_b32 s47, s47, 6
    v_add_u32 v8, s47, v0
    v_mul_u32_u24 v9, 0xaab, v8
    v_lshrrev_b32 v9, 15, v9
    v_mul_u32_u24 v10, 12, v9
    v_sub_u32 v10, v8, v10
    v_bfe_u32 v11, v9, 3, 1
    v_lshlrev_b32 v11, 1, v11
    v_xor_b32 v10, v10, v11
    v_mul_u32_u24 v9, 3456, v9
    v_lshrrev_b32 v11, 2, v10
    v_mul_u32_u24 v11, 1152, v11
    v_and_b32 v10, 3, v10
    v_add_u32 v9, v9, v11
    v_lshl_add_u32 v9, v10, 4, v9
    s_mul_i32 s48, s33, 36
    v_add_u32 v4, s48, v9
L_gm_k1_kernel_d2:
    s_add_u32 s47, s36, 24
    s_mov_b32 s87, 0
    s_lshl_b32 s97, s47, 10
    s_cmp_lt_u32 s47, 34
    s_cbranch_scc0 L_gm_k1_kernel_q3
    s_sub_u32 s47, s47, 16
    s_sub_u32 s48, s47, 9
    s_cmp_lt_u32 s47, 9
    s_cselect_b32 s76, s8, s12
    s_cselect_b32 s77, s9, s13
    s_cselect_b32 s78, s10, s14
    s_cselect_b32 s79, s11, s15
    s_cselect_b32 s47, s47, s48
    s_mov_b32 s92, 294912
    s_lshl_b32 s47, s47, 6
    v_add_u32 v8, s47, v0
    v_mul_u32_u24 v9, 0xe39, v8
    v_lshrrev_b32 v9, 16, v9
    v_mul_u32_u24 v10, 18, v9
    v_sub_u32 v10, v8, v10
    v_bfe_u32 v11, v9, 3, 1
    v_lshlrev_b32 v11, 3, v11
    v_xor_b32 v11, v10, v11
    v_cmp_gt_u32 vcc, 16, v10
    s_nop 1
    v_cndmask_b32 v10, v10, v11, vcc
    v_mul_u32_u24 v9, 9216, v9
    v_lshl_add_u32 v9, v10, 4, v9
    s_mul_i32 s48, s33, 288
    v_add_u32 v5, s48, v9
    s_branch L_gm_k1_kernel_d3
L_gm_k1_kernel_q3:
    s_sub_u32 s47, s47, 34
    s_mov_b32 s76, s20
    s_mov_b32 s77, s21
    s_mov_b32 s78, s22
    s_mov_b32 s79, s23
    s_mov_b32 s92, 110592
    s_lshl_b32 s47, s47, 6
    v_add_u32 v8, s47, v0
    v_mul_u32_u24 v9, 0xaab, v8
    v_lshrrev_b32 v9, 15, v9
    v_mul_u32_u24 v10, 12, v9
    v_sub_u32 v10, v8, v10
    v_bfe_u32 v11, v9, 3, 1
    v_lshlrev_b32 v11, 1, v11
    v_xor_b32 v10, v10, v11
    v_mul_u32_u24 v9, 3456, v9
    v_lshrrev_b32 v11, 2, v10
    v_mul_u32_u24 v11, 1152, v11
    v_and_b32 v10, 3, v10
    v_add_u32 v9, v9, v11
    v_lshl_add_u32 v9, v10, 4, v9
    s_mul_i32 s48, s33, 36
    v_add_u32 v5, s48, v9
L_gm_k1_kernel_d3:
    s_add_u32 s47, s36, 32
    s_mov_b32 s88, 0
    s_lshl_b32 s98, s47, 10
    s_cmp_lt_u32 s47, 34
    s_cbranch_scc0 L_gm_k1_kernel_q4
    s_sub_u32 s47, s47, 16
    s_sub_u32 s48, s47, 9
    s_cmp_lt_u32 s47, 9
    s_cselect_b32 s80, s8, s12
    s_cselect_b32 s81, s9, s13
    s_cselect_b32 s82, s10, s14
    s_cselect_b32 s83, s11, s15
    s_cselect_b32 s47, s47, s48
    s_mov_b32 s93, 294912
    s_lshl_b32 s47, s47, 6
    v_add_u32 v8, s47, v0
    v_mul_u32_u24 v9, 0xe39, v8
    v_lshrrev_b32 v9, 16, v9
    v_mul_u32_u24 v10, 18, v9
    v_sub_u32 v10, v8, v10
    v_bfe_u32 v11, v9, 3, 1
    v_lshlrev_b32 v11, 3, v11
    v_xor_b32 v11, v10, v11
    v_cmp_gt_u32 vcc, 16, v10
    s_nop 1
    v_cndmask_b32 v10, v10, v11, vcc
    v_mul_u32_u24 v9, 9216, v9
    v_lshl_add_u32 v9, v10, 4, v9
    s_mul_i32 s48, s33, 288
    v_add_u32 v6, s48, v9
    s_branch L_gm_k1_kernel_d4
L_gm_k1_kernel_q4:
    s_sub_u32 s47, s47, 34
    s_mov_b32 s80, s20
    s_mov_b32 s81, s21
    s_mov_b32 s82, s22
    s_mov_b32 s83, s23
    s_mov_b32 s93, 110592
    s_lshl_b32 s47, s47, 6
    v_add_u32 v8, s47, v0
    v_mul_u32_u24 v9, 0xaab, v8
    v_lshrrev_b32 v9, 15, v9
    v_mul_u32_u24 v10, 12, v9
    v_sub_u32 v10, v8, v10
    v_bfe_u32 v11, v9, 3, 1
    v_lshlrev_b32 v11, 1, v11
    v_xor_b32 v10, v10, v11
    v_mul_u32_u24 v9, 3456, v9
    v_lshrrev_b32 v11, 2, v10
    v_mul_u32_u24 v11, 1152, v11
    v_and_b32 v10, 3, v10
    v_add_u32 v9, v9, v11
    v_lshl_add_u32 v9, v10, 4, v9
    s_mul_i32 s48, s33, 36
    v_add_u32 v6, s48, v9
L_gm_k1_kernel_d4:
    s_add_u32 m0, s94, 0
    s_nop 0
    buffer_load_dwordx4 v2, s[64:67], s84 offen lds
    s_add_u32 s84, s84, s89
    s_add_u32 m0, s95, 0
    s_nop 0
    buffer_load_dwordx4 v3, s[68:71], s85 offen lds
    s_add_u32 s85, s85, s90
    s_add_u32 m0, s96, 0
    s_nop 0
    buffer_load_dwordx4 v4, s[72:75], s86 offen lds
    s_add_u32 s86, s86, s91
    s_add_u32 m0, s97, 0
    s_nop 0
    buffer_load_dwordx4 v5, s[76:79], s87 offen lds
    s_add_u32 s87, s87, s92
    s_add_u32 m0, s98, 0
    s_nop 0
    buffer_load_dwordx4 v6, s[80:83], s88 offen lds
    s_add_u32 s88, s88, s93
    s_add_u32 m0, s94, 40960
    s_nop 0
    buffer_load_dwordx4 v2, s[64:67], s84 offen lds
    s_add_u32 s84, s84, s89
    s_add_u32 m0, s95, 40960
    s_nop 0
    buffer_load_dwordx4 v3, s[68:71], s85 offen lds
    s_add_u32 s85, s85, s90
    s_add_u32 m0, s96, 40960
    s_nop 0
    buffer_load_dwordx4 v4, s[72:75], s86 offen lds
    s_add_u32 s86, s86, s91
    s_add_u32 m0, s97, 40960
    s_nop 0
    buffer_load_dwordx4 v5, s[76:79], s87 offen lds
    s_add_u32 s87, s87, s92
    s_add_u32 m0, s98, 40960
    s_nop 0
    buffer_load_dwordx4 v6, s[80:83], s88 offen lds
    s_add_u32 s88, s88, s93
    s_add_u32 m0, s94, 81920
    s_nop 0
    buffer_load_dwordx4 v2, s[64:67], s84 offen lds
    s_add_u32 s84, s84, s89
    s_add_u32 m0, s95, 81920
    s_nop 0
    buffer_load_dwordx4 v3, s[68:71], s85 offen lds
    s_add_u32 s85, s85, s90
    s_add_u32 m0, s96, 81920
    s_nop 0
    buffer_load_dwordx4 v4, s[72:75], s86 offen lds
    s_add_u32 s86, s86, s91
    s_add_u32 m0, s97, 81920
    s_nop 0
    buffer_load_dwordx4 v5, s[76:79], s87 offen lds
    s_add_u32 s87, s87, s92
    s_add_u32 m0, s98, 81920
    s_nop 0
    buffer_load_dwordx4 v6, s[80:83], s88 offen lds
    s_add_u32 s88, s88, s93
    s_mov_b32 s40, s52
    s_and_b32 s41, s53, 0xffff
    s_mov_b32 s42, 5308416
    s_mov_b32 s43, 0x20000
    s_lshl_b32 s48, s2, 13
    s_lshl_b32 s47, s36, 10
    v_lshl_add_u32 v8, v0, 4, s47
    buffer_load_dword v14, v8, s[40:43], s48 offen
    s_add_u32 s47, s48, 2097152
    buffer_load_dword v14, v8, s[40:43], s47 offen
    s_add_u32 s47, s48, 4194304
    buffer_load_dword v14, v8, s[40:43], s47 offen
    s_mov_b32 s40, s54
    s_and_b32 s41, s55, 0xffff
    s_mov_b32 s42, 663552
    s_mov_b32 s43, 0x20000
    buffer_load_dword v14, v8, s[40:43], s48 offen
    v_and_b32 v9, 15, v0
    s_lshl_b32 s47, s49, 7
    v_add_u32 v9, s47, v9
    v_lshlrev_b32 v9, 6, v9
    v_lshrrev_b32 v10, 4, v0
    v_bfe_u32 v11, v0, 3, 1
    v_lshlrev_b32 v11, 1, v11
    v_xor_b32 v10, v10, v11
    v_lshl_add_u32 v7, v10, 4, v9
    v_add_u32 v8, 81920, v7
    v_mov_b32 v64, 0
    v_mov_b32 v65, 0
    v_mov_b32 v66, 0
    v_mov_b32 v67, 0
    v_mov_b32 v68, 0
    v_mov_b32 v69, 0
    v_mov_b32 v70, 0
    v_mov_b32 v71, 0
    v_mov_b32 v72, 0
    v_mov_b32 v73, 0
    v_mov_b32 v74, 0
    v_mov_b32 v75, 0
    v_mov_b32 v76, 0
    v_mov_b32 v77, 0
    v_mov_b32 v78, 0
    v_mov_b32 v79, 0
    v_mov_b32 v80, 0
    v_mov_b32 v81, 0
    v_mov_b32 v82, 0
    v_mov_b32 v83, 0
    v_mov_b32 v84, 0
    v_mov_b32 v85, 0
    v_mov_b32 v86, 0
    v_mov_b32 v87, 0
    v_mov_b32 v88, 0
    v_mov_b32 v89, 0
    v_mov_b32 v90, 0
    v_mov_b32 v91, 0
    v_mov_b32 v92, 0
    v_mov_b32 v93, 0
    v_mov_b32 v94, 0
    v_mov_b32 v95, 0
    v_mov_b32 v96, 0
    v_mov_b32 v97, 0
    v_mov_b32 v98, 0
    v_mov_b32 v99, 0
    v_mov_b32 v100, 0
    v_mov_b32 v101, 0
    v_mov_b32 v102, 0
    v_mov_b32 v103, 0
    v_mov_b32 v104, 0
    v_mov_b32 v105, 0
    v_mov_b32 v106, 0
    v_mov_b32 v107, 0
    v_mov_b32 v108, 0
    v_mov_b32 v109, 0
    v_mov_b32 v110, 0
    v_mov_b32 v111, 0
    v_mov_b32 v112, 0
    v_mov_b32 v113, 0
    v_mov_b32 v114, 0
    v_mov_b32 v115, 0
    v_mov_b32 v116, 0
    v_mov_b32 v117, 0
    v_mov_b32 v118, 0
    v_mov_b32 v119, 0
    v_mov_b32 v120, 0
    v_mov_b32 v121, 0
    v_mov_b32 v122, 0
    v_mov_b32 v123, 0
    v_mov_b32 v124, 0
    v_mov_b32 v125, 0
    v_mov_b32 v126, 0
    v_mov_b32 v127, 0
    v_mov_b32 v128, 0
    v_mov_b32 v129, 0
    v_mov_b32 v130, 0
    v_mov_b32 v131, 0
    v_mov_b32 v132, 0
    v_mov_b32 v133, 0
    v_mov_b32 v134, 0
    v_mov_b32 v135, 0
    v_mov_b32 v136, 0
    v_mov_b32 v137, 0
    v_mov_b32 v138, 0
    v_mov_b32 v139, 0
    v_mov_b32 v140, 0
    v_mov_b32 v141, 0
    v_mov_b32 v142, 0
    v_mov_b32 v143, 0
    v_mov_b32 v144, 0
    v_mov_b32 v145, 0
    v_mov_b32 v146, 0
    v_mov_b32 v147, 0
    v_mov_b32 v148, 0
    v_mov_b32 v149, 0
    v_mov_b32 v150, 0
    v_mov_b32 v151, 0
    v_mov_b32 v152, 0
    v_mov_b32 v153, 0
    v_mov_b32 v154, 0
    v_mov_b32 v155, 0
    v_mov_b32 v156, 0
    v_mov_b32 v157, 0
    v_mov_b32 v158, 0
    v_mov_b32 v159, 0
    v_mov_b32 v160, 0
    v_mov_b32 v161, 0
    v_mov_b32 v162, 0
    v_mov_b32 v163, 0
    v_mov_b32 v164, 0
    v_mov_b32 v165, 0
    v_mov_b32 v166, 0
    v_mov_b32 v167, 0
    v_mov_b32 v168, 0
    v_mov_b32 v169, 0
    v_mov_b32 v170, 0
    v_mov_b32 v171, 0
    v_mov_b32 v172, 0
    v_mov_b32 v173, 0
    v_mov_b32 v174, 0
    v_mov_b32 v175, 0
    v_mov_b32 v176, 0
    v_mov_b32 v177, 0
    v_mov_b32 v178, 0
    v_mov_b32 v179, 0
    v_mov_b32 v180, 0
    v_mov_b32 v181, 0
    v_mov_b32 v182, 0
    v_mov_b32 v183, 0
    v_mov_b32 v184, 0
    v_mov_b32 v185, 0
    v_mov_b32 v186, 0
    v_mov_b32 v187, 0
    v_mov_b32 v188, 0
    v_mov_b32 v189, 0
    v_mov_b32 v190, 0
    v_mov_b32 v191, 0
    v_mov_b32 v192, 0
    v_mov_b32 v193, 0
    v_mov_b32 v194, 0
    v_mov_b32 v195, 0
    v_mov_b32 v196, 0
    v_mov_b32 v197, 0
    v_mov_b32 v198, 0
    v_mov_b32 v199, 0
    v_mov_b32 v200, 0
    v_mov_b32 v201, 0
    v_mov_b32 v202, 0
    v_mov_b32 v203, 0
    v_mov_b32 v204, 0
    v_mov_b32 v205, 0
    v_mov_b32 v206, 0
    v_mov_b32 v207, 0
    v_mov_b32 v208, 0
    v_mov_b32 v209, 0
    v_mov_b32 v210, 0
    v_mov_b32 v211, 0
    v_mov_b32 v212, 0
    v_mov_b32 v213, 0
    v_mov_b32 v214, 0
    v_mov_b32 v215, 0
    v_mov_b32 v216, 0
    v_mov_b32 v217, 0
    v_mov_b32 v218, 0
    v_mov_b32 v219, 0
    v_mov_b32 v220, 0
    v_mov_b32 v221, 0
    v_mov_b32 v222, 0
    v_mov_b32 v223, 0
    v_mov_b32 v224, 0
    v_mov_b32 v225, 0
    v_mov_b32 v226, 0
    v_mov_b32 v227, 0
    v_mov_b32 v228, 0
    v_mov_b32 v229, 0
    v_mov_b32 v230, 0
    v_mov_b32 v231, 0
    v_mov_b32 v232, 0
    v_mov_b32 v233, 0
    v_mov_b32 v234, 0
    v_mov_b32 v235, 0
    v_mov_b32 v236, 0
    v_mov_b32 v237, 0
    v_mov_b32 v238, 0
    v_mov_b32 v239, 0
    v_mov_b32 v240, 0
    v_mov_b32 v241, 0
    v_mov_b32 v242, 0
    v_mov_b32 v243, 0
    v_mov_b32 v244, 0
    v_mov_b32 v245, 0
    v_mov_b32 v246, 0
    v_mov_b32 v247, 0
    v_mov_b32 v248, 0
    v_mov_b32 v249, 0
    v_mov_b32 v250, 0
    v_mov_b32 v251, 0
    v_mov_b32 v252, 0
    v_mov_b32 v253, 0
    v_mov_b32 v254, 0
    v_mov_b32 v255, 0
    s_cmp_lt_u32 s36, 4
    s_cbranch_scc1 L_gm_k1_kernel_np
    s_setprio 1
L_gm_k1_kernel_np:
    s_cmp_eq_u32 s50, 3
    s_cbranch_scc1 L_gm_k1_kernel_qpath
    v_lshrrev_b32 v9, 4, v0
    v_bfe_u32 v10, v0, 2, 2
    v_lshl_add_u32 v10, v9, 3, v10
    v_mul_u32_u24 v10, 288, v10
    v_and_b32 v11, 1, v0
    v_lshl_add_u32 v10, v11, 3, v10
    v_and_b32 v9, 1, v9
    v_lshlrev_b32 v9, 3, v9
    v_bfe_u32 v11, v0, 1, 1
    s_mul_i32 s47, s50, 6
    v_add_u32 v11, s47, v11
    v_add_u32 v12, 0, v11
    v_xor_b32 v13, v12, v9
    v_cmp_gt_u32 vcc, 16, v12
    s_nop 1
    v_cndmask_b32 v13, v12, v13, vcc
    v_lshl_add_u32 v52, v13, 4, v10
    v_add_u32 v52, 16384, v52
    v_add_u32 v58, 81920, v52
    v_add_u32 v12, 2, v11
    v_xor_b32 v13, v12, v9
    v_cmp_gt_u32 vcc, 16, v12
    s_nop 1
    v_cndmask_b32 v13, v12, v13, vcc
    v_lshl_add_u32 v53, v13, 4, v10
    v_add_u32 v53, 16384, v53
    v_add_u32 v59, 81920, v53
    v_add_u32 v12, 4, v11
    v_xor_b32 v13, v12, v9
    v_cmp_gt_u32 vcc, 16, v12
    s_nop 1
    v_cndmask_b32 v13, v12, v13, vcc
    v_lshl_add_u32 v54, v13, 4, v10
    v_add_u32 v54, 16384, v54
    v_add_u32 v60, 81920, v54
    v_add_u32 v12, 0, v11
    v_xor_b32 v13, v12, v9
    v_cmp_gt_u32 vcc, 16, v12
    s_nop 1
    v_cndmask_b32 v13, v12, v13, vcc
    v_lshl_add_u32 v55, v13, 4, v10
    v_add_u32 v55, 25600, v55
    v_add_u32 v61, 81920, v55
    v_add_u32 v12, 2, v11
    v_xor_b32 v13, v12, v9
    v_cmp_gt_u32 vcc, 16, v12
    s_nop 1
    v_cndmask_b32 v13, v12, v13, vcc
    v_lshl_add_u32 v56, v13, 4, v10
    v_add_u32 v56, 25600, v56
    v_add_u32 v62, 81920, v56
    v_add_u32 v12, 4, v11
    v_xor_b32 v13, v12, v9
    v_cmp_gt_u32 vcc, 16, v12
    s_nop 1
    v_cndmask_b32 v13, v12, v13, vcc
    v_lshl_add_u32 v57, v13, 4, v10
    v_add_u32 v57, 25600, v57
    v_add_u32 v63, 81920, v57
    s_waitcnt vmcnt(14)
    s_barrier
    ds_read_b128 v[40:43], v7 offset:0
    ds_read_b128 v[44:47], v7 offset:1024
    ds_read_b128 v[48:51], v7 offset:2048
    ds_read_b64_tr_b16 v[16:17], v52 offset:0
    ds_read_b64_tr_b16 v[18:19], v52 offset:1152
    ds_read_b64_tr_b16 v[20:21], v53 offset:0
    ds_read_b64_tr_b16 v[22:23], v53 offset:1152
    ds_read_b64_tr_b16 v[24:25], v54 offset:0
    ds_read_b64_tr_b16 v[26:27], v54 offset:1152
    ds_read_b64_tr_b16 v[28:29], v55 offset:0
    ds_read_b64_tr_b16 v[30:31], v55 offset:1152
    ds_read_b64_tr_b16 v[32:33], v56 offset:0
    ds_read_b64_tr_b16 v[34:35], v56 offset:1152
    ds_read_b64_tr_b16 v[36:37], v57 offset:0
    ds_read_b64_tr_b16 v[38:39], v57 offset:1152
    ds_read_b128 v[10:13], v7 offset:3072
    s_mov_b32 s62, 3
L_gm_k1_kernel_loopg:
    s_waitcnt vmcnt(5)
    s_barrier
    s_waitcnt lgkmcnt(11)
    v_mfma_f32_16x16x32_bf16 v[64:67], v[16:19], v[40:43], v[64:67]
    s_waitcnt lgkmcnt(9)
    v_mfma_f32_16x16x32_bf16 v[96:99], v[20:23], v[40:43], v[96:99]
    s_waitcnt lgkmcnt(7)
    v_mfma_f32_16x16x32_bf16 v[128:131], v[24:27], v[40:43], v[128:131]
    s_waitcnt lgkmcnt(5)
    v_mfma_f32_16x16x32_bf16 v[160:163], v[28:31], v[40:43], v[160:163]
    s_waitcnt lgkmcnt(3)
    v_mfma_f32_16x16x32_bf16 v[192:195], v[32:35], v[40:43], v[192:195]
    s_waitcnt lgkmcnt(1)
    v_mfma_f32_16x16x32_bf16 v[224:227], v[36:39], v[40:43], v[224:227]
    s_add_u32 m0, s94, 122880
    s_nop 0
    buffer_load_dwordx4 v2, s[64:67], s84 offen lds
    s_add_u32 s84, s84, s89
    ds_read_b128 v[40:43], v7 offset:4096
    v_mfma_f32_16x16x32_bf16 v[68:71], v[16:19], v[44:47], v[68:71]
    v_mfma_f32_16x16x32_bf16 v[100:103], v[20:23], v[44:47], v[100:103]
    v_mfma_f32_16x16x32_bf16 v[132:135], v[24:27], v[44:47], v[132:135]
    v_mfma_f32_16x16x32_bf16 v[164:167], v[28:31], v[44:47], v[164:167]
    v_mfma_f32_16x16x32_bf16 v[196:199], v[32:35], v[44:47], v[196:199]
    v_mfma_f32_16x16x32_bf16 v[228:231], v[36:39], v[44:47], v[228:231]
    s_add_u32 m0, s95, 122880
    s_nop 0
    buffer_load_dwordx4 v3, s[68:71], s85 offen lds
    s_add_u32 s85, s85, s90
    ds_read_b128 v[44:47], v7 offset:5120
    v_mfma_f32_16x16x32_bf16 v[72:75], v[16:19], v[48:51], v[72:75]
    v_mfma_f32_16x16x32_bf16 v[104:107], v[20:23], v[48:51], v[104:107]
    v_mfma_f32_16x16x32_bf16 v[136:139], v[24:27], v[48:51], v[136:139]
    v_mfma_f32_16x16x32_bf16 v[168:171], v[28:31], v[48:51], v[168:171]
    v_mfma_f32_16x16x32_bf16 v[200:203], v[32:35], v[48:51], v[200:203]
    v_mfma_f32_16x16x32_bf16 v[232:235], v[36:39], v[48:51], v[232:235]
    s_add_u32 m0, s96, 122880
    s_nop 0
    buffer_load_dwordx4 v4, s[72:75], s86 offen lds
    s_add_u32 s86, s86, s91
    ds_read_b128 v[48:51], v7 offset:6144
    s_waitcnt lgkmcnt(3)
    v_mfma_f32_16x16x32_bf16 v[76:79], v[16:19], v[10:13], v[76:79]
    v_mfma_f32_16x16x32_bf16 v[108:111], v[20:23], v[10:13], v[108:111]
    v_mfma_f32_16x16x32_bf16 v[140:143], v[24:27], v[10:13], v[140:143]
    v_mfma_f32_16x16x32_bf16 v[172:175], v[28:31], v[10:13], v[172:175]
    v_mfma_f32_16x16x32_bf16 v[204:207], v[32:35], v[10:13], v[204:207]
    v_mfma_f32_16x16x32_bf16 v[236:239], v[36:39], v[10:13], v[236:239]
    s_add_u32 m0, s97, 122880
    s_nop 0
    buffer_load_dwordx4 v5, s[76:79], s87 offen lds
    s_add_u32 s87, s87, s92
    ds_read_b128 v[10:13], v7 offset:7168
    s_waitcnt lgkmcnt(3)
    v_mfma_f32_16x16x32_bf16 v[80:83], v[16:19], v[40:43], v[80:83]
    v_mfma_f32_16x16x32_bf16 v[112:115], v[20:23], v[40:43], v[112:115]
    v_mfma_f32_16x16x32_bf16 v[144:147], v[24:27], v[40:43], v[144:147]
    v_mfma_f32_16x16x32_bf16 v[176:179], v[28:31], v[40:43], v[176:179]
    v_mfma_f32_16x16x32_bf16 v[208:211], v[32:35], v[40:43], v[208:211]
    v_mfma_f32_16x16x32_bf16 v[240:243], v[36:39], v[40:43], v[240:243]
    s_add_u32 m0, s98, 122880
    s_nop 0
    buffer_load_dwordx4 v6, s[80:83], s88 offen lds
    s_add_u32 s88, s88, s93
    ds_read_b128 v[40:43], v7 offset:40960
    s_waitcnt lgkmcnt(3)
    v_mfma_f32_16x16x32_bf16 v[84:87], v[16:19], v[44:47], v[84:87]
    v_mfma_f32_16x16x32_bf16 v[116:119], v[20:23], v[44:47], v[116:119]
    v_mfma_f32_16x16x32_bf16 v[148:151], v[24:27], v[44:47], v[148:151]
    v_mfma_f32_16x16x32_bf16 v[180:183], v[28:31], v[44:47], v[180:183]
    v_mfma_f32_16x16x32_bf16 v[212:215], v[32:35], v[44:47], v[212:215]
    v_mfma_f32_16x16x32_bf16 v[244:247], v[36:39], v[44:47], v[244:247]
    ds_read_b128 v[44:47], v7 offset:41984
    s_waitcnt lgkmcnt(3)
    v_mfma_f32_16x16x32_bf16 v[88:91], v[16:19], v[48:51], v[88:91]
    v_mfma_f32_16x16x32_bf16 v[120:123], v[20:23], v[48:51], v[120:123]
    v_mfma_f32_16x16x32_bf16 v[152:155], v[24:27], v[48:51], v[152:155]
    v_mfma_f32_16x16x32_bf16 v[184:187], v[28:31], v[48:51], v[184:187]
    v_mfma_f32_16x16x32_bf16 v[216:219], v[32:35], v[48:51], v[216:219]
    v_mfma_f32_16x16x32_bf16 v[248:251], v[36:39], v[48:51], v[248:251]
    ds_read_b128 v[48:51], v7 offset:43008
    s_waitcnt lgkmcnt(3)
    v_mfma_f32_16x16x32_bf16 v[92:95], v[16:19], v[10:13], v[92:95]
    ds_read_b64_tr_b16 v[16:17], v52 offset:40960
    ds_read_b64_tr_b16 v[18:19], v52 offset:42112
    v_mfma_f32_16x16x32_bf16 v[124:127], v[20:23], v[10:13], v[124:127]
    ds_read_b64_tr_b16 v[20:21], v53 offset:40960
    ds_read_b64_tr_b16 v[22:23], v53 offset:42112
    v_mfma_f32_16x16x32_bf16 v[156:159], v[24:27], v[10:13], v[156:159]
    ds_read_b64_tr_b16 v[24:25], v54 offset:40960
    ds_read_b64_tr_b16 v[26:27], v54 offset:42112
    v_mfma_f32_16x16x32_bf16 v[188:191], v[28:31], v[10:13], v[188:191]
    ds_read_b64_tr_b16 v[28:29], v55 offset:40960
    ds_read_b64_tr_b16 v[30:31], v55 offset:42112
    v_mfma_f32_16x16x32_bf16 v[220:223], v[32:35], v[10:13], v[220:223]
    ds_read_b64_tr_b16 v[32:33], v56 offset:40960
    ds_read_b64_tr_b16 v[34:35], v56 offset:42112
    v_mfma_f32_16x16x32_bf16 v[252:255], v[36:39], v[10:13], v[252:255]
    ds_read_b64_tr_b16 v[36:37], v57 offset:40960
    ds_read_b64_tr_b16 v[38:39], v57 offset:42112
    ds_read_b128 v[10:13], v7 offset:44032
    s_waitcnt vmcnt(5)
    s_barrier
    s_waitcnt lgkmcnt(11)
    v_mfma_f32_16x16x32_bf16 v[64:67], v[16:19], v[40:43], v[64:67]
    s_waitcnt lgkmcnt(9)
    v_mfma_f32_16x16x32_bf16 v[96:99], v[20:23], v[40:43], v[96:99]
    s_waitcnt lgkmcnt(7)
    v_mfma_f32_16x16x32_bf16 v[128:131], v[24:27], v[40:43], v[128:131]
    s_waitcnt lgkmcnt(5)
    v_mfma_f32_16x16x32_bf16 v[160:163], v[28:31], v[40:43], v[160:163]
    s_waitcnt lgkmcnt(3)
    v_mfma_f32_16x16x32_bf16 v[192:195], v[32:35], v[40:43], v[192:195]
    s_waitcnt lgkmcnt(1)
    v_mfma_f32_16x16x32_bf16 v[224:227], v[36:39], v[40:43], v[224:227]
    s_add_u32 m0, s94, 0
    s_nop 0
    buffer_load_dwordx4 v2, s[64:67], s84 offen lds
    s_add_u32 s84, s84, s89
    ds_read_b128 v[40:43], v7 offset:45056
    v_mfma_f32_16x16x32_bf16 v[68:71], v[16:19], v[44:47], v[68:71]
    v_mfma_f32_16x16x32_bf16 v[100:103], v[20:23], v[44:47], v[100:103]
    v_mfma_f32_16x16x32_bf16 v[132:135], v[24:27], v[44:47], v[132:135]
    v_mfma_f32_16x16x32_bf16 v[164:167], v[28:31], v[44:47], v[164:167]
    v_mfma_f32_16x16x32_bf16 v[196:199], v[32:35], v[44:47], v[196:199]
    v_mfma_f32_16x16x32_bf16 v[228:231], v[36:39], v[44:47], v[228:231]
    s_add_u32 m0, s95, 0
    s_nop 0
    buffer_load_dwordx4 v3, s[68:71], s85 offen lds
    s_add_u32 s85, s85, s90
    ds_read_b128 v[44:47], v7 offset:46080
    v_mfma_f32_16x16x32_bf16 v[72:75], v[16:19], v[48:51], v[72:75]
    v_mfma_f32_16x16x32_bf16 v[104:107], v[20:23], v[48:51], v[104:107]
    v_mfma_f32_16x16x32_bf16 v[136:139], v[24:27], v[48:51], v[136:139]
    v_mfma_f32_16x16x32_bf16 v[168:171], v[28:31], v[48:51], v[168:171]
    v_mfma_f32_16x16x32_bf16 v[200:203], v[32:35], v[48:51], v[200:203]
    v_mfma_f32_16x16x32_bf16 v[232:235], v[36:39], v[48:51], v[232:235]
    s_add_u32 m0, s96, 0
    s_nop 0
    buffer_load_dwordx4 v4, s[72:75], s86 offen lds
    s_add_u32 s86, s86, s91
    ds_read_b128 v[48:51], v7 offset:47104
    s_waitcnt lgkmcnt(3)
    v_mfma_f32_16x16x32_bf16 v[76:79], v[16:19], v[10:13], v[76:79]
    v_mfma_f32_16x16x32_bf16 v[108:111], v[20:23], v[10:13], v[108:111]
    v_mfma_f32_16x16x32_bf16 v[140:143], v[24:27], v[10:13], v[140:143]
    v_mfma_f32_16x16x32_bf16 v[172:175], v[28:31], v[10:13], v[172:175]
    v_mfma_f32_16x16x32_bf16 v[204:207], v[32:35], v[10:13], v[204:207]
    v_mfma_f32_16x16x32_bf16 v[236:239], v[36:39], v[10:13], v[236:239]
    s_add_u32 m0, s97, 0
    s_nop 0
    buffer_load_dwordx4 v5, s[76:79], s87 offen lds
    s_add_u32 s87, s87, s92
    ds_read_b128 v[10:13], v7 offset:48128
    s_waitcnt lgkmcnt(3)
    v_mfma_f32_16x16x32_bf16 v[80:83], v[16:19], v[40:43], v[80:83]
    v_mfma_f32_16x16x32_bf16 v[112:115], v[20:23], v[40:43], v[112:115]
    v_mfma_f32_16x16x32_bf16 v[144:147], v[24:27], v[40:43], v[144:147]
    v_mfma_f32_16x16x32_bf16 v[176:179], v[28:31], v[40:43], v[176:179]
    v_mfma_f32_16x16x32_bf16 v[208:211], v[32:35], v[40:43], v[208:211]
    v_mfma_f32_16x16x32_bf16 v[240:243], v[36:39], v[40:43], v[240:243]
    s_add_u32 m0, s98, 0
    s_nop 0
    buffer_load_dwordx4 v6, s[80:83], s88 offen lds
    s_add_u32 s88, s88, s93
    ds_read_b128 v[40:43], v8 offset:0
    s_waitcnt lgkmcnt(3)
    v_mfma_f32_16x16x32_bf16 v[84:87], v[16:19], v[44:47], v[84:87]
    v_mfma_f32_16x16x32_bf16 v[116:119], v[20:23], v[44:47], v[116:119]
    v_mfma_f32_16x16x32_bf16 v[148:151], v[24:27], v[44:47], v[148:151]
    v_mfma_f32_16x16x32_bf16 v[180:183], v[28:31], v[44:47], v[180:183]
    v_mfma_f32_16x16x32_bf16 v[212:215], v[32:35], v[44:47], v[212:215]
    v_mfma_f32_16x16x32_bf16 v[244:247], v[36:39], v[44:47], v[244:247]
    ds_read_b128 v[44:47], v8 offset:1024
    s_waitcnt lgkmcnt(3)
    v_mfma_f32_16x16x32_bf16 v[88:91], v[16:19], v[48:51], v[88:91]
    v_mfma_f32_16x16x32_bf16 v[120:123], v[20:23], v[48:51], v[120:123]
    v_mfma_f32_16x16x32_bf16 v[152:155], v[24:27], v[48:51], v[152:155]
    v_mfma_f32_16x16x32_bf16 v[184:187], v[28:31], v[48:51], v[184:187]
    v_mfma_f32_16x16x32_bf16 v[216:219], v[32:35], v[48:51], v[216:219]
    v_mfma_f32_16x16x32_bf16 v[248:251], v[36:39], v[48:51], v[248:251]
    ds_read_b128 v[48:51], v8 offset:2048
    s_waitcnt lgkmcnt(3)
    v_mfma_f32_16x16x32_bf16 v[92:95], v[16:19], v[10:13], v[92:95]
    ds_read_b64_tr_b16 v[16:17], v58 offset:0
    ds_read_b64_tr_b16 v[18:19], v58 offset:1152
    v_mfma_f32_16x16x32_bf16 v[124:127], v[20:23], v[10:13], v[124:127]
    ds_read_b64_tr_b16 v[20:21], v59 offset:0
    ds_read_b64_tr_b16 v[22:23], v59 offset:1152
    v_mfma_f32_16x16x32_bf16 v[156:159], v[24:27], v[10:13], v[156:159]
    ds_read_b64_tr_b16 v[24:25], v60 offset:0
    ds_read_b64_tr_b16 v[26:27], v60 offset:1152
    v_mfma_f32_16x16x32_bf16 v[188:191], v[28:31], v[10:13], v[188:191]
    ds_read_b64_tr_b16 v[28:29], v61 offset:0
    ds_read_b64_tr_b16 v[30:31], v61 offset:1152
    v_mfma_f32_16x16x32_bf16 v[220:223], v[32:35], v[10:13], v[220:223]
    ds_read_b64_tr_b16 v[32:33], v62 offset:0
    ds_read_b64_tr_b16 v[34:35], v62 offset:1152
    v_mfma_f32_16x16x32_bf16 v[252:255], v[36:39], v[10:13], v[252:255]
    ds_read_b64_tr_b16 v[36:37], v63 offset:0
    ds_read_b64_tr_b16 v[38:39], v63 offset:1152
    ds_read_b128 v[10:13], v8 offset:3072
    s_waitcnt vmcnt(5)
    s_barrier
    s_waitcnt lgkmcnt(11)
    v_mfma_f32_16x16x32_bf16 v[64:67], v[16:19], v[40:43], v[64:67]
    s_waitcnt lgkmcnt(9)
    v_mfma_f32_16x16x32_bf16 v[96:99], v[20:23], v[40:43], v[96:99]
    s_waitcnt lgkmcnt(7)
    v_mfma_f32_16x16x32_bf16 v[128:131], v[24:27], v[40:43], v[128:131]
    s_waitcnt lgkmcnt(5)
    v_mfma_f32_16x16x32_bf16 v[160:163], v[28:31], v[40:43], v[160:163]
    s_waitcnt lgkmcnt(3)
    v_mfma_f32_16x16x32_bf16 v[192:195], v[32:35], v[40:43], v[192:195]
    s_waitcnt lgkmcnt(1)
    v_mfma_f32_16x16x32_bf16 v[224:227], v[36:39], v[40:43], v[224:227]
    s_add_u32 m0, s94, 40960
    s_nop 0
    buffer_load_dwordx4 v2, s[64:67], s84 offen lds
    s_add_u32 s84, s84, s89
    ds_read_b128 v[40:43], v8 offset:4096
    v_mfma_f32_16x16x32_bf16 v[68:71], v[16:19], v[44:47], v[68:71]
    v_mfma_f32_16x16x32_bf16 v[100:103], v[20:23], v[44:47], v[100:103]
    v_mfma_f32_16x16x32_bf16 v[132:135], v[24:27], v[44:47], v[132:135]
    v_mfma_f32_16x16x32_bf16 v[164:167], v[28:31], v[44:47], v[164:167]
    v_mfma_f32_16x16x32_bf16 v[196:199], v[32:35], v[44:47], v[196:199]
    v_mfma_f32_16x16x32_bf16 v[228:231], v[36:39], v[44:47], v[228:231]
    s_add_u32 m0, s95, 40960
    s_nop 0
    buffer_load_dwordx4 v3, s[68:71], s85 offen lds
    s_add_u32 s85, s85, s90
    ds_read_b128 v[44:47], v8 offset:5120
    v_mfma_f32_16x16x32_bf16 v[72:75], v[16:19], v[48:51], v[72:75]
    v_mfma_f32_16x16x32_bf16 v[104:107], v[20:23], v[48:51], v[104:107]
    v_mfma_f32_16x16x32_bf16 v[136:139], v[24:27], v[48:51], v[136:139]
    v_mfma_f32_16x16x32_bf16 v[168:171], v[28:31], v[48:51], v[168:171]
    v_mfma_f32_16x16x32_bf16 v[200:203], v[32:35], v[48:51], v[200:203]
    v_mfma_f32_16x16x32_bf16 v[232:235], v[36:39], v[48:51], v[232:235]
    s_add_u32 m0, s96, 40960
    s_nop 0
    buffer_load_dwordx4 v4, s[72:75], s86 offen lds
    s_add_u32 s86, s86, s91
    ds_read_b128 v[48:51], v8 offset:6144
    s_waitcnt lgkmcnt(3)
    v_mfma_f32_16x16x32_bf16 v[76:79], v[16:19], v[10:13], v[76:79]
    v_mfma_f32_16x16x32_bf16 v[108:111], v[20:23], v[10:13], v[108:111]
    v_mfma_f32_16x16x32_bf16 v[140:143], v[24:27], v[10:13], v[140:143]
    v_mfma_f32_16x16x32_bf16 v[172:175], v[28:31], v[10:13], v[172:175]
    v_mfma_f32_16x16x32_bf16 v[204:207], v[32:35], v[10:13], v[204:207]
    v_mfma_f32_16x16x32_bf16 v[236:239], v[36:39], v[10:13], v[236:239]
    s_add_u32 m0, s97, 40960
    s_nop 0
    buffer_load_dwordx4 v5, s[76:79], s87 offen lds
    s_add_u32 s87, s87, s92
    ds_read_b128 v[10:13], v8 offset:7168
    s_waitcnt lgkmcnt(3)
    v_mfma_f32_16x16x32_bf16 v[80:83], v[16:19], v[40:43], v[80:83]
    v_mfma_f32_16x16x32_bf16 v[112:115], v[20:23], v[40:43], v[112:115]
    v_mfma_f32_16x16x32_bf16 v[144:147], v[24:27], v[40:43], v[144:147]
    v_mfma_f32_16x16x32_bf16 v[176:179], v[28:31], v[40:43], v[176:179]
    v_mfma_f32_16x16x32_bf16 v[208:211], v[32:35], v[40:43], v[208:211]
    v_mfma_f32_16x16x32_bf16 v[240:243], v[36:39], v[40:43], v[240:243]
    s_add_u32 m0, s98, 40960
    s_nop 0
    buffer_load_dwordx4 v6, s[80:83], s88 offen lds
    s_add_u32 s88, s88, s93
    ds_read_b128 v[40:43], v8 offset:40960
    s_waitcnt lgkmcnt(3)
    v_mfma_f32_16x16x32_bf16 v[84:87], v[16:19], v[44:47], v[84:87]
    v_mfma_f32_16x16x32_bf16 v[116:119], v[20:23], v[44:47], v[116:119]
    v_mfma_f32_16x16x32_bf16 v[148:151], v[24:27], v[44:47], v[148:151]
    v_mfma_f32_16x16x32_bf16 v[180:183], v[28:31], v[44:47], v[180:183]
    v_mfma_f32_16x16x32_bf16 v[212:215], v[32:35], v[44:47], v[212:215]
    v_mfma_f32_16x16x32_bf16 v[244:247], v[36:39], v[44:47], v[244:247]
    ds_read_b128 v[44:47], v8 offset:41984
    s_waitcnt lgkmcnt(3)
    v_mfma_f32_16x16x32_bf16 v[88:91], v[16:19], v[48:51], v[88:91]
    v_mfma_f32_16x16x32_bf16 v[120:123], v[20:23], v[48:51], v[120:123]
    v_mfma_f32_16x16x32_bf16 v[152:155], v[24:27], v[48:51], v[152:155]
    v_mfma_f32_16x16x32_bf16 v[184:187], v[28:31], v[48:51], v[184:187]
    v_mfma_f32_16x16x32_bf16 v[216:219], v[32:35], v[48:51], v[216:219]
    v_mfma_f32_16x16x32_bf16 v[248:251], v[36:39], v[48:51], v[248:251]
    ds_read_b128 v[48:51], v8 offset:43008
    s_waitcnt lgkmcnt(3)
    v_mfma_f32_16x16x32_bf16 v[92:95], v[16:19], v[10:13], v[92:95]
    ds_read_b64_tr_b16 v[16:17], v58 offset:40960
    ds_read_b64_tr_b16 v[18:19], v58 offset:42112
    v_mfma_f32_16x16x32_bf16 v[124:127], v[20:23], v[10:13], v[124:127]
    ds_read_b64_tr_b16 v[20:21], v59 offset:40960
    ds_read_b64_tr_b16 v[22:23], v59 offset:42112
    v_mfma_f32_16x16x32_bf16 v[156:159], v[24:27], v[10:13], v[156:159]
    ds_read_b64_tr_b16 v[24:25], v60 offset:40960
    ds_read_b64_tr_b16 v[26:27], v60 offset:42112
    v_mfma_f32_16x16x32_bf16 v[188:191], v[28:31], v[10:13], v[188:191]
    ds_read_b64_tr_b16 v[28:29], v61 offset:40960
    ds_read_b64_tr_b16 v[30:31], v61 offset:42112
    v_mfma_f32_16x16x32_bf16 v[220:223], v[32:35], v[10:13], v[220:223]
    ds_read_b64_tr_b16 v[32:33], v62 offset:40960
    ds_read_b64_tr_b16 v[34:35], v62 offset:42112
    v_mfma_f32_16x16x32_bf16 v[252:255], v[36:39], v[10:13], v[252:255]
    ds_read_b64_tr_b16 v[36:37], v63 offset:40960
    ds_read_b64_tr_b16 v[38:39], v63 offset:42112
    ds_read_b128 v[10:13], v8 offset:44032
    s_waitcnt vmcnt(5)
    s_barrier
    s_waitcnt lgkmcnt(11)
    v_mfma_f32_16x16x32_bf16 v[64:67], v[16:19], v[40:43], v[64:67]
    s_waitcnt lgkmcnt(9)
    v_mfma_f32_16x16x32_bf16 v[96:99], v[20:23], v[40:43], v[96:99]
    s_waitcnt lgkmcnt(7)
    v_mfma_f32_16x16x32_bf16 v[128:131], v[24:27], v[40:43], v[128:131]
    s_waitcnt lgkmcnt(5)
    v_mfma_f32_16x16x32_bf16 v[160:163], v[28:31], v[40:43], v[160:163]
    s_waitcnt lgkmcnt(3)
    v_mfma_f32_16x16x32_bf16 v[192:195], v[32:35], v[40:43], v[192:195]
    s_waitcnt lgkmcnt(1)
    v_mfma_f32_16x16x32_bf16 v[224:227], v[36:39], v[40:43], v[224:227]
    s_add_u32 m0, s94, 81920
    s_nop 0
    buffer_load_dwordx4 v2, s[64:67], s84 offen lds
    s_add_u32 s84, s84, s89
    ds_read_b128 v[40:43], v8 offset:45056
    v_mfma_f32_16x16x32_bf16 v[68:71], v[16:19], v[44:47], v[68:71]
    v_mfma_f32_16x16x32_bf16 v[100:103], v[20:23], v[44:47], v[100:103]
    v_mfma_f32_16x16x32_bf16 v[132:135], v[24:27], v[44:47], v[132:135]
    v_mfma_f32_16x16x32_bf16 v[164:167], v[28:31], v[44:47], v[164:167]
    v_mfma_f32_16x16x32_bf16 v[196:199], v[32:35], v[44:47], v[196:199]
    v_mfma_f32_16x16x32_bf16 v[228:231], v[36:39], v[44:47], v[228:231]
    s_add_u32 m0, s95, 81920
    s_nop 0
    buffer_load_dwordx4 v3, s[68:71], s85 offen lds
    s_add_u32 s85, s85, s90
    ds_read_b128 v[44:47], v8 offset:46080
    v_mfma_f32_16x16x32_bf16 v[72:75], v[16:19], v[48:51], v[72:75]
    v_mfma_f32_16x16x32_bf16 v[104:107], v[20:23], v[48:51], v[104:107]
    v_mfma_f32_16x16x32_bf16 v[136:139], v[24:27], v[48:51], v[136:139]
    v_mfma_f32_16x16x32_bf16 v[168:171], v[28:31], v[48:51], v[168:171]
    v_mfma_f32_16x16x32_bf16 v[200:203], v[32:35], v[48:51], v[200:203]
    v_mfma_f32_16x16x32_bf16 v[232:235], v[36:39], v[48:51], v[232:235]
    s_add_u32 m0, s96, 81920
    s_nop 0
    buffer_load_dwordx4 v4, s[72:75], s86 offen lds
    s_add_u32 s86, s86, s91
    ds_read_b128 v[48:51], v8 offset:47104
    s_waitcnt lgkmcnt(3)
    v_mfma_f32_16x16x32_bf16 v[76:79], v[16:19], v[10:13], v[76:79]
    v_mfma_f32_16x16x32_bf16 v[108:111], v[20:23], v[10:13], v[108:111]
    v_mfma_f32_16x16x32_bf16 v[140:143], v[24:27], v[10:13], v[140:143]
    v_mfma_f32_16x16x32_bf16 v[172:175], v[28:31], v[10:13], v[172:175]
    v_mfma_f32_16x16x32_bf16 v[204:207], v[32:35], v[10:13], v[204:207]
    v_mfma_f32_16x16x32_bf16 v[236:239], v[36:39], v[10:13], v[236:239]
    s_add_u32 m0, s97, 81920
    s_nop 0
    buffer_load_dwordx4 v5, s[76:79], s87 offen lds
    s_add_u32 s87, s87, s92
    ds_read_b128 v[10:13], v8 offset:48128
    s_waitcnt lgkmcnt(3)
    v_mfma_f32_16x16x32_bf16 v[80:83], v[16:19], v[40:43], v[80:83]
    v_mfma_f32_16x16x32_bf16 v[112:115], v[20:23], v[40:43], v[112:115]
    v_mfma_f32_16x16x32_bf16 v[144:147], v[24:27], v[40:43], v[144:147]
    v_mfma_f32_16x16x32_bf16 v[176:179], v[28:31], v[40:43], v[176:179]
    v_mfma_f32_16x16x32_bf16 v[208:211], v[32:35], v[40:43], v[208:211]
    v_mfma_f32_16x16x32_bf16 v[240:243], v[36:39], v[40:43], v[240:243]
    s_add_u32 m0, s98, 81920
    s_nop 0
    buffer_load_dwordx4 v6, s[80:83], s88 offen lds
    s_add_u32 s88, s88, s93
    ds_read_b128 v[40:43], v7 offset:0
    s_waitcnt lgkmcnt(3)
    v_mfma_f32_16x16x32_bf16 v[84:87], v[16:19], v[44:47], v[84:87]
    v_mfma_f32_16x16x32_bf16 v[116:119], v[20:23], v[44:47], v[116:119]
    v_mfma_f32_16x16x32_bf16 v[148:151], v[24:27], v[44:47], v[148:151]
    v_mfma_f32_16x16x32_bf16 v[180:183], v[28:31], v[44:47], v[180:183]
    v_mfma_f32_16x16x32_bf16 v[212:215], v[32:35], v[44:47], v[212:215]
    v_mfma_f32_16x16x32_bf16 v[244:247], v[36:39], v[44:47], v[244:247]
    ds_read_b128 v[44:47], v7 offset:1024
    s_waitcnt lgkmcnt(3)
    v_mfma_f32_16x16x32_bf16 v[88:91], v[16:19], v[48:51], v[88:91]
    v_mfma_f32_16x16x32_bf16 v[120:123], v[20:23], v[48:51], v[120:123]
    v_mfma_f32_16x16x32_bf16 v[152:155], v[24:27], v[48:51], v[152:155]
    v_mfma_f32_16x16x32_bf16 v[184:187], v[28:31], v[48:51], v[184:187]
    v_mfma_f32_16x16x32_bf16 v[216:219], v[32:35], v[48:51], v[216:219]
    v_mfma_f32_16x16x32_bf16 v[248:251], v[36:39], v[48:51], v[248:251]
    ds_read_b128 v[48:51], v7 offset:2048
    s_waitcnt lgkmcnt(3)
    v_mfma_f32_16x16x32_bf16 v[92:95], v[16:19], v[10:13], v[92:95]
    ds_read_b64_tr_b16 v[16:17], v52 offset:0
    ds_read_b64_tr_b16 v[18:19], v52 offset:1152
    v_mfma_f32_16x16x32_bf16 v[124:127], v[20:23], v[10:13], v[124:127]
    ds_read_b64_tr_b16 v[20:21], v53 offset:0
    ds_read_b64_tr_b16 v[22:23], v53 offset:1152
    v_mfma_f32_16x16x32_bf16 v[156:159], v[24:27], v[10:13], v[156:159]
    ds_read_b64_tr_b16 v[24:25], v54 offset:0
    ds_read_b64_tr_b16 v[26:27], v54 offset:1152
    v_mfma_f32_16x16x32_bf16 v[188:191], v[28:31], v[10:13], v[188:191]
    ds_read_b64_tr_b16 v[28:29], v55 offset:0
    ds_read_b64_tr_b16 v[30:31], v55 offset:1152
    v_mfma_f32_16x16x32_bf16 v[220:223], v[32:35], v[10:13], v[220:223]
    ds_read_b64_tr_b16 v[32:33], v56 offset:0
    ds_read_b64_tr_b16 v[34:35], v56 offset:1152
    v_mfma_f32_16x16x32_bf16 v[252:255], v[36:39], v[10:13], v[252:255]
    ds_read_b64_tr_b16 v[36:37], v57 offset:0
    ds_read_b64_tr_b16 v[38:39], v57 offset:1152
    ds_read_b128 v[10:13], v7 offset:3072
    s_sub_u32 s62, s62, 1
    s_cmp_lg_u32 s62, 0
    s_cbranch_scc1 L_gm_k1_kernel_loopg
    s_waitcnt vmcnt(5)
    s_barrier
    s_waitcnt lgkmcnt(11)
    v_mfma_f32_16x16x32_bf16 v[64:67], v[16:19], v[40:43], v[64:67]
    s_waitcnt lgkmcnt(9)
    v_mfma_f32_16x16x32_bf16 v[96:99], v[20:23], v[40:43], v[96:99]
    s_waitcnt lgkmcnt(7)
    v_mfma_f32_16x16x32_bf16 v[128:131], v[24:27], v[40:43], v[128:131]
    s_waitcnt lgkmcnt(5)
    v_mfma_f32_16x16x32_bf16 v[160:163], v[28:31], v[40:43], v[160:163]
    s_waitcnt lgkmcnt(3)
    v_mfma_f32_16x16x32_bf16 v[192:195], v[32:35], v[40:43], v[192:195]
    s_waitcnt lgkmcnt(1)
    v_mfma_f32_16x16x32_bf16 v[224:227], v[36:39], v[40:43], v[224:227]
    s_add_u32 m0, s94, 122880
    s_nop 0
    buffer_load_dwordx4 v2, s[64:67], s84 offen lds
    s_add_u32 s84, s84, s89
    ds_read_b128 v[40:43], v7 offset:4096
    v_mfma_f32_16x16x32_bf16 v[68:71], v[16:19], v[44:47], v[68:71]
    v_mfma_f32_16x16x32_bf16 v[100:103], v[20:23], v[44:47], v[100:103]
    v_mfma_f32_16x16x32_bf16 v[132:135], v[24:27], v[44:47], v[132:135]
    v_mfma_f32_16x16x32_bf16 v[164:167], v[28:31], v[44:47], v[164:167]
    v_mfma_f32_16x16x32_bf16 v[196:199], v[32:35], v[44:47], v[196:199]
    v_mfma_f32_16x16x32_bf16 v[228:231], v[36:39], v[44:47], v[228:231]
    s_add_u32 m0, s95, 122880
    s_nop 0
    buffer_load_dwordx4 v3, s[68:71], s85 offen lds
    s_add_u32 s85, s85, s90
    ds_read_b128 v[44:47], v7 offset:5120
    v_mfma_f32_16x16x32_bf16 v[72:75], v[16:19], v[48:51], v[72:75]
    v_mfma_f32_16x16x32_bf16 v[104:107], v[20:23], v[48:51], v[104:107]
    v_mfma_f32_16x16x32_bf16 v[136:139], v[24:27], v[48:51], v[136:139]
    v_mfma_f32_16x16x32_bf16 v[168:171], v[28:31], v[48:51], v[168:171]
    v_mfma_f32_16x16x32_bf16 v[200:203], v[32:35], v[48:51], v[200:203]
    v_mfma_f32_16x16x32_bf16 v[232:235], v[36:39], v[48:51], v[232:235]
    s_add_u32 m0, s96, 122880
    s_nop 0
    buffer_load_dwordx4 v4, s[72:75], s86 offen lds
    s_add_u32 s86, s86, s91
    ds_read_b128 v[48:51], v7 offset:6144
    s_waitcnt lgkmcnt(3)
    v_mfma_f32_16x16x32_bf16 v[76:79], v[16:19], v[10:13], v[76:79]
    v_mfma_f32_16x16x32_bf16 v[108:111], v[20:23], v[10:13], v[108:111]
    v_mfma_f32_16x16x32_bf16 v[140:143], v[24:27], v[10:13], v[140:143]
    v_mfma_f32_16x16x32_bf16 v[172:175], v[28:31], v[10:13], v[172:175]
    v_mfma_f32_16x16x32_bf16 v[204:207], v[32:35], v[10:13], v[204:207]
    v_mfma_f32_16x16x32_bf16 v[236:239], v[36:39], v[10:13], v[236:239]
    s_add_u32 m0, s97, 122880
    s_nop 0
    buffer_load_dwordx4 v5, s[76:79], s87 offen lds
    s_add_u32 s87, s87, s92
    ds_read_b128 v[10:13], v7 offset:7168
    s_waitcnt lgkmcnt(3)
    v_mfma_f32_16x16x32_bf16 v[80:83], v[16:19], v[40:43], v[80:83]
    v_mfma_f32_16x16x32_bf16 v[112:115], v[20:23], v[40:43], v[112:115]
    v_mfma_f32_16x16x32_bf16 v[144:147], v[24:27], v[40:43], v[144:147]
    v_mfma_f32_16x16x32_bf16 v[176:179], v[28:31], v[40:43], v[176:179]
    v_mfma_f32_16x16x32_bf16 v[208:211], v[32:35], v[40:43], v[208:211]
    v_mfma_f32_16x16x32_bf16 v[240:243], v[36:39], v[40:43], v[240:243]
    s_add_u32 m0, s98, 122880
    s_nop 0
    buffer_load_dwordx4 v6, s[80:83], s88 offen lds
    s_add_u32 s88, s88, s93
    ds_read_b128 v[40:43], v7 offset:40960
    s_waitcnt lgkmcnt(3)
    v_mfma_f32_16x16x32_bf16 v[84:87], v[16:19], v[44:47], v[84:87]
    v_mfma_f32_16x16x32_bf16 v[116:119], v[20:23], v[44:47], v[116:119]
    v_mfma_f32_16x16x32_bf16 v[148:151], v[24:27], v[44:47], v[148:151]
    v_mfma_f32_16x16x32_bf16 v[180:183], v[28:31], v[44:47], v[180:183]
    v_mfma_f32_16x16x32_bf16 v[212:215], v[32:35], v[44:47], v[212:215]
    v_mfma_f32_16x16x32_bf16 v[244:247], v[36:39], v[44:47], v[244:247]
    ds_read_b128 v[44:47], v7 offset:41984
    s_waitcnt lgkmcnt(3)
    v_mfma_f32_16x16x32_bf16 v[88:91], v[16:19], v[48:51], v[88:91]
    v_mfma_f32_16x16x32_bf16 v[120:123], v[20:23], v[48:51], v[120:123]
    v_mfma_f32_16x16x32_bf16 v[152:155], v[24:27], v[48:51], v[152:155]
    v_mfma_f32_16x16x32_bf16 v[184:187], v[28:31], v[48:51], v[184:187]
    v_mfma_f32_16x16x32_bf16 v[216:219], v[32:35], v[48:51], v[216:219]
    v_mfma_f32_16x16x32_bf16 v[248:251], v[36:39], v[48:51], v[248:251]
    ds_read_b128 v[48:51], v7 offset:43008
    s_waitcnt lgkmcnt(3)
    v_mfma_f32_16x16x32_bf16 v[92:95], v[16:19], v[10:13], v[92:95]
    ds_read_b64_tr_b16 v[16:17], v52 offset:40960
    ds_read_b64_tr_b16 v[18:19], v52 offset:42112
    v_mfma_f32_16x16x32_bf16 v[124:127], v[20:23], v[10:13], v[124:127]
    ds_read_b64_tr_b16 v[20:21], v53 offset:40960
    ds_read_b64_tr_b16 v[22:23], v53 offset:42112
    v_mfma_f32_16x16x32_bf16 v[156:159], v[24:27], v[10:13], v[156:159]
    ds_read_b64_tr_b16 v[24:25], v54 offset:40960
    ds_read_b64_tr_b16 v[26:27], v54 offset:42112
    v_mfma_f32_16x16x32_bf16 v[188:191], v[28:31], v[10:13], v[188:191]
    ds_read_b64_tr_b16 v[28:29], v55 offset:40960
    ds_read_b64_tr_b16 v[30:31], v55 offset:42112
    v_mfma_f32_16x16x32_bf16 v[220:223], v[32:35], v[10:13], v[220:223]
    ds_read_b64_tr_b16 v[32:33], v56 offset:40960
    ds_read_b64_tr_b16 v[34:35], v56 offset:42112
    v_mfma_f32_16x16x32_bf16 v[252:255], v[36:39], v[10:13], v[252:255]
    ds_read_b64_tr_b16 v[36:37], v57 offset:40960
    ds_read_b64_tr_b16 v[38:39], v57 offset:42112
    ds_read_b128 v[10:13], v7 offset:44032
    s_waitcnt vmcnt(5)
    s_barrier
    s_waitcnt lgkmcnt(11)
    v_mfma_f32_16x16x32_bf16 v[64:67], v[16:19], v[40:43], v[64:67]
    s_waitcnt lgkmcnt(9)
    v_mfma_f32_16x16x32_bf16 v[96:99], v[20:23], v[40:43], v[96:99]
    s_waitcnt lgkmcnt(7)
    v_mfma_f32_16x16x32_bf16 v[128:131], v[24:27], v[40:43], v[128:131]
    s_waitcnt lgkmcnt(5)
    v_mfma_f32_16x16x32_bf16 v[160:163], v[28:31], v[40:43], v[160:163]
    s_waitcnt lgkmcnt(3)
    v_mfma_f32_16x16x32_bf16 v[192:195], v[32:35], v[40:43], v[192:195]
    s_waitcnt lgkmcnt(1)
    v_mfma_f32_16x16x32_bf16 v[224:227], v[36:39], v[40:43], v[224:227]
    s_add_u32 m0, s94, 0
    s_nop 0
    buffer_load_dwordx4 v2, s[64:67], s84 offen lds
    s_add_u32 s84, s84, s89
    ds_read_b128 v[40:43], v7 offset:45056
    v_mfma_f32_16x16x32_bf16 v[68:71], v[16:19], v[44:47], v[68:71]
    v_mfma_f32_16x16x32_bf16 v[100:103], v[20:23], v[44:47], v[100:103]
    v_mfma_f32_16x16x32_bf16 v[132:135], v[24:27], v[44:47], v[132:135]
    v_mfma_f32_16x16x32_bf16 v[164:167], v[28:31], v[44:47], v[164:167]
    v_mfma_f32_16x16x32_bf16 v[196:199], v[32:35], v[44:47], v[196:199]
    v_mfma_f32_16x16x32_bf16 v[228:231], v[36:39], v[44:47], v[228:231]
    s_add_u32 m0, s95, 0
    s_nop 0
    buffer_load_dwordx4 v3, s[68:71], s85 offen lds
    s_add_u32 s85, s85, s90
    ds_read_b128 v[44:47], v7 offset:46080
    v_mfma_f32_16x16x32_bf16 v[72:75], v[16:19], v[48:51], v[72:75]
    v_mfma_f32_16x16x32_bf16 v[104:107], v[20:23], v[48:51], v[104:107]
    v_mfma_f32_16x16x32_bf16 v[136:139], v[24:27], v[48:51], v[136:139]
    v_mfma_f32_16x16x32_bf16 v[168:171], v[28:31], v[48:51], v[168:171]
    v_mfma_f32_16x16x32_bf16 v[200:203], v[32:35], v[48:51], v[200:203]
    v_mfma_f32_16x16x32_bf16 v[232:235], v[36:39], v[48:51], v[232:235]
    s_add_u32 m0, s96, 0
    s_nop 0
    buffer_load_dwordx4 v4, s[72:75], s86 offen lds
    s_add_u32 s86, s86, s91
    ds_read_b128 v[48:51], v7 offset:47104
    s_waitcnt lgkmcnt(3)
    v_mfma_f32_16x16x32_bf16 v[76:79], v[16:19], v[10:13], v[76:79]
    v_mfma_f32_16x16x32_bf16 v[108:111], v[20:23], v[10:13], v[108:111]
    v_mfma_f32_16x16x32_bf16 v[140:143], v[24:27], v[10:13], v[140:143]
    v_mfma_f32_16x16x32_bf16 v[172:175], v[28:31], v[10:13], v[172:175]
    v_mfma_f32_16x16x32_bf16 v[204:207], v[32:35], v[10:13], v[204:207]
    v_mfma_f32_16x16x32_bf16 v[236:239], v[36:39], v[10:13], v[236:239]
    s_add_u32 m0, s97, 0
    s_nop 0
    buffer_load_dwordx4 v5, s[76:79], s87 offen lds
    s_add_u32 s87, s87, s92
    ds_read_b128 v[10:13], v7 offset:48128
    s_waitcnt lgkmcnt(3)
    v_mfma_f32_16x16x32_bf16 v[80:83], v[16:19], v[40:43], v[80:83]
    v_mfma_f32_16x16x32_bf16 v[112:115], v[20:23], v[40:43], v[112:115]
    v_mfma_f32_16x16x32_bf16 v[144:147], v[24:27], v[40:43], v[144:147]
    v_mfma_f32_16x16x32_bf16 v[176:179], v[28:31], v[40:43], v[176:179]
    v_mfma_f32_16x16x32_bf16 v[208:211], v[32:35], v[40:43], v[208:211]
    v_mfma_f32_16x16x32_bf16 v[240:243], v[36:39], v[40:43], v[240:243]
    s_add_u32 m0, s98, 0
    s_nop 0
    buffer_load_dwordx4 v6, s[80:83], s88 offen lds
    s_add_u32 s88, s88, s93
    ds_read_b128 v[40:43], v8 offset:0
    s_waitcnt lgkmcnt(3)
    v_mfma_f32_16x16x32_bf16 v[84:87], v[16:19], v[44:47], v[84:87]
    v_mfma_f32_16x16x32_bf16 v[116:119], v[20:23], v[44:47], v[116:119]
    v_mfma_f32_16x16x32_bf16 v[148:151], v[24:27], v[44:47], v[148:151]
    v_mfma_f32_16x16x32_bf16 v[180:183], v[28:31], v[44:47], v[180:183]
    v_mfma_f32_16x16x32_bf16 v[212:215], v[32:35], v[44:47], v[212:215]
    v_mfma_f32_16x16x32_bf16 v[244:247], v[36:39], v[44:47], v[244:247]
    ds_read_b128 v[44:47], v8 offset:1024
    s_waitcnt lgkmcnt(3)
    v_mfma_f32_16x16x32_bf16 v[88:91], v[16:19], v[48:51], v[88:91]
    v_mfma_f32_16x16x32_bf16 v[120:123], v[20:23], v[48:51], v[120:123]
    v_mfma_f32_16x16x32_bf16 v[152:155], v[24:27], v[48:51], v[152:155]
    v_mfma_f32_16x16x32_bf16 v[184:187], v[28:31], v[48:51], v[184:187]
    v_mfma_f32_16x16x32_bf16 v[216:219], v[32:35], v[48:51], v[216:219]
    v_mfma_f32_16x16x32_bf16 v[248:251], v[36:39], v[48:51], v[248:251]
    ds_read_b128 v[48:51], v8 offset:2048
    s_waitcnt lgkmcnt(3)
    v_mfma_f32_16x16x32_bf16 v[92:95], v[16:19], v[10:13], v[92:95]
    ds_read_b64_tr_b16 v[16:17], v58 offset:0
    ds_read_b64_tr_b16 v[18:19], v58 offset:1152
    v_mfma_f32_16x16x32_bf16 v[124:127], v[20:23], v[10:13], v[124:127]
    ds_read_b64_tr_b16 v[20:21], v59 offset:0
    ds_read_b64_tr_b16 v[22:23], v59 offset:1152
    v_mfma_f32_16x16x32_bf16 v[156:159], v[24:27], v[10:13], v[156:159]
    ds_read_b64_tr_b16 v[24:25], v60 offset:0
    ds_read_b64_tr_b16 v[26:27], v60 offset:1152
    v_mfma_f32_16x16x32_bf16 v[188:191], v[28:31], v[10:13], v[188:191]
    ds_read_b64_tr_b16 v[28:29], v61 offset:0
    ds_read_b64_tr_b16 v[30:31], v61 offset:1152
    v_mfma_f32_16x16x32_bf16 v[220:223], v[32:35], v[10:13], v[220:223]
    ds_read_b64_tr_b16 v[32:33], v62 offset:0
    ds_read_b64_tr_b16 v[34:35], v62 offset:1152
    v_mfma_f32_16x16x32_bf16 v[252:255], v[36:39], v[10:13], v[252:255]
    ds_read_b64_tr_b16 v[36:37], v63 offset:0
    ds_read_b64_tr_b16 v[38:39], v63 offset:1152
    ds_read_b128 v[10:13], v8 offset:3072
    s_waitcnt vmcnt(5)
    s_barrier
    s_waitcnt lgkmcnt(11)
    v_mfma_f32_16x16x32_bf16 v[64:67], v[16:19], v[40:43], v[64:67]
    s_waitcnt lgkmcnt(9)
    v_mfma_f32_16x16x32_bf16 v[96:99], v[20:23], v[40:43], v[96:99]
    s_waitcnt lgkmcnt(7)
    v_mfma_f32_16x16x32_bf16 v[128:131], v[24:27], v[40:43], v[128:131]
    s_waitcnt lgkmcnt(5)
    v_mfma_f32_16x16x32_bf16 v[160:163], v[28:31], v[40:43], v[160:163]
    s_waitcnt lgkmcnt(3)
    v_mfma_f32_16x16x32_bf16 v[192:195], v[32:35], v[40:43], v[192:195]
    s_waitcnt lgkmcnt(1)
    v_mfma_f32_16x16x32_bf16 v[224:227], v[36:39], v[40:43], v[224:227]
    s_add_u32 m0, s94, 40960
    s_nop 0
    buffer_load_dwordx4 v2, s[64:67], s84 offen lds
    s_add_u32 s84, s84, s89
    ds_read_b128 v[40:43], v8 offset:4096
    v_mfma_f32_16x16x32_bf16 v[68:71], v[16:19], v[44:47], v[68:71]
    v_mfma_f32_16x16x32_bf16 v[100:103], v[20:23], v[44:47], v[100:103]
    v_mfma_f32_16x16x32_bf16 v[132:135], v[24:27], v[44:47], v[132:135]
    v_mfma_f32_16x16x32_bf16 v[164:167], v[28:31], v[44:47], v[164:167]
    v_mfma_f32_16x16x32_bf16 v[196:199], v[32:35], v[44:47], v[196:199]
    v_mfma_f32_16x16x32_bf16 v[228:231], v[36:39], v[44:47], v[228:231]
    s_add_u32 m0, s95, 40960
    s_nop 0
    buffer_load_dwordx4 v3, s[68:71], s85 offen lds
    s_add_u32 s85, s85, s90
    ds_read_b128 v[44:47], v8 offset:5120
    v_mfma_f32_16x16x32_bf16 v[72:75], v[16:19], v[48:51], v[72:75]
    v_mfma_f32_16x16x32_bf16 v[104:107], v[20:23], v[48:51], v[104:107]
    v_mfma_f32_16x16x32_bf16 v[136:139], v[24:27], v[48:51], v[136:139]
    v_mfma_f32_16x16x32_bf16 v[168:171], v[28:31], v[48:51], v[168:171]
    v_mfma_f32_16x16x32_bf16 v[200:203], v[32:35], v[48:51], v[200:203]
    v_mfma_f32_16x16x32_bf16 v[232:235], v[36:39], v[48:51], v[232:235]
    s_add_u32 m0, s96, 40960
    s_nop 0
    buffer_load_dwordx4 v4, s[72:75], s86 offen lds
    s_add_u32 s86, s86, s91
    ds_read_b128 v[48:51], v8 offset:6144
    s_waitcnt lgkmcnt(3)
    v_mfma_f32_16x16x32_bf16 v[76:79], v[16:19], v[10:13], v[76:79]
    v_mfma_f32_16x16x32_bf16 v[108:111], v[20:23], v[10:13], v[108:111]
    v_mfma_f32_16x16x32_bf16 v[140:143], v[24:27], v[10:13], v[140:143]
    v_mfma_f32_16x16x32_bf16 v[172:175], v[28:31], v[10:13], v[172:175]
    v_mfma_f32_16x16x32_bf16 v[204:207], v[32:35], v[10:13], v[204:207]
    v_mfma_f32_16x16x32_bf16 v[236:239], v[36:39], v[10:13], v[236:239]
    s_add_u32 m0, s97, 40960
    s_nop 0
    buffer_load_dwordx4 v5, s[76:79], s87 offen lds
    s_add_u32 s87, s87, s92
    ds_read_b128 v[10:13], v8 offset:7168
    s_waitcnt lgkmcnt(3)
    v_mfma_f32_16x16x32_bf16 v[80:83], v[16:19], v[40:43], v[80:83]
    v_mfma_f32_16x16x32_bf16 v[112:115], v[20:23], v[40:43], v[112:115]
    v_mfma_f32_16x16x32_bf16 v[144:147], v[24:27], v[40:43], v[144:147]
    v_mfma_f32_16x16x32_bf16 v[176:179], v[28:31], v[40:43], v[176:179]
    v_mfma_f32_16x16x32_bf16 v[208:211], v[32:35], v[40:43], v[208:211]
    v_mfma_f32_16x16x32_bf16 v[240:243], v[36:39], v[40:43], v[240:243]
    s_add_u32 m0, s98, 40960
    s_nop 0
    buffer_load_dwordx4 v6, s[80:83], s88 offen lds
    s_add_u32 s88, s88, s93
    ds_read_b128 v[40:43], v8 offset:40960
    s_waitcnt lgkmcnt(3)
    v_mfma_f32_16x16x32_bf16 v[84:87], v[16:19], v[44:47], v[84:87]
    v_mfma_f32_16x16x32_bf16 v[116:119], v[20:23], v[44:47], v[116:119]
    v_mfma_f32_16x16x32_bf16 v[148:151], v[24:27], v[44:47], v[148:151]
    v_mfma_f32_16x16x32_bf16 v[180:183], v[28:31], v[44:47], v[180:183]
    v_mfma_f32_16x16x32_bf16 v[212:215], v[32:35], v[44:47], v[212:215]
    v_mfma_f32_16x16x32_bf16 v[244:247], v[36:39], v[44:47], v[244:247]
    ds_read_b128 v[44:47], v8 offset:41984
    s_waitcnt lgkmcnt(3)
    v_mfma_f32_16x16x32_bf16 v[88:91], v[16:19], v[48:51], v[88:91]
    v_mfma_f32_16x16x32_bf16 v[120:123], v[20:23], v[48:51], v[120:123]
    v_mfma_f32_16x16x32_bf16 v[152:155], v[24:27], v[48:51], v[152:155]
    v_mfma_f32_16x16x32_bf16 v[184:187], v[28:31], v[48:51], v[184:187]
    v_mfma_f32_16x16x32_bf16 v[216:219], v[32:35], v[48:51], v[216:219]
    v_mfma_f32_16x16x32_bf16 v[248:251], v[36:39], v[48:51], v[248:251]
    ds_read_b128 v[48:51], v8 offset:43008
    s_waitcnt lgkmcnt(3)
    v_mfma_f32_16x16x32_bf16 v[92:95], v[16:19], v[10:13], v[92:95]
    ds_read_b64_tr_b16 v[16:17], v58 offset:40960
    ds_read_b64_tr_b16 v[18:19], v58 offset:42112
    v_mfma_f32_16x16x32_bf16 v[124:127], v[20:23], v[10:13], v[124:127]
    ds_read_b64_tr_b16 v[20:21], v59 offset:40960
    ds_read_b64_tr_b16 v[22:23], v59 offset:42112
    v_mfma_f32_16x16x32_bf16 v[156:159], v[24:27], v[10:13], v[156:159]
    ds_read_b64_tr_b16 v[24:25], v60 offset:40960
    ds_read_b64_tr_b16 v[26:27], v60 offset:42112
    v_mfma_f32_16x16x32_bf16 v[188:191], v[28:31], v[10:13], v[188:191]
    ds_read_b64_tr_b16 v[28:29], v61 offset:40960
    ds_read_b64_tr_b16 v[30:31], v61 offset:42112
    v_mfma_f32_16x16x32_bf16 v[220:223], v[32:35], v[10:13], v[220:223]
    ds_read_b64_tr_b16 v[32:33], v62 offset:40960
    ds_read_b64_tr_b16 v[34:35], v62 offset:42112
    v_mfma_f32_16x16x32_bf16 v[252:255], v[36:39], v[10:13], v[252:255]
    ds_read_b64_tr_b16 v[36:37], v63 offset:40960
    ds_read_b64_tr_b16 v[38:39], v63 offset:42112
    ds_read_b128 v[10:13], v8 offset:44032
    s_waitcnt vmcnt(5)
    s_barrier
    s_waitcnt lgkmcnt(11)
    v_mfma_f32_16x16x32_bf16 v[64:67], v[16:19], v[40:43], v[64:67]
    s_waitcnt lgkmcnt(9)
    v_mfma_f32_16x16x32_bf16 v[96:99], v[20:23], v[40:43], v[96:99]
    s_waitcnt lgkmcnt(7)
    v_mfma_f32_16x16x32_bf16 v[128:131], v[24:27], v[40:43], v[128:131]
    s_waitcnt lgkmcnt(5)
    v_mfma_f32_16x16x32_bf16 v[160:163], v[28:31], v[40:43], v[160:163]
    s_waitcnt lgkmcnt(3)
    v_mfma_f32_16x16x32_bf16 v[192:195], v[32:35], v[40:43], v[192:195]
    s_waitcnt lgkmcnt(1)
    v_mfma_f32_16x16x32_bf16 v[224:227], v[36:39], v[40:43], v[224:227]
    ds_read_b128 v[40:43], v8 offset:45056
    v_mfma_f32_16x16x32_bf16 v[68:71], v[16:19], v[44:47], v[68:71]
    v_mfma_f32_16x16x32_bf16 v[100:103], v[20:23], v[44:47], v[100:103]
    v_mfma_f32_16x16x32_bf16 v[132:135], v[24:27], v[44:47], v[132:135]
    v_mfma_f32_16x16x32_bf16 v[164:167], v[28:31], v[44:47], v[164:167]
    v_mfma_f32_16x16x32_bf16 v[196:199], v[32:35], v[44:47], v[196:199]
    v_mfma_f32_16x16x32_bf16 v[228:231], v[36:39], v[44:47], v[228:231]
    ds_read_b128 v[44:47], v8 offset:46080
    v_mfma_f32_16x16x32_bf16 v[72:75], v[16:19], v[48:51], v[72:75]
    v_mfma_f32_16x16x32_bf16 v[104:107], v[20:23], v[48:51], v[104:107]
    v_mfma_f32_16x16x32_bf16 v[136:139], v[24:27], v[48:51], v[136:139]
    v_mfma_f32_16x16x32_bf16 v[168:171], v[28:31], v[48:51], v[168:171]
    v_mfma_f32_16x16x32_bf16 v[200:203], v[32:35], v[48:51], v[200:203]
    v_mfma_f32_16x16x32_bf16 v[232:235], v[36:39], v[48:51], v[232:235]
    ds_read_b128 v[48:51], v8 offset:47104
    s_waitcnt lgkmcnt(3)
    v_mfma_f32_16x16x32_bf16 v[76:79], v[16:19], v[10:13], v[76:79]
    v_mfma_f32_16x16x32_bf16 v[108:111], v[20:23], v[10:13], v[108:111]
    v_mfma_f32_16x16x32_bf16 v[140:143], v[24:27], v[10:13], v[140:143]
    v_mfma_f32_16x16x32_bf16 v[172:175], v[28:31], v[10:13], v[172:175]
    v_mfma_f32_16x16x32_bf16 v[204:207], v[32:35], v[10:13], v[204:207]
    v_mfma_f32_16x16x32_bf16 v[236:239], v[36:39], v[10:13], v[236:239]
    ds_read_b128 v[10:13], v8 offset:48128
    s_waitcnt lgkmcnt(3)
    v_mfma_f32_16x16x32_bf16 v[80:83], v[16:19], v[40:43], v[80:83]
    v_mfma_f32_16x16x32_bf16 v[112:115], v[20:23], v[40:43], v[112:115]
    v_mfma_f32_16x16x32_bf16 v[144:147], v[24:27], v[40:43], v[144:147]
    v_mfma_f32_16x16x32_bf16 v[176:179], v[28:31], v[40:43], v[176:179]
    v_mfma_f32_16x16x32_bf16 v[208:211], v[32:35], v[40:43], v[208:211]
    v_mfma_f32_16x16x32_bf16 v[240:243], v[36:39], v[40:43], v[240:243]
    ds_read_b128 v[40:43], v7 offset:0
    s_waitcnt lgkmcnt(3)
    v_mfma_f32_16x16x32_bf16 v[84:87], v[16:19], v[44:47], v[84:87]
    v_mfma_f32_16x16x32_bf16 v[116:119], v[20:23], v[44:47], v[116:119]
    v_mfma_f32_16x16x32_bf16 v[148:151], v[24:27], v[44:47], v[148:151]
    v_mfma_f32_16x16x32_bf16 v[180:183], v[28:31], v[44:47], v[180:183]
    v_mfma_f32_16x16x32_bf16 v[212:215], v[32:35], v[44:47], v[212:215]
    v_mfma_f32_16x16x32_bf16 v[244:247], v[36:39], v[44:47], v[244:247]
    ds_read_b128 v[44:47], v7 offset:1024
    s_waitcnt lgkmcnt(3)
    v_mfma_f32_16x16x32_bf16 v[88:91], v[16:19], v[48:51], v[88:91]
    v_mfma_f32_16x16x32_bf16 v[120:123], v[20:23], v[48:51], v[120:123]
    v_mfma_f32_16x16x32_bf16 v[152:155], v[24:27], v[48:51], v[152:155]
    v_mfma_f32_16x16x32_bf16 v[184:187], v[28:31], v[48:51], v[184:187]
    v_mfma_f32_16x16x32_bf16 v[216:219], v[32:35], v[48:51], v[216:219]
    v_mfma_f32_16x16x32_bf16 v[248:251], v[36:39], v[48:51], v[248:251]
    ds_read_b128 v[48:51], v7 offset:2048
    s_waitcnt lgkmcnt(3)
    v_mfma_f32_16x16x32_bf16 v[92:95], v[16:19], v[10:13], v[92:95]
    ds_read_b64_tr_b16 v[16:17], v52 offset:0
    ds_read_b64_tr_b16 v[18:19], v52 offset:1152
    v_mfma_f32_16x16x32_bf16 v[124:127], v[20:23], v[10:13], v[124:127]
    ds_read_b64_tr_b16 v[20:21], v53 offset:0
    ds_read_b64_tr_b16 v[22:23], v53 offset:1152
    v_mfma_f32_16x16x32_bf16 v[156:159], v[24:27], v[10:13], v[156:159]
    ds_read_b64_tr_b16 v[24:25], v54 offset:0
    ds_read_b64_tr_b16 v[26:27], v54 offset:1152
    v_mfma_f32_16x16x32_bf16 v[188:191], v[28:31], v[10:13], v[188:191]
    ds_read_b64_tr_b16 v[28:29], v55 offset:0
    ds_read_b64_tr_b16 v[30:31], v55 offset:1152
    v_mfma_f32_16x16x32_bf16 v[220:223], v[32:35], v[10:13], v[220:223]
    ds_read_b64_tr_b16 v[32:33], v56 offset:0
    ds_read_b64_tr_b16 v[34:35], v56 offset:1152
    v_mfma_f32_16x16x32_bf16 v[252:255], v[36:39], v[10:13], v[252:255]
    ds_read_b64_tr_b16 v[36:37], v57 offset:0
    ds_read_b64_tr_b16 v[38:39], v57 offset:1152
    ds_read_b128 v[10:13], v7 offset:3072
    s_waitcnt vmcnt(0)
    s_barrier
    s_waitcnt lgkmcnt(11)
    v_mfma_f32_16x16x32_bf16 v[64:67], v[16:19], v[40:43], v[64:67]
    s_waitcnt lgkmcnt(9)
    v_mfma_f32_16x16x32_bf16 v[96:99], v[20:23], v[40:43], v[96:99]
    s_waitcnt lgkmcnt(7)
    v_mfma_f32_16x16x32_bf16 v[128:131], v[24:27], v[40:43], v[128:131]
    s_waitcnt lgkmcnt(5)
    v_mfma_f32_16x16x32_bf16 v[160:163], v[28:31], v[40:43], v[160:163]
    s_waitcnt lgkmcnt(3)
    v_mfma_f32_16x16x32_bf16 v[192:195], v[32:35], v[40:43], v[192:195]
    s_waitcnt lgkmcnt(1)
    v_mfma_f32_16x16x32_bf16 v[224:227], v[36:39], v[40:43], v[224:227]
    ds_read_b128 v[40:43], v7 offset:4096
    v_mfma_f32_16x16x32_bf16 v[68:71], v[16:19], v[44:47], v[68:71]
    v_mfma_f32_16x16x32_bf16 v[100:103], v[20:23], v[44:47], v[100:103]
    v_mfma_f32_16x16x32_bf16 v[132:135], v[24:27], v[44:47], v[132:135]
    v_mfma_f32_16x16x32_bf16 v[164:167], v[28:31], v[44:47], v[164:167]
    v_mfma_f32_16x16x32_bf16 v[196:199], v[32:35], v[44:47], v[196:199]
    v_mfma_f32_16x16x32_bf16 v[228:231], v[36:39], v[44:47], v[228:231]
    ds_read_b128 v[44:47], v7 offset:5120
    v_mfma_f32_16x16x32_bf16 v[72:75], v[16:19], v[48:51], v[72:75]
    v_mfma_f32_16x16x32_bf16 v[104:107], v[20:23], v[48:51], v[104:107]
    v_mfma_f32_16x16x32_bf16 v[136:139], v[24:27], v[48:51], v[136:139]
    v_mfma_f32_16x16x32_bf16 v[168:171], v[28:31], v[48:51], v[168:171]
    v_mfma_f32_16x16x32_bf16 v[200:203], v[32:35], v[48:51], v[200:203]
    v_mfma_f32_16x16x32_bf16 v[232:235], v[36:39], v[48:51], v[232:235]
    ds_read_b128 v[48:51], v7 offset:6144
    s_waitcnt lgkmcnt(3)
    v_mfma_f32_16x16x32_bf16 v[76:79], v[16:19], v[10:13], v[76:79]
    v_mfma_f32_16x16x32_bf16 v[108:111], v[20:23], v[10:13], v[108:111]
    v_mfma_f32_16x16x32_bf16 v[140:143], v[24:27], v[10:13], v[140:143]
    v_mfma_f32_16x16x32_bf16 v[172:175], v[28:31], v[10:13], v[172:175]
    v_mfma_f32_16x16x32_bf16 v[204:207], v[32:35], v[10:13], v[204:207]
    v_mfma_f32_16x16x32_bf16 v[236:239], v[36:39], v[10:13], v[236:239]
    ds_read_b128 v[10:13], v7 offset:7168
    s_waitcnt lgkmcnt(3)
    v_mfma_f32_16x16x32_bf16 v[80:83], v[16:19], v[40:43], v[80:83]
    v_mfma_f32_16x16x32_bf16 v[112:115], v[20:23], v[40:43], v[112:115]
    v_mfma_f32_16x16x32_bf16 v[144:147], v[24:27], v[40:43], v[144:147]
    v_mfma_f32_16x16x32_bf16 v[176:179], v[28:31], v[40:43], v[176:179]
    v_mfma_f32_16x16x32_bf16 v[208:211], v[32:35], v[40:43], v[208:211]
    v_mfma_f32_16x16x32_bf16 v[240:243], v[36:39], v[40:43], v[240:243]
    ds_read_b128 v[40:43], v7 offset:40960
    s_waitcnt lgkmcnt(3)
    v_mfma_f32_16x16x32_bf16 v[84:87], v[16:19], v[44:47], v[84:87]
    v_mfma_f32_16x16x32_bf16 v[116:119], v[20:23], v[44:47], v[116:119]
    v_mfma_f32_16x16x32_bf16 v[148:151], v[24:27], v[44:47], v[148:151]
    v_mfma_f32_16x16x32_bf16 v[180:183], v[28:31], v[44:47], v[180:183]
    v_mfma_f32_16x16x32_bf16 v[212:215], v[32:35], v[44:47], v[212:215]
    v_mfma_f32_16x16x32_bf16 v[244:247], v[36:39], v[44:47], v[244:247]
    ds_read_b128 v[44:47], v7 offset:41984
    s_waitcnt lgkmcnt(3)
    v_mfma_f32_16x16x32_bf16 v[88:91], v[16:19], v[48:51], v[88:91]
    v_mfma_f32_16x16x32_bf16 v[120:123], v[20:23], v[48:51], v[120:123]
    v_mfma_f32_16x16x32_bf16 v[152:155], v[24:27], v[48:51], v[152:155]
    v_mfma_f32_16x16x32_bf16 v[184:187], v[28:31], v[48:51], v[184:187]
    v_mfma_f32_16x16x32_bf16 v[216:219], v[32:35], v[48:51], v[216:219]
    v_mfma_f32_16x16x32_bf16 v[248:251], v[36:39], v[48:51], v[248:251]
    ds_read_b128 v[48:51], v7 offset:43008
    s_waitcnt lgkmcnt(3)
    v_mfma_f32_16x16x32_bf16 v[92:95], v[16:19], v[10:13], v[92:95]
    ds_read_b64_tr_b16 v[16:17], v52 offset:40960
    ds_read_b64_tr_b16 v[18:19], v52 offset:42112
    v_mfma_f32_16x16x32_bf16 v[124:127], v[20:23], v[10:13], v[124:127]
    ds_read_b64_tr_b16 v[20:21], v53 offset:40960
    ds_read_b64_tr_b16 v[22:23], v53 offset:42112
    v_mfma_f32_16x16x32_bf16 v[156:159], v[24:27], v[10:13], v[156:159]
    ds_read_b64_tr_b16 v[24:25], v54 offset:40960
    ds_read_b64_tr_b16 v[26:27], v54 offset:42112
    v_mfma_f32_16x16x32_bf16 v[188:191], v[28:31], v[10:13], v[188:191]
    ds_read_b64_tr_b16 v[28:29], v55 offset:40960
    ds_read_b64_tr_b16 v[30:31], v55 offset:42112
    v_mfma_f32_16x16x32_bf16 v[220:223], v[32:35], v[10:13], v[220:223]
    ds_read_b64_tr_b16 v[32:33], v56 offset:40960
    ds_read_b64_tr_b16 v[34:35], v56 offset:42112
    v_mfma_f32_16x16x32_bf16 v[252:255], v[36:39], v[10:13], v[252:255]
    ds_read_b64_tr_b16 v[36:37], v57 offset:40960
    ds_read_b64_tr_b16 v[38:39], v57 offset:42112
    ds_read_b128 v[10:13], v7 offset:44032
    s_waitcnt lgkmcnt(11)
    v_mfma_f32_16x16x32_bf16 v[64:67], v[16:19], v[40:43], v[64:67]
    s_waitcnt lgkmcnt(9)
    v_mfma_f32_16x16x32_bf16 v[96:99], v[20:23], v[40:43], v[96:99]
    s_waitcnt lgkmcnt(7)
    v_mfma_f32_16x16x32_bf16 v[128:131], v[24:27], v[40:43], v[128:131]
    s_waitcnt lgkmcnt(5)
    v_mfma_f32_16x16x32_bf16 v[160:163], v[28:31], v[40:43], v[160:163]
    s_waitcnt lgkmcnt(3)
    v_mfma_f32_16x16x32_bf16 v[192:195], v[32:35], v[40:43], v[192:195]
    s_waitcnt lgkmcnt(1)
    v_mfma_f32_16x16x32_bf16 v[224:227], v[36:39], v[40:43], v[224:227]
    ds_read_b128 v[40:43], v7 offset:45056
    v_mfma_f32_16x16x32_bf16 v[68:71], v[16:19], v[44:47], v[68:71]
    v_mfma_f32_16x16x32_bf16 v[100:103], v[20:23], v[44:47], v[100:103]
    v_mfma_f32_16x16x32_bf16 v[132:135], v[24:27], v[44:47], v[132:135]
    v_mfma_f32_16x16x32_bf16 v[164:167], v[28:31], v[44:47], v[164:167]
    v_mfma_f32_16x16x32_bf16 v[196:199], v[32:35], v[44:47], v[196:199]
    v_mfma_f32_16x16x32_bf16 v[228:231], v[36:39], v[44:47], v[228:231]
    ds_read_b128 v[44:47], v7 offset:46080
    v_mfma_f32_16x16x32_bf16 v[72:75], v[16:19], v[48:51], v[72:75]
    v_mfma_f32_16x16x32_bf16 v[104:107], v[20:23], v[48:51], v[104:107]
    v_mfma_f32_16x16x32_bf16 v[136:139], v[24:27], v[48:51], v[136:139]
    v_mfma_f32_16x16x32_bf16 v[168:171], v[28:31], v[48:51], v[168:171]
    v_mfma_f32_16x16x32_bf16 v[200:203], v[32:35], v[48:51], v[200:203]
    v_mfma_f32_16x16x32_bf16 v[232:235], v[36:39], v[48:51], v[232:235]
    ds_read_b128 v[48:51], v7 offset:47104
    s_waitcnt lgkmcnt(3)
    v_mfma_f32_16x16x32_bf16 v[76:79], v[16:19], v[10:13], v[76:79]
    v_mfma_f32_16x16x32_bf16 v[108:111], v[20:23], v[10:13], v[108:111]
    v_mfma_f32_16x16x32_bf16 v[140:143], v[24:27], v[10:13], v[140:143]
    v_mfma_f32_16x16x32_bf16 v[172:175], v[28:31], v[10:13], v[172:175]
    v_mfma_f32_16x16x32_bf16 v[204:207], v[32:35], v[10:13], v[204:207]
    v_mfma_f32_16x16x32_bf16 v[236:239], v[36:39], v[10:13], v[236:239]
    ds_read_b128 v[10:13], v7 offset:48128
    s_waitcnt lgkmcnt(3)
    v_mfma_f32_16x16x32_bf16 v[80:83], v[16:19], v[40:43], v[80:83]
    v_mfma_f32_16x16x32_bf16 v[112:115], v[20:23], v[40:43], v[112:115]
    v_mfma_f32_16x16x32_bf16 v[144:147], v[24:27], v[40:43], v[144:147]
    v_mfma_f32_16x16x32_bf16 v[176:179], v[28:31], v[40:43], v[176:179]
    v_mfma_f32_16x16x32_bf16 v[208:211], v[32:35], v[40:43], v[208:211]
    v_mfma_f32_16x16x32_bf16 v[240:243], v[36:39], v[40:43], v[240:243]
    s_waitcnt lgkmcnt(2)
    v_mfma_f32_16x16x32_bf16 v[84:87], v[16:19], v[44:47], v[84:87]
    v_mfma_f32_16x16x32_bf16 v[116:119], v[20:23], v[44:47], v[116:119]
    v_mfma_f32_16x16x32_bf16 v[148:151], v[24:27], v[44:47], v[148:151]
    v_mfma_f32_16x16x32_bf16 v[180:183], v[28:31], v[44:47], v[180:183]
    v_mfma_f32_16x16x32_bf16 v[212:215], v[32:35], v[44:47], v[212:215]
    v_mfma_f32_16x16x32_bf16 v[244:247], v[36:39], v[44:47], v[244:247]
    s_waitcnt lgkmcnt(1)
    v_mfma_f32_16x16x32_bf16 v[88:91], v[16:19], v[48:51], v[88:91]
    v_mfma_f32_16x16x32_bf16 v[120:123], v[20:23], v[48:51], v[120:123]
    v_mfma_f32_16x16x32_bf16 v[152:155], v[24:27], v[48:51], v[152:155]
    v_mfma_f32_16x16x32_bf16 v[184:187], v[28:31], v[48:51], v[184:187]
    v_mfma_f32_16x16x32_bf16 v[216:219], v[32:35], v[48:51], v[216:219]
    v_mfma_f32_16x16x32_bf16 v[248:251], v[36:39], v[48:51], v[248:251]
    s_waitcnt lgkmcnt(0)
    v_mfma_f32_16x16x32_bf16 v[92:95], v[16:19], v[10:13], v[92:95]
    v_mfma_f32_16x16x32_bf16 v[124:127], v[20:23], v[10:13], v[124:127]
    v_mfma_f32_16x16x32_bf16 v[156:159], v[24:27], v[10:13], v[156:159]
    v_mfma_f32_16x16x32_bf16 v[188:191], v[28:31], v[10:13], v[188:191]
    v_mfma_f32_16x16x32_bf16 v[220:223], v[32:35], v[10:13], v[220:223]
    v_mfma_f32_16x16x32_bf16 v[252:255], v[36:39], v[10:13], v[252:255]
    s_nop 7
    s_nop 1
    s_barrier
    v_and_b32 v1, 15, v0
    s_lshl_b32 s47, s49, 7
    v_add_u32 v1, s47, v1
    v_mul_u32_u24 v1, 304, v1
    v_lshrrev_b32 v2, 4, v0
    v_lshl_add_u32 v1, v2, 3, v1
    s_mul_i32 s56, s50, 96
    v_add_u32 v1, s56, v1
    s_mov_b32 s57, 0xffff0000
    v_cvt_pk_bf16_f32 v16, v64, v65
    v_cvt_pk_bf16_f32 v17, v66, v67
    v_cvt_pk_bf16_f32 v18, v160, v161
    v_cvt_pk_bf16_f32 v19, v162, v163
    v_lshlrev_b32 v20, 16, v16
    v_and_b32 v21, s57, v16
    v_lshlrev_b32 v22, 16, v17
    v_and_b32 v23, s57, v17
    v_lshlrev_b32 v24, 16, v18
    v_and_b32 v25, s57, v18
    v_lshlrev_b32 v26, 16, v19
    v_and_b32 v27, s57, v19
    v_mul_f32 v20, v20, v24
    v_mul_f32 v21, v21, v25
    v_mul_f32 v22, v22, v26
    v_mul_f32 v23, v23, v27
    v_cvt_pk_bf16_f32 v28, v20, v21
    v_cvt_pk_bf16_f32 v29, v22, v23
    ds_write_b64 v1, v[28:29] offset:0
    v_cvt_pk_bf16_f32 v32, v96, v97
    v_cvt_pk_bf16_f32 v33, v98, v99
    v_cvt_pk_bf16_f32 v34, v192, v193
    v_cvt_pk_bf16_f32 v35, v194, v195
    v_lshlrev_b32 v36, 16, v32
    v_and_b32 v37, s57, v32
    v_lshlrev_b32 v38, 16, v33
    v_and_b32 v39, s57, v33
    v_lshlrev_b32 v40, 16, v34
    v_and_b32 v41, s57, v34
    v_lshlrev_b32 v42, 16, v35
    v_and_b32 v43, s57, v35
    v_mul_f32 v36, v36, v40
    v_mul_f32 v37, v37, v41
    v_mul_f32 v38, v38, v42
    v_mul_f32 v39, v39, v43
    v_cvt_pk_bf16_f32 v44, v36, v37
    v_cvt_pk_bf16_f32 v45, v38, v39
    ds_write_b64 v1, v[44:45] offset:32
    v_cvt_pk_bf16_f32 v16, v128, v129
    v_cvt_pk_bf16_f32 v17, v130, v131
    v_cvt_pk_bf16_f32 v18, v224, v225
    v_cvt_pk_bf16_f32 v19, v226, v227
    v_lshlrev_b32 v20, 16, v16
    v_and_b32 v21, s57, v16
    v_lshlrev_b32 v22, 16, v17
    v_and_b32 v23, s57, v17
    v_lshlrev_b32 v24, 16, v18
    v_and_b32 v25, s57, v18
    v_lshlrev_b32 v26, 16, v19
    v_and_b32 v27, s57, v19
    v_mul_f32 v20, v20, v24
    v_mul_f32 v21, v21, v25
    v_mul_f32 v22, v22, v26
    v_mul_f32 v23, v23, v27
    v_cvt_pk_bf16_f32 v28, v20, v21
    v_cvt_pk_bf16_f32 v29, v22, v23
    ds_write_b64 v1, v[28:29] offset:64
    v_cvt_pk_bf16_f32 v16, v68, v69
    v_cvt_pk_bf16_f32 v17, v70, v71
    v_cvt_pk_bf16_f32 v18, v164, v165
    v_cvt_pk_bf16_f32 v19, v166, v167
    v_lshlrev_b32 v20, 16, v16
    v_and_b32 v21, s57, v16
    v_lshlrev_b32 v22, 16, v17
    v_and_b32 v23, s57, v17
    v_lshlrev_b32 v24, 16, v18
    v_and_b32 v25, s57, v18
    v_lshlrev_b32 v26, 16, v19
    v_and_b32 v27, s57, v19
    v_mul_f32 v20, v20, v24
    v_mul_f32 v21, v21, v25
    v_mul_f32 v22, v22, v26
    v_mul_f32 v23, v23, v27
    v_cvt_pk_bf16_f32 v28, v20, v21
    v_cvt_pk_bf16_f32 v29, v22, v23
    ds_write_b64 v1, v[28:29] offset:4864
    v_cvt_pk_bf16_f32 v32, v100, v101
    v_cvt_pk_bf16_f32 v33, v102, v103
    v_cvt_pk_bf16_f32 v34, v196, v197
    v_cvt_pk_bf16_f32 v35, v198, v199
    v_lshlrev_b32 v36, 16, v32
    v_and_b32 v37, s57, v32
    v_lshlrev_b32 v38, 16, v33
    v_and_b32 v39, s57, v33
    v_lshlrev_b32 v40, 16, v34
    v_and_b32 v41, s57, v34
    v_lshlrev_b32 v42, 16, v35
    v_and_b32 v43, s57, v35
    v_mul_f32 v36, v36, v40
    v_mul_f32 v37, v37, v41
    v_mul_f32 v38, v38, v42
    v_mul_f32 v39, v39, v43
    v_cvt_pk_bf16_f32 v44, v36, v37
    v_cvt_pk_bf16_f32 v45, v38, v39
    ds_write_b64 v1, v[44:45] offset:4896
    v_cvt_pk_bf16_f32 v16, v132, v133
    v_cvt_pk_bf16_f32 v17, v134, v135
    v_cvt_pk_bf16_f32 v18, v228, v229
    v_cvt_pk_bf16_f32 v19, v230, v231
    v_lshlrev_b32 v20, 16, v16
    v_and_b32 v21, s57, v16
    v_lshlrev_b32 v22, 16, v17
    v_and_b32 v23, s57, v17
    v_lshlrev_b32 v24, 16, v18
    v_and_b32 v25, s57, v18
    v_lshlrev_b32 v26, 16, v19
    v_and_b32 v27, s57, v19
    v_mul_f32 v20, v20, v24
    v_mul_f32 v21, v21, v25
    v_mul_f32 v22, v22, v26
    v_mul_f32 v23, v23, v27
    v_cvt_pk_bf16_f32 v28, v20, v21
    v_cvt_pk_bf16_f32 v29, v22, v23
    ds_write_b64 v1, v[28:29] offset:4928
    v_cvt_pk_bf16_f32 v16, v72, v73
    v_cvt_pk_bf16_f32 v17, v74, v75
    v_cvt_pk_bf16_f32 v18, v168, v169
    v_cvt_pk_bf16_f32 v19, v170, v171
    v_lshlrev_b32 v20, 16, v16
    v_and_b32 v21, s57, v16
    v_lshlrev_b32 v22, 16, v17
    v_and_b32 v23, s57, v17
    v_lshlrev_b32 v24, 16, v18
    v_and_b32 v25, s57, v18
    v_lshlrev_b32 v26, 16, v19
    v_and_b32 v27, s57, v19
    v_mul_f32 v20, v20, v24
    v_mul_f32 v21, v21, v25
    v_mul_f32 v22, v22, v26
    v_mul_f32 v23, v23, v27
    v_cvt_pk_bf16_f32 v28, v20, v21
    v_cvt_pk_bf16_f32 v29, v22, v23
    ds_write_b64 v1, v[28:29] offset:9728
    v_cvt_pk_bf16_f32 v32, v104, v105
    v_cvt_pk_bf16_f32 v33, v106, v107
    v_cvt_pk_bf16_f32 v34, v200, v201
    v_cvt_pk_bf16_f32 v35, v202, v203
    v_lshlrev_b32 v36, 16, v32
    v_and_b32 v37, s57, v32
    v_lshlrev_b32 v38, 16, v33
    v_and_b32 v39, s57, v33
    v_lshlrev_b32 v40, 16, v34
    v_and_b32 v41, s57, v34
    v_lshlrev_b32 v42, 16, v35
    v_and_b32 v43, s57, v35
    v_mul_f32 v36, v36, v40
    v_mul_f32 v37, v37, v41
    v_mul_f32 v38, v38, v42
    v_mul_f32 v39, v39, v43
    v_cvt_pk_bf16_f32 v44, v36, v37
    v_cvt_pk_bf16_f32 v45, v38, v39
    ds_write_b64 v1, v[44:45] offset:9760
    v_cvt_pk_bf16_f32 v16, v136, v137
    v_cvt_pk_bf16_f32 v17, v138, v139
    v_cvt_pk_bf16_f32 v18, v232, v233
    v_cvt_pk_bf16_f32 v19, v234, v235
    v_lshlrev_b32 v20, 16, v16
    v_and_b32 v21, s57, v16
    v_lshlrev_b32 v22, 16, v17
    v_and_b32 v23, s57, v17
    v_lshlrev_b32 v24, 16, v18
    v_and_b32 v25, s57, v18
    v_lshlrev_b32 v26, 16, v19
    v_and_b32 v27, s57, v19
    v_mul_f32 v20, v20, v24
    v_mul_f32 v21, v21, v25
    v_mul_f32 v22, v22, v26
    v_mul_f32 v23, v23, v27
    v_cvt_pk_bf16_f32 v28, v20, v21
    v_cvt_pk_bf16_f32 v29, v22, v23
    ds_write_b64 v1, v[28:29] offset:9792
    v_cvt_pk_bf16_f32 v16, v76, v77
    v_cvt_pk_bf16_f32 v17, v78, v79
    v_cvt_pk_bf16_f32 v18, v172, v173
    v_cvt_pk_bf16_f32 v19, v174, v175
    v_lshlrev_b32 v20, 16, v16
    v_and_b32 v21, s57, v16
    v_lshlrev_b32 v22, 16, v17
    v_and_b32 v23, s57, v17
    v_lshlrev_b32 v24, 16, v18
    v_and_b32 v25, s57, v18
    v_lshlrev_b32 v26, 16, v19
    v_and_b32 v27, s57, v19
    v_mul_f32 v20, v20, v24
    v_mul_f32 v21, v21, v25
    v_mul_f32 v22, v22, v26
    v_mul_f32 v23, v23, v27
    v_cvt_pk_bf16_f32 v28, v20, v21
    v_cvt_pk_bf16_f32 v29, v22, v23
    ds_write_b64 v1, v[28:29] offset:14592
    v_cvt_pk_bf16_f32 v32, v108, v109
    v_cvt_pk_bf16_f32 v33, v110, v111
    v_cvt_pk_bf16_f32 v34, v204, v205
    v_cvt_pk_bf16_f32 v35, v206, v207
    v_lshlrev_b32 v36, 16, v32
    v_and_b32 v37, s57, v32
    v_lshlrev_b32 v38, 16, v33
    v_and_b32 v39, s57, v33
    v_lshlrev_b32 v40, 16, v34
    v_and_b32 v41, s57, v34
    v_lshlrev_b32 v42, 16, v35
    v_and_b32 v43, s57, v35
    v_mul_f32 v36, v36, v40
    v_mul_f32 v37, v37, v41
    v_mul_f32 v38, v38, v42
    v_mul_f32 v39, v39, v43
    v_cvt_pk_bf16_f32 v44, v36, v37
    v_cvt_pk_bf16_f32 v45, v38, v39
    ds_write_b64 v1, v[44:45] offset:14624
    v_cvt_pk_bf16_f32 v16, v140, v141
    v_cvt_pk_bf16_f32 v17, v142, v143
    v_cvt_pk_bf16_f32 v18, v236, v237
    v_cvt_pk_bf16_f32 v19, v238, v239
    v_lshlrev_b32 v20, 16, v16
    v_and_b32 v21, s57, v16
    v_lshlrev_b32 v22, 16, v17
    v_and_b32 v23, s57, v17
    v_lshlrev_b32 v24, 16, v18
    v_and_b32 v25, s57, v18
    v_lshlrev_b32 v26, 16, v19
    v_and_b32 v27, s57, v19
    v_mul_f32 v20, v20, v24
    v_mul_f32 v21, v21, v25
    v_mul_f32 v22, v22, v26
    v_mul_f32 v23, v23, v27
    v_cvt_pk_bf16_f32 v28, v20, v21
    v_cvt_pk_bf16_f32 v29, v22, v23
    ds_write_b64 v1, v[28:29] offset:14656
    v_cvt_pk_bf16_f32 v16, v80, v81
    v_cvt_pk_bf16_f32 v17, v82, v83
    v_cvt_pk_bf16_f32 v18, v176, v177
    v_cvt_pk_bf16_f32 v19, v178, v179
    v_lshlrev_b32 v20, 16, v16
    v_and_b32 v21, s57, v16
    v_lshlrev_b32 v22, 16, v17
    v_and_b32 v23, s57, v17
    v_lshlrev_b32 v24, 16, v18
    v_and_b32 v25, s57, v18
    v_lshlrev_b32 v26, 16, v19
    v_and_b32 v27, s57, v19
    v_mul_f32 v20, v20, v24
    v_mul_f32 v21, v21, v25
    v_mul_f32 v22, v22, v26
    v_mul_f32 v23, v23, v27
    v_cvt_pk_bf16_f32 v28, v20, v21
    v_cvt_pk_bf16_f32 v29, v22, v23
    ds_write_b64 v1, v[28:29] offset:19456
    v_cvt_pk_bf16_f32 v32, v112, v113
    v_cvt_pk_bf16_f32 v33, v114, v115
    v_cvt_pk_bf16_f32 v34, v208, v209
    v_cvt_pk_bf16_f32 v35, v210, v211
    v_lshlrev_b32 v36, 16, v32
    v_and_b32 v37, s57, v32
    v_lshlrev_b32 v38, 16, v33
    v_and_b32 v39, s57, v33
    v_lshlrev_b32 v40, 16, v34
    v_and_b32 v41, s57, v34
    v_lshlrev_b32 v42, 16, v35
    v_and_b32 v43, s57, v35
    v_mul_f32 v36, v36, v40
    v_mul_f32 v37, v37, v41
    v_mul_f32 v38, v38, v42
    v_mul_f32 v39, v39, v43
    v_cvt_pk_bf16_f32 v44, v36, v37
    v_cvt_pk_bf16_f32 v45, v38, v39
    ds_write_b64 v1, v[44:45] offset:19488
    v_cvt_pk_bf16_f32 v16, v144, v145
    v_cvt_pk_bf16_f32 v17, v146, v147
    v_cvt_pk_bf16_f32 v18, v240, v241
    v_cvt_pk_bf16_f32 v19, v242, v243
    v_lshlrev_b32 v20, 16, v16
    v_and_b32 v21, s57, v16
    v_lshlrev_b32 v22, 16, v17
    v_and_b32 v23, s57, v17
    v_lshlrev_b32 v24, 16, v18
    v_and_b32 v25, s57, v18
    v_lshlrev_b32 v26, 16, v19
    v_and_b32 v27, s57, v19
    v_mul_f32 v20, v20, v24
    v_mul_f32 v21, v21, v25
    v_mul_f32 v22, v22, v26
    v_mul_f32 v23, v23, v27
    v_cvt_pk_bf16_f32 v28, v20, v21
    v_cvt_pk_bf16_f32 v29, v22, v23
    ds_write_b64 v1, v[28:29] offset:19520
    v_cvt_pk_bf16_f32 v16, v84, v85
    v_cvt_pk_bf16_f32 v17, v86, v87
    v_cvt_pk_bf16_f32 v18, v180, v181
    v_cvt_pk_bf16_f32 v19, v182, v183
    v_lshlrev_b32 v20, 16, v16
    v_and_b32 v21, s57, v16
    v_lshlrev_b32 v22, 16, v17
    v_and_b32 v23, s57, v17
    v_lshlrev_b32 v24, 16, v18
    v_and_b32 v25, s57, v18
    v_lshlrev_b32 v26, 16, v19
    v_and_b32 v27, s57, v19
    v_mul_f32 v20, v20, v24
    v_mul_f32 v21, v21, v25
    v_mul_f32 v22, v22, v26
    v_mul_f32 v23, v23, v27
    v_cvt_pk_bf16_f32 v28, v20, v21
    v_cvt_pk_bf16_f32 v29, v22, v23
    ds_write_b64 v1, v[28:29] offset:24320
    v_cvt_pk_bf16_f32 v32, v116, v117
    v_cvt_pk_bf16_f32 v33, v118, v119
    v_cvt_pk_bf16_f32 v34, v212, v213
    v_cvt_pk_bf16_f32 v35, v214, v215
    v_lshlrev_b32 v36, 16, v32
    v_and_b32 v37, s57, v32
    v_lshlrev_b32 v38, 16, v33
    v_and_b32 v39, s57, v33
    v_lshlrev_b32 v40, 16, v34
    v_and_b32 v41, s57, v34
    v_lshlrev_b32 v42, 16, v35
    v_and_b32 v43, s57, v35
    v_mul_f32 v36, v36, v40
    v_mul_f32 v37, v37, v41
    v_mul_f32 v38, v38, v42
    v_mul_f32 v39, v39, v43
    v_cvt_pk_bf16_f32 v44, v36, v37
    v_cvt_pk_bf16_f32 v45, v38, v39
    ds_write_b64 v1, v[44:45] offset:24352
    v_cvt_pk_bf16_f32 v16, v148, v149
    v_cvt_pk_bf16_f32 v17, v150, v151
    v_cvt_pk_bf16_f32 v18, v244, v245
    v_cvt_pk_bf16_f32 v19, v246, v247
    v_lshlrev_b32 v20, 16, v16
    v_and_b32 v21, s57, v16
    v_lshlrev_b32 v22, 16, v17
    v_and_b32 v23, s57, v17
    v_lshlrev_b32 v24, 16, v18
    v_and_b32 v25, s57, v18
    v_lshlrev_b32 v26, 16, v19
    v_and_b32 v27, s57, v19
    v_mul_f32 v20, v20, v24
    v_mul_f32 v21, v21, v25
    v_mul_f32 v22, v22, v26
    v_mul_f32 v23, v23, v27
    v_cvt_pk_bf16_f32 v28, v20, v21
    v_cvt_pk_bf16_f32 v29, v22, v23
    ds_write_b64 v1, v[28:29] offset:24384
    v_cvt_pk_bf16_f32 v16, v88, v89
    v_cvt_pk_bf16_f32 v17, v90, v91
    v_cvt_pk_bf16_f32 v18, v184, v185
    v_cvt_pk_bf16_f32 v19, v186, v187
    v_lshlrev_b32 v20, 16, v16
    v_and_b32 v21, s57, v16
    v_lshlrev_b32 v22, 16, v17
    v_and_b32 v23, s57, v17
    v_lshlrev_b32 v24, 16, v18
    v_and_b32 v25, s57, v18
    v_lshlrev_b32 v26, 16, v19
    v_and_b32 v27, s57, v19
    v_mul_f32 v20, v20, v24
    v_mul_f32 v21, v21, v25
    v_mul_f32 v22, v22, v26
    v_mul_f32 v23, v23, v27
    v_cvt_pk_bf16_f32 v28, v20, v21
    v_cvt_pk_bf16_f32 v29, v22, v23
    ds_write_b64 v1, v[28:29] offset:29184
    v_cvt_pk_bf16_f32 v32, v120, v121
    v_cvt_pk_bf16_f32 v33, v122, v123
    v_cvt_pk_bf16_f32 v34, v216, v217
    v_cvt_pk_bf16_f32 v35, v218, v219
    v_lshlrev_b32 v36, 16, v32
    v_and_b32 v37, s57, v32
    v_lshlrev_b32 v38, 16, v33
    v_and_b32 v39, s57, v33
    v_lshlrev_b32 v40, 16, v34
    v_and_b32 v41, s57, v34
    v_lshlrev_b32 v42, 16, v35
    v_and_b32 v43, s57, v35
    v_mul_f32 v36, v36, v40
    v_mul_f32 v37, v37, v41
    v_mul_f32 v38, v38, v42
    v_mul_f32 v39, v39, v43
    v_cvt_pk_bf16_f32 v44, v36, v37
    v_cvt_pk_bf16_f32 v45, v38, v39
    ds_write_b64 v1, v[44:45] offset:29216
    v_cvt_pk_bf16_f32 v16, v152, v153
    v_cvt_pk_bf16_f32 v17, v154, v155
    v_cvt_pk_bf16_f32 v18, v248, v249
    v_cvt_pk_bf16_f32 v19, v250, v251
    v_lshlrev_b32 v20, 16, v16
    v_and_b32 v21, s57, v16
    v_lshlrev_b32 v22, 16, v17
    v_and_b32 v23, s57, v17
    v_lshlrev_b32 v24, 16, v18
    v_and_b32 v25, s57, v18
    v_lshlrev_b32 v26, 16, v19
    v_and_b32 v27, s57, v19
    v_mul_f32 v20, v20, v24
    v_mul_f32 v21, v21, v25
    v_mul_f32 v22, v22, v26
    v_mul_f32 v23, v23, v27
    v_cvt_pk_bf16_f32 v28, v20, v21
    v_cvt_pk_bf16_f32 v29, v22, v23
    ds_write_b64 v1, v[28:29] offset:29248
    v_cvt_pk_bf16_f32 v16, v92, v93
    v_cvt_pk_bf16_f32 v17, v94, v95
    v_cvt_pk_bf16_f32 v18, v188, v189
    v_cvt_pk_bf16_f32 v19, v190, v191
    v_lshlrev_b32 v20, 16, v16
    v_and_b32 v21, s57, v16
    v_lshlrev_b32 v22, 16, v17
    v_and_b32 v23, s57, v17
    v_lshlrev_b32 v24, 16, v18
    v_and_b32 v25, s57, v18
    v_lshlrev_b32 v26, 16, v19
    v_and_b32 v27, s57, v19
    v_mul_f32 v20, v20, v24
    v_mul_f32 v21, v21, v25
    v_mul_f32 v22, v22, v26
    v_mul_f32 v23, v23, v27
    v_cvt_pk_bf16_f32 v28, v20, v21
    v_cvt_pk_bf16_f32 v29, v22, v23
    ds_write_b64 v1, v[28:29] offset:34048
    v_cvt_pk_bf16_f32 v32, v124, v125
    v_cvt_pk_bf16_f32 v33, v126, v127
    v_cvt_pk_bf16_f32 v34, v220, v221
    v_cvt_pk_bf16_f32 v35, v222, v223
    v_lshlrev_b32 v36, 16, v32
    v_and_b32 v37, s57, v32
    v_lshlrev_b32 v38, 16, v33
    v_and_b32 v39, s57, v33
    v_lshlrev_b32 v40, 16, v34
    v_and_b32 v41, s57, v34
    v_lshlrev_b32 v42, 16, v35
    v_and_b32 v43, s57, v35
    v_mul_f32 v36, v36, v40
    v_mul_f32 v37, v37, v41
    v_mul_f32 v38, v38, v42
    v_mul_f32 v39, v39, v43
    v_cvt_pk_bf16_f32 v44, v36, v37
    v_cvt_pk_bf16_f32 v45, v38, v39
    ds_write_b64 v1, v[44:45] offset:34080
    v_cvt_pk_bf16_f32 v16, v156, v157
    v_cvt_pk_bf16_f32 v17, v158, v159
    v_cvt_pk_bf16_f32 v18, v252, v253
    v_cvt_pk_bf16_f32 v19, v254, v255
    v_lshlrev_b32 v20, 16, v16
    v_and_b32 v21, s57, v16
    v_lshlrev_b32 v22, 16, v17
    v_and_b32 v23, s57, v17
    v_lshlrev_b32 v24, 16, v18
    v_and_b32 v25, s57, v18
    v_lshlrev_b32 v26, 16, v19
    v_and_b32 v27, s57, v19
    v_mul_f32 v20, v20, v24
    v_mul_f32 v21, v21, v25
    v_mul_f32 v22, v22, v26
    v_mul_f32 v23, v23, v27
    v_cvt_pk_bf16_f32 v28, v20, v21
    v_cvt_pk_bf16_f32 v29, v22, v23
    ds_write_b64 v1, v[28:29] offset:34112
    s_branch L_gm_k1_kernel_hstore
L_gm_k1_kernel_qpath:
    v_lshrrev_b32 v9, 4, v0
    v_bfe_u32 v10, v0, 2, 2
    v_lshl_add_u32 v10, v9, 3, v10
    v_mul_u32_u24 v10, 192, v10
    v_and_b32 v11, 1, v0
    v_lshl_add_u32 v10, v11, 3, v10
    v_and_b32 v9, 1, v9
    v_lshlrev_b32 v9, 1, v9
    v_bfe_u32 v11, v0, 1, 1
    v_add_u32 v12, 0, v11
    v_xor_b32 v13, v12, v9
    v_lshl_add_u32 v52, v13, 4, v10
    v_add_u32 v52, 34816, v52
    v_add_u32 v58, 81920, v52
    v_add_u32 v12, 2, v11
    v_xor_b32 v13, v12, v9
    v_lshl_add_u32 v53, v13, 4, v10
    v_add_u32 v53, 34816, v53
    v_add_u32 v59, 81920, v53
    v_add_u32 v12, 4, v11
    v_xor_b32 v13, v12, v9
    v_lshl_add_u32 v54, v13, 4, v10
    v_add_u32 v54, 34816, v54
    v_add_u32 v60, 81920, v54
    v_add_u32 v12, 6, v11
    v_xor_b32 v13, v12, v9
    v_lshl_add_u32 v55, v13, 4, v10
    v_add_u32 v55, 34816, v55
    v_add_u32 v61, 81920, v55
    v_add_u32 v12, 8, v11
    v_xor_b32 v13, v12, v9
    v_lshl_add_u32 v56, v13, 4, v10
    v_add_u32 v56, 34816, v56
    v_add_u32 v62, 81920, v56
    v_add_u32 v12, 10, v11
    v_xor_b32 v13, v12, v9
    v_lshl_add_u32 v57, v13, 4, v10
    v_add_u32 v57, 34816, v57
    v_add_u32 v63, 81920, v57
    s_waitcnt vmcnt(14)
    s_barrier
    ds_read_b128 v[40:43], v7 offset:0
    ds_read_b128 v[44:47], v7 offset:1024
    ds_read_b128 v[48:51], v7 offset:2048
    ds_read_b64_tr_b16 v[16:17], v52 offset:0
    ds_read_b64_tr_b16 v[18:19], v52 offset:768
    ds_read_b64_tr_b16 v[20:21], v53 offset:0
    ds_read_b64_tr_b16 v[22:23], v53 offset:768
    ds_read_b64_tr_b16 v[24:25], v54 offset:0
    ds_read_b64_tr_b16 v[26:27], v54 offset:768
    ds_read_b64_tr_b16 v[28:29], v55 offset:0
    ds_read_b64_tr_b16 v[30:31], v55 offset:768
    ds_read_b64_tr_b16 v[32:33], v56 offset:0
    ds_read_b64_tr_b16 v[34:35], v56 offset:768
    ds_read_b64_tr_b16 v[36:37], v57 offset:0
    ds_read_b64_tr_b16 v[38:39], v57 offset:768
    ds_read_b128 v[10:13], v7 offset:3072
    s_mov_b32 s62, 3
L_gm_k1_kernel_loopq:
    s_waitcnt vmcnt(5)
    s_barrier
    s_waitcnt lgkmcnt(11)
    v_mfma_f32_16x16x32_bf16 v[64:67], v[16:19], v[40:43], v[64:67]
    s_waitcnt lgkmcnt(9)
    v_mfma_f32_16x16x32_bf16 v[96:99], v[20:23], v[40:43], v[96:99]
    s_waitcnt lgkmcnt(7)
    v_mfma_f32_16x16x32_bf16 v[128:131], v[24:27], v[40:43], v[128:131]
    s_waitcnt lgkmcnt(5)
    v_mfma_f32_16x16x32_bf16 v[160:163], v[28:31], v[40:43], v[160:163]
    s_waitcnt lgkmcnt(3)
    v_mfma_f32_16x16x32_bf16 v[192:195], v[40:43], v[32:35], v[192:195]
    s_waitcnt lgkmcnt(1)
    v_mfma_f32_16x16x32_bf16 v[224:227], v[40:43], v[36:39], v[224:227]
    s_add_u32 m0, s94, 122880
    s_nop 0
    buffer_load_dwordx4 v2, s[64:67], s84 offen lds
    s_add_u32 s84, s84, s89
    ds_read_b128 v[40:43], v7 offset:4096
    v_mfma_f32_16x16x32_bf16 v[68:71], v[16:19], v[44:47], v[68:71]
    v_mfma_f32_16x16x32_bf16 v[100:103], v[20:23], v[44:47], v[100:103]
    v_mfma_f32_16x16x32_bf16 v[132:135], v[24:27], v[44:47], v[132:135]
    v_mfma_f32_16x16x32_bf16 v[164:167], v[28:31], v[44:47], v[164:167]
    v_mfma_f32_16x16x32_bf16 v[196:199], v[44:47], v[32:35], v[196:199]
    v_mfma_f32_16x16x32_bf16 v[228:231], v[44:47], v[36:39], v[228:231]
    s_add_u32 m0, s95, 122880
    s_nop 0
    buffer_load_dwordx4 v3, s[68:71], s85 offen lds
    s_add_u32 s85, s85, s90
    ds_read_b128 v[44:47], v7 offset:5120
    v_mfma_f32_16x16x32_bf16 v[72:75], v[16:19], v[48:51], v[72:75]
    v_mfma_f32_16x16x32_bf16 v[104:107], v[20:23], v[48:51], v[104:107]
    v_mfma_f32_16x16x32_bf16 v[136:139], v[24:27], v[48:51], v[136:139]
    v_mfma_f32_16x16x32_bf16 v[168:171], v[28:31], v[48:51], v[168:171]
    v_mfma_f32_16x16x32_bf16 v[200:203], v[48:51], v[32:35], v[200:203]
    v_mfma_f32_16x16x32_bf16 v[232:235], v[48:51], v[36:39], v[232:235]
    s_add_u32 m0, s96, 122880
    s_nop 0
    buffer_load_dwordx4 v4, s[72:75], s86 offen lds
    s_add_u32 s86, s86, s91
    ds_read_b128 v[48:51], v7 offset:6144
    s_waitcnt lgkmcnt(3)
    v_mfma_f32_16x16x32_bf16 v[76:79], v[16:19], v[10:13], v[76:79]
    v_mfma_f32_16x16x32_bf16 v[108:111], v[20:23], v[10:13], v[108:111]
    v_mfma_f32_16x16x32_bf16 v[140:143], v[24:27], v[10:13], v[140:143]
    v_mfma_f32_16x16x32_bf16 v[172:175], v[28:31], v[10:13], v[172:175]
    v_mfma_f32_16x16x32_bf16 v[204:207], v[10:13], v[32:35], v[204:207]
    v_mfma_f32_16x16x32_bf16 v[236:239], v[10:13], v[36:39], v[236:239]
    s_add_u32 m0, s97, 122880
    s_nop 0
    buffer_load_dwordx4 v5, s[76:79], s87 offen lds
    s_add_u32 s87, s87, s92
    ds_read_b128 v[10:13], v7 offset:7168
    s_waitcnt lgkmcnt(3)
    v_mfma_f32_16x16x32_bf16 v[80:83], v[16:19], v[40:43], v[80:83]
    v_mfma_f32_16x16x32_bf16 v[112:115], v[20:23], v[40:43], v[112:115]
    v_mfma_f32_16x16x32_bf16 v[144:147], v[24:27], v[40:43], v[144:147]
    v_mfma_f32_16x16x32_bf16 v[176:179], v[28:31], v[40:43], v[176:179]
    v_mfma_f32_16x16x32_bf16 v[208:211], v[40:43], v[32:35], v[208:211]
    v_mfma_f32_16x16x32_bf16 v[240:243], v[40:43], v[36:39], v[240:243]
    s_add_u32 m0, s98, 122880
    s_nop 0
    buffer_load_dwordx4 v6, s[80:83], s88 offen lds
    s_add_u32 s88, s88, s93
    ds_read_b128 v[40:43], v7 offset:40960
    s_waitcnt lgkmcnt(3)
    v_mfma_f32_16x16x32_bf16 v[84:87], v[16:19], v[44:47], v[84:87]
    v_mfma_f32_16x16x32_bf16 v[116:119], v[20:23], v[44:47], v[116:119]
    v_mfma_f32_16x16x32_bf16 v[148:151], v[24:27], v[44:47], v[148:151]
    v_mfma_f32_16x16x32_bf16 v[180:183], v[28:31], v[44:47], v[180:183]
    v_mfma_f32_16x16x32_bf16 v[212:215], v[44:47], v[32:35], v[212:215]
    v_mfma_f32_16x16x32_bf16 v[244:247], v[44:47], v[36:39], v[244:247]
    ds_read_b128 v[44:47], v7 offset:41984
    s_waitcnt lgkmcnt(3)
    v_mfma_f32_16x16x32_bf16 v[88:91], v[16:19], v[48:51], v[88:91]
    v_mfma_f32_16x16x32_bf16 v[120:123], v[20:23], v[48:51], v[120:123]
    v_mfma_f32_16x16x32_bf16 v[152:155], v[24:27], v[48:51], v[152:155]
    v_mfma_f32_16x16x32_bf16 v[184:187], v[28:31], v[48:51], v[184:187]
    v_mfma_f32_16x16x32_bf16 v[216:219], v[48:51], v[32:35], v[216:219]
    v_mfma_f32_16x16x32_bf16 v[248:251], v[48:51], v[36:39], v[248:251]
    ds_read_b128 v[48:51], v7 offset:43008
    s_waitcnt lgkmcnt(3)
    v_mfma_f32_16x16x32_bf16 v[92:95], v[16:19], v[10:13], v[92:95]
    ds_read_b64_tr_b16 v[16:17], v52 offset:40960
    ds_read_b64_tr_b16 v[18:19], v52 offset:41728
    v_mfma_f32_16x16x32_bf16 v[124:127], v[20:23], v[10:13], v[124:127]
    ds_read_b64_tr_b16 v[20:21], v53 offset:40960
    ds_read_b64_tr_b16 v[22:23], v53 offset:41728
    v_mfma_f32_16x16x32_bf16 v[156:159], v[24:27], v[10:13], v[156:159]
    ds_read_b64_tr_b16 v[24:25], v54 offset:40960
    ds_read_b64_tr_b16 v[26:27], v54 offset:41728
    v_mfma_f32_16x16x32_bf16 v[188:191], v[28:31], v[10:13], v[188:191]
    ds_read_b64_tr_b16 v[28:29], v55 offset:40960
    ds_read_b64_tr_b16 v[30:31], v55 offset:41728
    v_mfma_f32_16x16x32_bf16 v[220:223], v[10:13], v[32:35], v[220:223]
    ds_read_b64_tr_b16 v[32:33], v56 offset:40960
    ds_read_b64_tr_b16 v[34:35], v56 offset:41728
    v_mfma_f32_16x16x32_bf16 v[252:255], v[10:13], v[36:39], v[252:255]
    ds_read_b64_tr_b16 v[36:37], v57 offset:40960
    ds_read_b64_tr_b16 v[38:39], v57 offset:41728
    ds_read_b128 v[10:13], v7 offset:44032
    s_waitcnt vmcnt(5)
    s_barrier
    s_waitcnt lgkmcnt(11)
    v_mfma_f32_16x16x32_bf16 v[64:67], v[16:19], v[40:43], v[64:67]
    s_waitcnt lgkmcnt(9)
    v_mfma_f32_16x16x32_bf16 v[96:99], v[20:23], v[40:43], v[96:99]
    s_waitcnt lgkmcnt(7)
    v_mfma_f32_16x16x32_bf16 v[128:131], v[24:27], v[40:43], v[128:131]
    s_waitcnt lgkmcnt(5)
    v_mfma_f32_16x16x32_bf16 v[160:163], v[28:31], v[40:43], v[160:163]
    s_waitcnt lgkmcnt(3)
    v_mfma_f32_16x16x32_bf16 v[192:195], v[40:43], v[32:35], v[192:195]
    s_waitcnt lgkmcnt(1)
    v_mfma_f32_16x16x32_bf16 v[224:227], v[40:43], v[36:39], v[224:227]
    s_add_u32 m0, s94, 0
    s_nop 0
    buffer_load_dwordx4 v2, s[64:67], s84 offen lds
    s_add_u32 s84, s84, s89
    ds_read_b128 v[40:43], v7 offset:45056
    v_mfma_f32_16x16x32_bf16 v[68:71], v[16:19], v[44:47], v[68:71]
    v_mfma_f32_16x16x32_bf16 v[100:103], v[20:23], v[44:47], v[100:103]
    v_mfma_f32_16x16x32_bf16 v[132:135], v[24:27], v[44:47], v[132:135]
    v_mfma_f32_16x16x32_bf16 v[164:167], v[28:31], v[44:47], v[164:167]
    v_mfma_f32_16x16x32_bf16 v[196:199], v[44:47], v[32:35], v[196:199]
    v_mfma_f32_16x16x32_bf16 v[228:231], v[44:47], v[36:39], v[228:231]
    s_add_u32 m0, s95, 0
    s_nop 0
    buffer_load_dwordx4 v3, s[68:71], s85 offen lds
    s_add_u32 s85, s85, s90
    ds_read_b128 v[44:47], v7 offset:46080
    v_mfma_f32_16x16x32_bf16 v[72:75], v[16:19], v[48:51], v[72:75]
    v_mfma_f32_16x16x32_bf16 v[104:107], v[20:23], v[48:51], v[104:107]
    v_mfma_f32_16x16x32_bf16 v[136:139], v[24:27], v[48:51], v[136:139]
    v_mfma_f32_16x16x32_bf16 v[168:171], v[28:31], v[48:51], v[168:171]
    v_mfma_f32_16x16x32_bf16 v[200:203], v[48:51], v[32:35], v[200:203]
    v_mfma_f32_16x16x32_bf16 v[232:235], v[48:51], v[36:39], v[232:235]
    s_add_u32 m0, s96, 0
    s_nop 0
    buffer_load_dwordx4 v4, s[72:75], s86 offen lds
    s_add_u32 s86, s86, s91
    ds_read_b128 v[48:51], v7 offset:47104
    s_waitcnt lgkmcnt(3)
    v_mfma_f32_16x16x32_bf16 v[76:79], v[16:19], v[10:13], v[76:79]
    v_mfma_f32_16x16x32_bf16 v[108:111], v[20:23], v[10:13], v[108:111]
    v_mfma_f32_16x16x32_bf16 v[140:143], v[24:27], v[10:13], v[140:143]
    v_mfma_f32_16x16x32_bf16 v[172:175], v[28:31], v[10:13], v[172:175]
    v_mfma_f32_16x16x32_bf16 v[204:207], v[10:13], v[32:35], v[204:207]
    v_mfma_f32_16x16x32_bf16 v[236:239], v[10:13], v[36:39], v[236:239]
    s_add_u32 m0, s97, 0
    s_nop 0
    buffer_load_dwordx4 v5, s[76:79], s87 offen lds
    s_add_u32 s87, s87, s92
    ds_read_b128 v[10:13], v7 offset:48128
    s_waitcnt lgkmcnt(3)
    v_mfma_f32_16x16x32_bf16 v[80:83], v[16:19], v[40:43], v[80:83]
    v_mfma_f32_16x16x32_bf16 v[112:115], v[20:23], v[40:43], v[112:115]
    v_mfma_f32_16x16x32_bf16 v[144:147], v[24:27], v[40:43], v[144:147]
    v_mfma_f32_16x16x32_bf16 v[176:179], v[28:31], v[40:43], v[176:179]
    v_mfma_f32_16x16x32_bf16 v[208:211], v[40:43], v[32:35], v[208:211]
    v_mfma_f32_16x16x32_bf16 v[240:243], v[40:43], v[36:39], v[240:243]
    s_add_u32 m0, s98, 0
    s_nop 0
    buffer_load_dwordx4 v6, s[80:83], s88 offen lds
    s_add_u32 s88, s88, s93
    ds_read_b128 v[40:43], v8 offset:0
    s_waitcnt lgkmcnt(3)
    v_mfma_f32_16x16x32_bf16 v[84:87], v[16:19], v[44:47], v[84:87]
    v_mfma_f32_16x16x32_bf16 v[116:119], v[20:23], v[44:47], v[116:119]
    v_mfma_f32_16x16x32_bf16 v[148:151], v[24:27], v[44:47], v[148:151]
    v_mfma_f32_16x16x32_bf16 v[180:183], v[28:31], v[44:47], v[180:183]
    v_mfma_f32_16x16x32_bf16 v[212:215], v[44:47], v[32:35], v[212:215]
    v_mfma_f32_16x16x32_bf16 v[244:247], v[44:47], v[36:39], v[244:247]
    ds_read_b128 v[44:47], v8 offset:1024
    s_waitcnt lgkmcnt(3)
    v_mfma_f32_16x16x32_bf16 v[88:91], v[16:19], v[48:51], v[88:91]
    v_mfma_f32_16x16x32_bf16 v[120:123], v[20:23], v[48:51], v[120:123]
    v_mfma_f32_16x16x32_bf16 v[152:155], v[24:27], v[48:51], v[152:155]
    v_mfma_f32_16x16x32_bf16 v[184:187], v[28:31], v[48:51], v[184:187]
    v_mfma_f32_16x16x32_bf16 v[216:219], v[48:51], v[32:35], v[216:219]
    v_mfma_f32_16x16x32_bf16 v[248:251], v[48:51], v[36:39], v[248:251]
    ds_read_b128 v[48:51], v8 offset:2048
    s_waitcnt lgkmcnt(3)
    v_mfma_f32_16x16x32_bf16 v[92:95], v[16:19], v[10:13], v[92:95]
    ds_read_b64_tr_b16 v[16:17], v58 offset:0
    ds_read_b64_tr_b16 v[18:19], v58 offset:768
    v_mfma_f32_16x16x32_bf16 v[124:127], v[20:23], v[10:13], v[124:127]
    ds_read_b64_tr_b16 v[20:21], v59 offset:0
    ds_read_b64_tr_b16 v[22:23], v59 offset:768
    v_mfma_f32_16x16x32_bf16 v[156:159], v[24:27], v[10:13], v[156:159]
    ds_read_b64_tr_b16 v[24:25], v60 offset:0
    ds_read_b64_tr_b16 v[26:27], v60 offset:768
    v_mfma_f32_16x16x32_bf16 v[188:191], v[28:31], v[10:13], v[188:191]
    ds_read_b64_tr_b16 v[28:29], v61 offset:0
    ds_read_b64_tr_b16 v[30:31], v61 offset:768
    v_mfma_f32_16x16x32_bf16 v[220:223], v[10:13], v[32:35], v[220:223]
    ds_read_b64_tr_b16 v[32:33], v62 offset:0
    ds_read_b64_tr_b16 v[34:35], v62 offset:768
    v_mfma_f32_16x16x32_bf16 v[252:255], v[10:13], v[36:39], v[252:255]
    ds_read_b64_tr_b16 v[36:37], v63 offset:0
    ds_read_b64_tr_b16 v[38:39], v63 offset:768
    ds_read_b128 v[10:13], v8 offset:3072
    s_waitcnt vmcnt(5)
    s_barrier
    s_waitcnt lgkmcnt(11)
    v_mfma_f32_16x16x32_bf16 v[64:67], v[16:19], v[40:43], v[64:67]
    s_waitcnt lgkmcnt(9)
    v_mfma_f32_16x16x32_bf16 v[96:99], v[20:23], v[40:43], v[96:99]
    s_waitcnt lgkmcnt(7)
    v_mfma_f32_16x16x32_bf16 v[128:131], v[24:27], v[40:43], v[128:131]
    s_waitcnt lgkmcnt(5)
    v_mfma_f32_16x16x32_bf16 v[160:163], v[28:31], v[40:43], v[160:163]
    s_waitcnt lgkmcnt(3)
    v_mfma_f32_16x16x32_bf16 v[192:195], v[40:43], v[32:35], v[192:195]
    s_waitcnt lgkmcnt(1)
    v_mfma_f32_16x16x32_bf16 v[224:227], v[40:43], v[36:39], v[224:227]
    s_add_u32 m0, s94, 40960
    s_nop 0
    buffer_load_dwordx4 v2, s[64:67], s84 offen lds
    s_add_u32 s84, s84, s89
    ds_read_b128 v[40:43], v8 offset:4096
    v_mfma_f32_16x16x32_bf16 v[68:71], v[16:19], v[44:47], v[68:71]
    v_mfma_f32_16x16x32_bf16 v[100:103], v[20:23], v[44:47], v[100:103]
    v_mfma_f32_16x16x32_bf16 v[132:135], v[24:27], v[44:47], v[132:135]
    v_mfma_f32_16x16x32_bf16 v[164:167], v[28:31], v[44:47], v[164:167]
    v_mfma_f32_16x16x32_bf16 v[196:199], v[44:47], v[32:35], v[196:199]
    v_mfma_f32_16x16x32_bf16 v[228:231], v[44:47], v[36:39], v[228:231]
    s_add_u32 m0, s95, 40960
    s_nop 0
    buffer_load_dwordx4 v3, s[68:71], s85 offen lds
    s_add_u32 s85, s85, s90
    ds_read_b128 v[44:47], v8 offset:5120
    v_mfma_f32_16x16x32_bf16 v[72:75], v[16:19], v[48:51], v[72:75]
    v_mfma_f32_16x16x32_bf16 v[104:107], v[20:23], v[48:51], v[104:107]
    v_mfma_f32_16x16x32_bf16 v[136:139], v[24:27], v[48:51], v[136:139]
    v_mfma_f32_16x16x32_bf16 v[168:171], v[28:31], v[48:51], v[168:171]
    v_mfma_f32_16x16x32_bf16 v[200:203], v[48:51], v[32:35], v[200:203]
    v_mfma_f32_16x16x32_bf16 v[232:235], v[48:51], v[36:39], v[232:235]
    s_add_u32 m0, s96, 40960
    s_nop 0
    buffer_load_dwordx4 v4, s[72:75], s86 offen lds
    s_add_u32 s86, s86, s91
    ds_read_b128 v[48:51], v8 offset:6144
    s_waitcnt lgkmcnt(3)
    v_mfma_f32_16x16x32_bf16 v[76:79], v[16:19], v[10:13], v[76:79]
    v_mfma_f32_16x16x32_bf16 v[108:111], v[20:23], v[10:13], v[108:111]
    v_mfma_f32_16x16x32_bf16 v[140:143], v[24:27], v[10:13], v[140:143]
    v_mfma_f32_16x16x32_bf16 v[172:175], v[28:31], v[10:13], v[172:175]
    v_mfma_f32_16x16x32_bf16 v[204:207], v[10:13], v[32:35], v[204:207]
    v_mfma_f32_16x16x32_bf16 v[236:239], v[10:13], v[36:39], v[236:239]
    s_add_u32 m0, s97, 40960
    s_nop 0
    buffer_load_dwordx4 v5, s[76:79], s87 offen lds
    s_add_u32 s87, s87, s92
    ds_read_b128 v[10:13], v8 offset:7168
    s_waitcnt lgkmcnt(3)
    v_mfma_f32_16x16x32_bf16 v[80:83], v[16:19], v[40:43], v[80:83]
    v_mfma_f32_16x16x32_bf16 v[112:115], v[20:23], v[40:43], v[112:115]
    v_mfma_f32_16x16x32_bf16 v[144:147], v[24:27], v[40:43], v[144:147]
    v_mfma_f32_16x16x32_bf16 v[176:179], v[28:31], v[40:43], v[176:179]
    v_mfma_f32_16x16x32_bf16 v[208:211], v[40:43], v[32:35], v[208:211]
    v_mfma_f32_16x16x32_bf16 v[240:243], v[40:43], v[36:39], v[240:243]
    s_add_u32 m0, s98, 40960
    s_nop 0
    buffer_load_dwordx4 v6, s[80:83], s88 offen lds
    s_add_u32 s88, s88, s93
    ds_read_b128 v[40:43], v8 offset:40960
    s_waitcnt lgkmcnt(3)
    v_mfma_f32_16x16x32_bf16 v[84:87], v[16:19], v[44:47], v[84:87]
    v_mfma_f32_16x16x32_bf16 v[116:119], v[20:23], v[44:47], v[116:119]
    v_mfma_f32_16x16x32_bf16 v[148:151], v[24:27], v[44:47], v[148:151]
    v_mfma_f32_16x16x32_bf16 v[180:183], v[28:31], v[44:47], v[180:183]
    v_mfma_f32_16x16x32_bf16 v[212:215], v[44:47], v[32:35], v[212:215]
    v_mfma_f32_16x16x32_bf16 v[244:247], v[44:47], v[36:39], v[244:247]
    ds_read_b128 v[44:47], v8 offset:41984
    s_waitcnt lgkmcnt(3)
    v_mfma_f32_16x16x32_bf16 v[88:91], v[16:19], v[48:51], v[88:91]
    v_mfma_f32_16x16x32_bf16 v[120:123], v[20:23], v[48:51], v[120:123]
    v_mfma_f32_16x16x32_bf16 v[152:155], v[24:27], v[48:51], v[152:155]
    v_mfma_f32_16x16x32_bf16 v[184:187], v[28:31], v[48:51], v[184:187]
    v_mfma_f32_16x16x32_bf16 v[216:219], v[48:51], v[32:35], v[216:219]
    v_mfma_f32_16x16x32_bf16 v[248:251], v[48:51], v[36:39], v[248:251]
    ds_read_b128 v[48:51], v8 offset:43008
    s_waitcnt lgkmcnt(3)
    v_mfma_f32_16x16x32_bf16 v[92:95], v[16:19], v[10:13], v[92:95]
    ds_read_b64_tr_b16 v[16:17], v58 offset:40960
    ds_read_b64_tr_b16 v[18:19], v58 offset:41728
    v_mfma_f32_16x16x32_bf16 v[124:127], v[20:23], v[10:13], v[124:127]
    ds_read_b64_tr_b16 v[20:21], v59 offset:40960
    ds_read_b64_tr_b16 v[22:23], v59 offset:41728
    v_mfma_f32_16x16x32_bf16 v[156:159], v[24:27], v[10:13], v[156:159]
    ds_read_b64_tr_b16 v[24:25], v60 offset:40960
    ds_read_b64_tr_b16 v[26:27], v60 offset:41728
    v_mfma_f32_16x16x32_bf16 v[188:191], v[28:31], v[10:13], v[188:191]
    ds_read_b64_tr_b16 v[28:29], v61 offset:40960
    ds_read_b64_tr_b16 v[30:31], v61 offset:41728
    v_mfma_f32_16x16x32_bf16 v[220:223], v[10:13], v[32:35], v[220:223]
    ds_read_b64_tr_b16 v[32:33], v62 offset:40960
    ds_read_b64_tr_b16 v[34:35], v62 offset:41728
    v_mfma_f32_16x16x32_bf16 v[252:255], v[10:13], v[36:39], v[252:255]
    ds_read_b64_tr_b16 v[36:37], v63 offset:40960
    ds_read_b64_tr_b16 v[38:39], v63 offset:41728
    ds_read_b128 v[10:13], v8 offset:44032
    s_waitcnt vmcnt(5)
    s_barrier
    s_waitcnt lgkmcnt(11)
    v_mfma_f32_16x16x32_bf16 v[64:67], v[16:19], v[40:43], v[64:67]
    s_waitcnt lgkmcnt(9)
    v_mfma_f32_16x16x32_bf16 v[96:99], v[20:23], v[40:43], v[96:99]
    s_waitcnt lgkmcnt(7)
    v_mfma_f32_16x16x32_bf16 v[128:131], v[24:27], v[40:43], v[128:131]
    s_waitcnt lgkmcnt(5)
    v_mfma_f32_16x16x32_bf16 v[160:163], v[28:31], v[40:43], v[160:163]
    s_waitcnt lgkmcnt(3)
    v_mfma_f32_16x16x32_bf16 v[192:195], v[40:43], v[32:35], v[192:195]
    s_waitcnt lgkmcnt(1)
    v_mfma_f32_16x16x32_bf16 v[224:227], v[40:43], v[36:39], v[224:227]
    s_add_u32 m0, s94, 81920
    s_nop 0
    buffer_load_dwordx4 v2, s[64:67], s84 offen lds
    s_add_u32 s84, s84, s89
    ds_read_b128 v[40:43], v8 offset:45056
    v_mfma_f32_16x16x32_bf16 v[68:71], v[16:19], v[44:47], v[68:71]
    v_mfma_f32_16x16x32_bf16 v[100:103], v[20:23], v[44:47], v[100:103]
    v_mfma_f32_16x16x32_bf16 v[132:135], v[24:27], v[44:47], v[132:135]
    v_mfma_f32_16x16x32_bf16 v[164:167], v[28:31], v[44:47], v[164:167]
    v_mfma_f32_16x16x32_bf16 v[196:199], v[44:47], v[32:35], v[196:199]
    v_mfma_f32_16x16x32_bf16 v[228:231], v[44:47], v[36:39], v[228:231]
    s_add_u32 m0, s95, 81920
    s_nop 0
    buffer_load_dwordx4 v3, s[68:71], s85 offen lds
    s_add_u32 s85, s85, s90
    ds_read_b128 v[44:47], v8 offset:46080
    v_mfma_f32_16x16x32_bf16 v[72:75], v[16:19], v[48:51], v[72:75]
    v_mfma_f32_16x16x32_bf16 v[104:107], v[20:23], v[48:51], v[104:107]
    v_mfma_f32_16x16x32_bf16 v[136:139], v[24:27], v[48:51], v[136:139]
    v_mfma_f32_16x16x32_bf16 v[168:171], v[28:31], v[48:51], v[168:171]
    v_mfma_f32_16x16x32_bf16 v[200:203], v[48:51], v[32:35], v[200:203]
    v_mfma_f32_16x16x32_bf16 v[232:235], v[48:51], v[36:39], v[232:235]
    s_add_u32 m0, s96, 81920
    s_nop 0
    buffer_load_dwordx4 v4, s[72:75], s86 offen lds
    s_add_u32 s86, s86, s91
    ds_read_b128 v[48:51], v8 offset:47104
    s_waitcnt lgkmcnt(3)
    v_mfma_f32_16x16x32_bf16 v[76:79], v[16:19], v[10:13], v[76:79]
    v_mfma_f32_16x16x32_bf16 v[108:111], v[20:23], v[10:13], v[108:111]
    v_mfma_f32_16x16x32_bf16 v[140:143], v[24:27], v[10:13], v[140:143]
    v_mfma_f32_16x16x32_bf16 v[172:175], v[28:31], v[10:13], v[172:175]
    v_mfma_f32_16x16x32_bf16 v[204:207], v[10:13], v[32:35], v[204:207]
    v_mfma_f32_16x16x32_bf16 v[236:239], v[10:13], v[36:39], v[236:239]
    s_add_u32 m0, s97, 81920
    s_nop 0
    buffer_load_dwordx4 v5, s[76:79], s87 offen lds
    s_add_u32 s87, s87, s92
    ds_read_b128 v[10:13], v8 offset:48128
    s_waitcnt lgkmcnt(3)
    v_mfma_f32_16x16x32_bf16 v[80:83], v[16:19], v[40:43], v[80:83]
    v_mfma_f32_16x16x32_bf16 v[112:115], v[20:23], v[40:43], v[112:115]
    v_mfma_f32_16x16x32_bf16 v[144:147], v[24:27], v[40:43], v[144:147]
    v_mfma_f32_16x16x32_bf16 v[176:179], v[28:31], v[40:43], v[176:179]
    v_mfma_f32_16x16x32_bf16 v[208:211], v[40:43], v[32:35], v[208:211]
    v_mfma_f32_16x16x32_bf16 v[240:243], v[40:43], v[36:39], v[240:243]
    s_add_u32 m0, s98, 81920
    s_nop 0
    buffer_load_dwordx4 v6, s[80:83], s88 offen lds
    s_add_u32 s88, s88, s93
    ds_read_b128 v[40:43], v7 offset:0
    s_waitcnt lgkmcnt(3)
    v_mfma_f32_16x16x32_bf16 v[84:87], v[16:19], v[44:47], v[84:87]
    v_mfma_f32_16x16x32_bf16 v[116:119], v[20:23], v[44:47], v[116:119]
    v_mfma_f32_16x16x32_bf16 v[148:151], v[24:27], v[44:47], v[148:151]
    v_mfma_f32_16x16x32_bf16 v[180:183], v[28:31], v[44:47], v[180:183]
    v_mfma_f32_16x16x32_bf16 v[212:215], v[44:47], v[32:35], v[212:215]
    v_mfma_f32_16x16x32_bf16 v[244:247], v[44:47], v[36:39], v[244:247]
    ds_read_b128 v[44:47], v7 offset:1024
    s_waitcnt lgkmcnt(3)
    v_mfma_f32_16x16x32_bf16 v[88:91], v[16:19], v[48:51], v[88:91]
    v_mfma_f32_16x16x32_bf16 v[120:123], v[20:23], v[48:51], v[120:123]
    v_mfma_f32_16x16x32_bf16 v[152:155], v[24:27], v[48:51], v[152:155]
    v_mfma_f32_16x16x32_bf16 v[184:187], v[28:31], v[48:51], v[184:187]
    v_mfma_f32_16x16x32_bf16 v[216:219], v[48:51], v[32:35], v[216:219]
    v_mfma_f32_16x16x32_bf16 v[248:251], v[48:51], v[36:39], v[248:251]
    ds_read_b128 v[48:51], v7 offset:2048
    s_waitcnt lgkmcnt(3)
    v_mfma_f32_16x16x32_bf16 v[92:95], v[16:19], v[10:13], v[92:95]
    ds_read_b64_tr_b16 v[16:17], v52 offset:0
    ds_read_b64_tr_b16 v[18:19], v52 offset:768
    v_mfma_f32_16x16x32_bf16 v[124:127], v[20:23], v[10:13], v[124:127]
    ds_read_b64_tr_b16 v[20:21], v53 offset:0
    ds_read_b64_tr_b16 v[22:23], v53 offset:768
    v_mfma_f32_16x16x32_bf16 v[156:159], v[24:27], v[10:13], v[156:159]
    ds_read_b64_tr_b16 v[24:25], v54 offset:0
    ds_read_b64_tr_b16 v[26:27], v54 offset:768
    v_mfma_f32_16x16x32_bf16 v[188:191], v[28:31], v[10:13], v[188:191]
    ds_read_b64_tr_b16 v[28:29], v55 offset:0
    ds_read_b64_tr_b16 v[30:31], v55 offset:768
    v_mfma_f32_16x16x32_bf16 v[220:223], v[10:13], v[32:35], v[220:223]
    ds_read_b64_tr_b16 v[32:33], v56 offset:0
    ds_read_b64_tr_b16 v[34:35], v56 offset:768
    v_mfma_f32_16x16x32_bf16 v[252:255], v[10:13], v[36:39], v[252:255]
    ds_read_b64_tr_b16 v[36:37], v57 offset:0
    ds_read_b64_tr_b16 v[38:39], v57 offset:768
    ds_read_b128 v[10:13], v7 offset:3072
    s_sub_u32 s62, s62, 1
    s_cmp_lg_u32 s62, 0
    s_cbranch_scc1 L_gm_k1_kernel_loopq
    s_waitcnt vmcnt(5)
    s_barrier
    s_waitcnt lgkmcnt(11)
    v_mfma_f32_16x16x32_bf16 v[64:67], v[16:19], v[40:43], v[64:67]
    s_waitcnt lgkmcnt(9)
    v_mfma_f32_16x16x32_bf16 v[96:99], v[20:23], v[40:43], v[96:99]
    s_waitcnt lgkmcnt(7)
    v_mfma_f32_16x16x32_bf16 v[128:131], v[24:27], v[40:43], v[128:131]
    s_waitcnt lgkmcnt(5)
    v_mfma_f32_16x16x32_bf16 v[160:163], v[28:31], v[40:43], v[160:163]
    s_waitcnt lgkmcnt(3)
    v_mfma_f32_16x16x32_bf16 v[192:195], v[40:43], v[32:35], v[192:195]
    s_waitcnt lgkmcnt(1)
    v_mfma_f32_16x16x32_bf16 v[224:227], v[40:43], v[36:39], v[224:227]
    s_add_u32 m0, s94, 122880
    s_nop 0
    buffer_load_dwordx4 v2, s[64:67], s84 offen lds
    s_add_u32 s84, s84, s89
    ds_read_b128 v[40:43], v7 offset:4096
    v_mfma_f32_16x16x32_bf16 v[68:71], v[16:19], v[44:47], v[68:71]
    v_mfma_f32_16x16x32_bf16 v[100:103], v[20:23], v[44:47], v[100:103]
    v_mfma_f32_16x16x32_bf16 v[132:135], v[24:27], v[44:47], v[132:135]
    v_mfma_f32_16x16x32_bf16 v[164:167], v[28:31], v[44:47], v[164:167]
    v_mfma_f32_16x16x32_bf16 v[196:199], v[44:47], v[32:35], v[196:199]
    v_mfma_f32_16x16x32_bf16 v[228:231], v[44:47], v[36:39], v[228:231]
    s_add_u32 m0, s95, 122880
    s_nop 0
    buffer_load_dwordx4 v3, s[68:71], s85 offen lds
    s_add_u32 s85, s85, s90
    ds_read_b128 v[44:47], v7 offset:5120
    v_mfma_f32_16x16x32_bf16 v[72:75], v[16:19], v[48:51], v[72:75]
    v_mfma_f32_16x16x32_bf16 v[104:107], v[20:23], v[48:51], v[104:107]
    v_mfma_f32_16x16x32_bf16 v[136:139], v[24:27], v[48:51], v[136:139]
    v_mfma_f32_16x16x32_bf16 v[168:171], v[28:31], v[48:51], v[168:171]
    v_mfma_f32_16x16x32_bf16 v[200:203], v[48:51], v[32:35], v[200:203]
    v_mfma_f32_16x16x32_bf16 v[232:235], v[48:51], v[36:39], v[232:235]
    s_add_u32 m0, s96, 122880
    s_nop 0
    buffer_load_dwordx4 v4, s[72:75], s86 offen lds
    s_add_u32 s86, s86, s91
    ds_read_b128 v[48:51], v7 offset:6144
    s_waitcnt lgkmcnt(3)
    v_mfma_f32_16x16x32_bf16 v[76:79], v[16:19], v[10:13], v[76:79]
    v_mfma_f32_16x16x32_bf16 v[108:111], v[20:23], v[10:13], v[108:111]
    v_mfma_f32_16x16x32_bf16 v[140:143], v[24:27], v[10:13], v[140:143]
    v_mfma_f32_16x16x32_bf16 v[172:175], v[28:31], v[10:13], v[172:175]
    v_mfma_f32_16x16x32_bf16 v[204:207], v[10:13], v[32:35], v[204:207]
    v_mfma_f32_16x16x32_bf16 v[236:239], v[10:13], v[36:39], v[236:239]
    s_add_u32 m0, s97, 122880
    s_nop 0
    buffer_load_dwordx4 v5, s[76:79], s87 offen lds
    s_add_u32 s87, s87, s92
    ds_read_b128 v[10:13], v7 offset:7168
    s_waitcnt lgkmcnt(3)
    v_mfma_f32_16x16x32_bf16 v[80:83], v[16:19], v[40:43], v[80:83]
    v_mfma_f32_16x16x32_bf16 v[112:115], v[20:23], v[40:43], v[112:115]
    v_mfma_f32_16x16x32_bf16 v[144:147], v[24:27], v[40:43], v[144:147]
    v_mfma_f32_16x16x32_bf16 v[176:179], v[28:31], v[40:43], v[176:179]
    v_mfma_f32_16x16x32_bf16 v[208:211], v[40:43], v[32:35], v[208:211]
    v_mfma_f32_16x16x32_bf16 v[240:243], v[40:43], v[36:39], v[240:243]
    s_add_u32 m0, s98, 122880
    s_nop 0
    buffer_load_dwordx4 v6, s[80:83], s88 offen lds
    s_add_u32 s88, s88, s93
    ds_read_b128 v[40:43], v7 offset:40960
    s_waitcnt lgkmcnt(3)
    v_mfma_f32_16x16x32_bf16 v[84:87], v[16:19], v[44:47], v[84:87]
    v_mfma_f32_16x16x32_bf16 v[116:119], v[20:23], v[44:47], v[116:119]
    v_mfma_f32_16x16x32_bf16 v[148:151], v[24:27], v[44:47], v[148:151]
    v_mfma_f32_16x16x32_bf16 v[180:183], v[28:31], v[44:47], v[180:183]
    v_mfma_f32_16x16x32_bf16 v[212:215], v[44:47], v[32:35], v[212:215]
    v_mfma_f32_16x16x32_bf16 v[244:247], v[44:47], v[36:39], v[244:247]
    ds_read_b128 v[44:47], v7 offset:41984
    s_waitcnt lgkmcnt(3)
    v_mfma_f32_16x16x32_bf16 v[88:91], v[16:19], v[48:51], v[88:91]
    v_mfma_f32_16x16x32_bf16 v[120:123], v[20:23], v[48:51], v[120:123]
    v_mfma_f32_16x16x32_bf16 v[152:155], v[24:27], v[48:51], v[152:155]
    v_mfma_f32_16x16x32_bf16 v[184:187], v[28:31], v[48:51], v[184:187]
    v_mfma_f32_16x16x32_bf16 v[216:219], v[48:51], v[32:35], v[216:219]
    v_mfma_f32_16x16x32_bf16 v[248:251], v[48:51], v[36:39], v[248:251]
    ds_read_b128 v[48:51], v7 offset:43008
    s_waitcnt lgkmcnt(3)
    v_mfma_f32_16x16x32_bf16 v[92:95], v[16:19], v[10:13], v[92:95]
    ds_read_b64_tr_b16 v[16:17], v52 offset:40960
    ds_read_b64_tr_b16 v[18:19], v52 offset:41728
    v_mfma_f32_16x16x32_bf16 v[124:127], v[20:23], v[10:13], v[124:127]
    ds_read_b64_tr_b16 v[20:21], v53 offset:40960
    ds_read_b64_tr_b16 v[22:23], v53 offset:41728
    v_mfma_f32_16x16x32_bf16 v[156:159], v[24:27], v[10:13], v[156:159]
    ds_read_b64_tr_b16 v[24:25], v54 offset:40960
    ds_read_b64_tr_b16 v[26:27], v54 offset:41728
    v_mfma_f32_16x16x32_bf16 v[188:191], v[28:31], v[10:13], v[188:191]
    ds_read_b64_tr_b16 v[28:29], v55 offset:40960
    ds_read_b64_tr_b16 v[30:31], v55 offset:41728
    v_mfma_f32_16x16x32_bf16 v[220:223], v[10:13], v[32:35], v[220:223]
    ds_read_b64_tr_b16 v[32:33], v56 offset:40960
    ds_read_b64_tr_b16 v[34:35], v56 offset:41728
    v_mfma_f32_16x16x32_bf16 v[252:255], v[10:13], v[36:39], v[252:255]
    ds_read_b64_tr_b16 v[36:37], v57 offset:40960
    ds_read_b64_tr_b16 v[38:39], v57 offset:41728
    ds_read_b128 v[10:13], v7 offset:44032
    s_waitcnt vmcnt(5)
    s_barrier
    s_waitcnt lgkmcnt(11)
    v_mfma_f32_16x16x32_bf16 v[64:67], v[16:19], v[40:43], v[64:67]
    s_waitcnt lgkmcnt(9)
    v_mfma_f32_16x16x32_bf16 v[96:99], v[20:23], v[40:43], v[96:99]
    s_waitcnt lgkmcnt(7)
    v_mfma_f32_16x16x32_bf16 v[128:131], v[24:27], v[40:43], v[128:131]
    s_waitcnt lgkmcnt(5)
    v_mfma_f32_16x16x32_bf16 v[160:163], v[28:31], v[40:43], v[160:163]
    s_waitcnt lgkmcnt(3)
    v_mfma_f32_16x16x32_bf16 v[192:195], v[40:43], v[32:35], v[192:195]
    s_waitcnt lgkmcnt(1)
    v_mfma_f32_16x16x32_bf16 v[224:227], v[40:43], v[36:39], v[224:227]
    s_add_u32 m0, s94, 0
    s_nop 0
    buffer_load_dwordx4 v2, s[64:67], s84 offen lds
    s_add_u32 s84, s84, s89
    ds_read_b128 v[40:43], v7 offset:45056
    v_mfma_f32_16x16x32_bf16 v[68:71], v[16:19], v[44:47], v[68:71]
    v_mfma_f32_16x16x32_bf16 v[100:103], v[20:23], v[44:47], v[100:103]
    v_mfma_f32_16x16x32_bf16 v[132:135], v[24:27], v[44:47], v[132:135]
    v_mfma_f32_16x16x32_bf16 v[164:167], v[28:31], v[44:47], v[164:167]
    v_mfma_f32_16x16x32_bf16 v[196:199], v[44:47], v[32:35], v[196:199]
    v_mfma_f32_16x16x32_bf16 v[228:231], v[44:47], v[36:39], v[228:231]
    s_add_u32 m0, s95, 0
    s_nop 0
    buffer_load_dwordx4 v3, s[68:71], s85 offen lds
    s_add_u32 s85, s85, s90
    ds_read_b128 v[44:47], v7 offset:46080
    v_mfma_f32_16x16x32_bf16 v[72:75], v[16:19], v[48:51], v[72:75]
    v_mfma_f32_16x16x32_bf16 v[104:107], v[20:23], v[48:51], v[104:107]
    v_mfma_f32_16x16x32_bf16 v[136:139], v[24:27], v[48:51], v[136:139]
    v_mfma_f32_16x16x32_bf16 v[168:171], v[28:31], v[48:51], v[168:171]
    v_mfma_f32_16x16x32_bf16 v[200:203], v[48:51], v[32:35], v[200:203]
    v_mfma_f32_16x16x32_bf16 v[232:235], v[48:51], v[36:39], v[232:235]
    s_add_u32 m0, s96, 0
    s_nop 0
    buffer_load_dwordx4 v4, s[72:75], s86 offen lds
    s_add_u32 s86, s86, s91
    ds_read_b128 v[48:51], v7 offset:47104
    s_waitcnt lgkmcnt(3)
    v_mfma_f32_16x16x32_bf16 v[76:79], v[16:19], v[10:13], v[76:79]
    v_mfma_f32_16x16x32_bf16 v[108:111], v[20:23], v[10:13], v[108:111]
    v_mfma_f32_16x16x32_bf16 v[140:143], v[24:27], v[10:13], v[140:143]
    v_mfma_f32_16x16x32_bf16 v[172:175], v[28:31], v[10:13], v[172:175]
    v_mfma_f32_16x16x32_bf16 v[204:207], v[10:13], v[32:35], v[204:207]
    v_mfma_f32_16x16x32_bf16 v[236:239], v[10:13], v[36:39], v[236:239]
    s_add_u32 m0, s97, 0
    s_nop 0
    buffer_load_dwordx4 v5, s[76:79], s87 offen lds
    s_add_u32 s87, s87, s92
    ds_read_b128 v[10:13], v7 offset:48128
    s_waitcnt lgkmcnt(3)
    v_mfma_f32_16x16x32_bf16 v[80:83], v[16:19], v[40:43], v[80:83]
    v_mfma_f32_16x16x32_bf16 v[112:115], v[20:23], v[40:43], v[112:115]
    v_mfma_f32_16x16x32_bf16 v[144:147], v[24:27], v[40:43], v[144:147]
    v_mfma_f32_16x16x32_bf16 v[176:179], v[28:31], v[40:43], v[176:179]
    v_mfma_f32_16x16x32_bf16 v[208:211], v[40:43], v[32:35], v[208:211]
    v_mfma_f32_16x16x32_bf16 v[240:243], v[40:43], v[36:39], v[240:243]
    s_add_u32 m0, s98, 0
    s_nop 0
    buffer_load_dwordx4 v6, s[80:83], s88 offen lds
    s_add_u32 s88, s88, s93
    ds_read_b128 v[40:43], v8 offset:0
    s_waitcnt lgkmcnt(3)
    v_mfma_f32_16x16x32_bf16 v[84:87], v[16:19], v[44:47], v[84:87]
    v_mfma_f32_16x16x32_bf16 v[116:119], v[20:23], v[44:47], v[116:119]
    v_mfma_f32_16x16x32_bf16 v[148:151], v[24:27], v[44:47], v[148:151]
    v_mfma_f32_16x16x32_bf16 v[180:183], v[28:31], v[44:47], v[180:183]
    v_mfma_f32_16x16x32_bf16 v[212:215], v[44:47], v[32:35], v[212:215]
    v_mfma_f32_16x16x32_bf16 v[244:247], v[44:47], v[36:39], v[244:247]
    ds_read_b128 v[44:47], v8 offset:1024
    s_waitcnt lgkmcnt(3)
    v_mfma_f32_16x16x32_bf16 v[88:91], v[16:19], v[48:51], v[88:91]
    v_mfma_f32_16x16x32_bf16 v[120:123], v[20:23], v[48:51], v[120:123]
    v_mfma_f32_16x16x32_bf16 v[152:155], v[24:27], v[48:51], v[152:155]
    v_mfma_f32_16x16x32_bf16 v[184:187], v[28:31], v[48:51], v[184:187]
    v_mfma_f32_16x16x32_bf16 v[216:219], v[48:51], v[32:35], v[216:219]
    v_mfma_f32_16x16x32_bf16 v[248:251], v[48:51], v[36:39], v[248:251]
    ds_read_b128 v[48:51], v8 offset:2048
    s_waitcnt lgkmcnt(3)
    v_mfma_f32_16x16x32_bf16 v[92:95], v[16:19], v[10:13], v[92:95]
    ds_read_b64_tr_b16 v[16:17], v58 offset:0
    ds_read_b64_tr_b16 v[18:19], v58 offset:768
    v_mfma_f32_16x16x32_bf16 v[124:127], v[20:23], v[10:13], v[124:127]
    ds_read_b64_tr_b16 v[20:21], v59 offset:0
    ds_read_b64_tr_b16 v[22:23], v59 offset:768
    v_mfma_f32_16x16x32_bf16 v[156:159], v[24:27], v[10:13], v[156:159]
    ds_read_b64_tr_b16 v[24:25], v60 offset:0
    ds_read_b64_tr_b16 v[26:27], v60 offset:768
    v_mfma_f32_16x16x32_bf16 v[188:191], v[28:31], v[10:13], v[188:191]
    ds_read_b64_tr_b16 v[28:29], v61 offset:0
    ds_read_b64_tr_b16 v[30:31], v61 offset:768
    v_mfma_f32_16x16x32_bf16 v[220:223], v[10:13], v[32:35], v[220:223]
    ds_read_b64_tr_b16 v[32:33], v62 offset:0
    ds_read_b64_tr_b16 v[34:35], v62 offset:768
    v_mfma_f32_16x16x32_bf16 v[252:255], v[10:13], v[36:39], v[252:255]
    ds_read_b64_tr_b16 v[36:37], v63 offset:0
    ds_read_b64_tr_b16 v[38:39], v63 offset:768
    ds_read_b128 v[10:13], v8 offset:3072
    s_waitcnt vmcnt(5)
    s_barrier
    s_waitcnt lgkmcnt(11)
    v_mfma_f32_16x16x32_bf16 v[64:67], v[16:19], v[40:43], v[64:67]
    s_waitcnt lgkmcnt(9)
    v_mfma_f32_16x16x32_bf16 v[96:99], v[20:23], v[40:43], v[96:99]
    s_waitcnt lgkmcnt(7)
    v_mfma_f32_16x16x32_bf16 v[128:131], v[24:27], v[40:43], v[128:131]
    s_waitcnt lgkmcnt(5)
    v_mfma_f32_16x16x32_bf16 v[160:163], v[28:31], v[40:43], v[160:163]
    s_waitcnt lgkmcnt(3)
    v_mfma_f32_16x16x32_bf16 v[192:195], v[40:43], v[32:35], v[192:195]
    s_waitcnt lgkmcnt(1)
    v_mfma_f32_16x16x32_bf16 v[224:227], v[40:43], v[36:39], v[224:227]
    s_add_u32 m0, s94, 40960
    s_nop 0
    buffer_load_dwordx4 v2, s[64:67], s84 offen lds
    s_add_u32 s84, s84, s89
    ds_read_b128 v[40:43], v8 offset:4096
    v_mfma_f32_16x16x32_bf16 v[68:71], v[16:19], v[44:47], v[68:71]
    v_mfma_f32_16x16x32_bf16 v[100:103], v[20:23], v[44:47], v[100:103]
    v_mfma_f32_16x16x32_bf16 v[132:135], v[24:27], v[44:47], v[132:135]
    v_mfma_f32_16x16x32_bf16 v[164:167], v[28:31], v[44:47], v[164:167]
    v_mfma_f32_16x16x32_bf16 v[196:199], v[44:47], v[32:35], v[196:199]
    v_mfma_f32_16x16x32_bf16 v[228:231], v[44:47], v[36:39], v[228:231]
    s_add_u32 m0, s95, 40960
    s_nop 0
    buffer_load_dwordx4 v3, s[68:71], s85 offen lds
    s_add_u32 s85, s85, s90
    ds_read_b128 v[44:47], v8 offset:5120
    v_mfma_f32_16x16x32_bf16 v[72:75], v[16:19], v[48:51], v[72:75]
    v_mfma_f32_16x16x32_bf16 v[104:107], v[20:23], v[48:51], v[104:107]
    v_mfma_f32_16x16x32_bf16 v[136:139], v[24:27], v[48:51], v[136:139]
    v_mfma_f32_16x16x32_bf16 v[168:171], v[28:31], v[48:51], v[168:171]
    v_mfma_f32_16x16x32_bf16 v[200:203], v[48:51], v[32:35], v[200:203]
    v_mfma_f32_16x16x32_bf16 v[232:235], v[48:51], v[36:39], v[232:235]
    s_add_u32 m0, s96, 40960
    s_nop 0
    buffer_load_dwordx4 v4, s[72:75], s86 offen lds
    s_add_u32 s86, s86, s91
    ds_read_b128 v[48:51], v8 offset:6144
    s_waitcnt lgkmcnt(3)
    v_mfma_f32_16x16x32_bf16 v[76:79], v[16:19], v[10:13], v[76:79]
    v_mfma_f32_16x16x32_bf16 v[108:111], v[20:23], v[10:13], v[108:111]
    v_mfma_f32_16x16x32_bf16 v[140:143], v[24:27], v[10:13], v[140:143]
    v_mfma_f32_16x16x32_bf16 v[172:175], v[28:31], v[10:13], v[172:175]
    v_mfma_f32_16x16x32_bf16 v[204:207], v[10:13], v[32:35], v[204:207]
    v_mfma_f32_16x16x32_bf16 v[236:239], v[10:13], v[36:39], v[236:239]
    s_add_u32 m0, s97, 40960
    s_nop 0
    buffer_load_dwordx4 v5, s[76:79], s87 offen lds
    s_add_u32 s87, s87, s92
    ds_read_b128 v[10:13], v8 offset:7168
    s_waitcnt lgkmcnt(3)
    v_mfma_f32_16x16x32_bf16 v[80:83], v[16:19], v[40:43], v[80:83]
    v_mfma_f32_16x16x32_bf16 v[112:115], v[20:23], v[40:43], v[112:115]
    v_mfma_f32_16x16x32_bf16 v[144:147], v[24:27], v[40:43], v[144:147]
    v_mfma_f32_16x16x32_bf16 v[176:179], v[28:31], v[40:43], v[176:179]
    v_mfma_f32_16x16x32_bf16 v[208:211], v[40:43], v[32:35], v[208:211]
    v_mfma_f32_16x16x32_bf16 v[240:243], v[40:43], v[36:39], v[240:243]
    s_add_u32 m0, s98, 40960
    s_nop 0
    buffer_load_dwordx4 v6, s[80:83], s88 offen lds
    s_add_u32 s88, s88, s93
    ds_read_b128 v[40:43], v8 offset:40960
    s_waitcnt lgkmcnt(3)
    v_mfma_f32_16x16x32_bf16 v[84:87], v[16:19], v[44:47], v[84:87]
    v_mfma_f32_16x16x32_bf16 v[116:119], v[20:23], v[44:47], v[116:119]
    v_mfma_f32_16x16x32_bf16 v[148:151], v[24:27], v[44:47], v[148:151]
    v_mfma_f32_16x16x32_bf16 v[180:183], v[28:31], v[44:47], v[180:183]
    v_mfma_f32_16x16x32_bf16 v[212:215], v[44:47], v[32:35], v[212:215]
    v_mfma_f32_16x16x32_bf16 v[244:247], v[44:47], v[36:39], v[244:247]
    ds_read_b128 v[44:47], v8 offset:41984
    s_waitcnt lgkmcnt(3)
    v_mfma_f32_16x16x32_bf16 v[88:91], v[16:19], v[48:51], v[88:91]
    v_mfma_f32_16x16x32_bf16 v[120:123], v[20:23], v[48:51], v[120:123]
    v_mfma_f32_16x16x32_bf16 v[152:155], v[24:27], v[48:51], v[152:155]
    v_mfma_f32_16x16x32_bf16 v[184:187], v[28:31], v[48:51], v[184:187]
    v_mfma_f32_16x16x32_bf16 v[216:219], v[48:51], v[32:35], v[216:219]
    v_mfma_f32_16x16x32_bf16 v[248:251], v[48:51], v[36:39], v[248:251]
    ds_read_b128 v[48:51], v8 offset:43008
    s_waitcnt lgkmcnt(3)
    v_mfma_f32_16x16x32_bf16 v[92:95], v[16:19], v[10:13], v[92:95]
    ds_read_b64_tr_b16 v[16:17], v58 offset:40960
    ds_read_b64_tr_b16 v[18:19], v58 offset:41728
    v_mfma_f32_16x16x32_bf16 v[124:127], v[20:23], v[10:13], v[124:127]
    ds_read_b64_tr_b16 v[20:21], v59 offset:40960
    ds_read_b64_tr_b16 v[22:23], v59 offset:41728
    v_mfma_f32_16x16x32_bf16 v[156:159], v[24:27], v[10:13], v[156:159]
    ds_read_b64_tr_b16 v[24:25], v60 offset:40960
    ds_read_b64_tr_b16 v[26:27], v60 offset:41728
    v_mfma_f32_16x16x32_bf16 v[188:191], v[28:31], v[10:13], v[188:191]
    ds_read_b64_tr_b16 v[28:29], v61 offset:40960
    ds_read_b64_tr_b16 v[30:31], v61 offset:41728
    v_mfma_f32_16x16x32_bf16 v[220:223], v[10:13], v[32:35], v[220:223]
    ds_read_b64_tr_b16 v[32:33], v62 offset:40960
    ds_read_b64_tr_b16 v[34:35], v62 offset:41728
    v_mfma_f32_16x16x32_bf16 v[252:255], v[10:13], v[36:39], v[252:255]
    ds_read_b64_tr_b16 v[36:37], v63 offset:40960
    ds_read_b64_tr_b16 v[38:39], v63 offset:41728
    ds_read_b128 v[10:13], v8 offset:44032
    s_waitcnt vmcnt(5)
    s_barrier
    s_waitcnt lgkmcnt(11)
    v_mfma_f32_16x16x32_bf16 v[64:67], v[16:19], v[40:43], v[64:67]
    s_waitcnt lgkmcnt(9)
    v_mfma_f32_16x16x32_bf16 v[96:99], v[20:23], v[40:43], v[96:99]
    s_waitcnt lgkmcnt(7)
    v_mfma_f32_16x16x32_bf16 v[128:131], v[24:27], v[40:43], v[128:131]
    s_waitcnt lgkmcnt(5)
    v_mfma_f32_16x16x32_bf16 v[160:163], v[28:31], v[40:43], v[160:163]
    s_waitcnt lgkmcnt(3)
    v_mfma_f32_16x16x32_bf16 v[192:195], v[40:43], v[32:35], v[192:195]
    s_waitcnt lgkmcnt(1)
    v_mfma_f32_16x16x32_bf16 v[224:227], v[40:43], v[36:39], v[224:227]
    ds_read_b128 v[40:43], v8 offset:45056
    v_mfma_f32_16x16x32_bf16 v[68:71], v[16:19], v[44:47], v[68:71]
    v_mfma_f32_16x16x32_bf16 v[100:103], v[20:23], v[44:47], v[100:103]
    v_mfma_f32_16x16x32_bf16 v[132:135], v[24:27], v[44:47], v[132:135]
    v_mfma_f32_16x16x32_bf16 v[164:167], v[28:31], v[44:47], v[164:167]
    v_mfma_f32_16x16x32_bf16 v[196:199], v[44:47], v[32:35], v[196:199]
    v_mfma_f32_16x16x32_bf16 v[228:231], v[44:47], v[36:39], v[228:231]
    ds_read_b128 v[44:47], v8 offset:46080
    v_mfma_f32_16x16x32_bf16 v[72:75], v[16:19], v[48:51], v[72:75]
    v_mfma_f32_16x16x32_bf16 v[104:107], v[20:23], v[48:51], v[104:107]
    v_mfma_f32_16x16x32_bf16 v[136:139], v[24:27], v[48:51], v[136:139]
    v_mfma_f32_16x16x32_bf16 v[168:171], v[28:31], v[48:51], v[168:171]
    v_mfma_f32_16x16x32_bf16 v[200:203], v[48:51], v[32:35], v[200:203]
    v_mfma_f32_16x16x32_bf16 v[232:235], v[48:51], v[36:39], v[232:235]
    ds_read_b128 v[48:51], v8 offset:47104
    s_waitcnt lgkmcnt(3)
    v_mfma_f32_16x16x32_bf16 v[76:79], v[16:19], v[10:13], v[76:79]
    v_mfma_f32_16x16x32_bf16 v[108:111], v[20:23], v[10:13], v[108:111]
    v_mfma_f32_16x16x32_bf16 v[140:143], v[24:27], v[10:13], v[140:143]
    v_mfma_f32_16x16x32_bf16 v[172:175], v[28:31], v[10:13], v[172:175]
    v_mfma_f32_16x16x32_bf16 v[204:207], v[10:13], v[32:35], v[204:207]
    v_mfma_f32_16x16x32_bf16 v[236:239], v[10:13], v[36:39], v[236:239]
    ds_read_b128 v[10:13], v8 offset:48128
    s_waitcnt lgkmcnt(3)
    v_mfma_f32_16x16x32_bf16 v[80:83], v[16:19], v[40:43], v[80:83]
    v_mfma_f32_16x16x32_bf16 v[112:115], v[20:23], v[40:43], v[112:115]
    v_mfma_f32_16x16x32_bf16 v[144:147], v[24:27], v[40:43], v[144:147]
    v_mfma_f32_16x16x32_bf16 v[176:179], v[28:31], v[40:43], v[176:179]
    v_mfma_f32_16x16x32_bf16 v[208:211], v[40:43], v[32:35], v[208:211]
    v_mfma_f32_16x16x32_bf16 v[240:243], v[40:43], v[36:39], v[240:243]
    ds_read_b128 v[40:43], v7 offset:0
    s_waitcnt lgkmcnt(3)
    v_mfma_f32_16x16x32_bf16 v[84:87], v[16:19], v[44:47], v[84:87]
    v_mfma_f32_16x16x32_bf16 v[116:119], v[20:23], v[44:47], v[116:119]
    v_mfma_f32_16x16x32_bf16 v[148:151], v[24:27], v[44:47], v[148:151]
    v_mfma_f32_16x16x32_bf16 v[180:183], v[28:31], v[44:47], v[180:183]
    v_mfma_f32_16x16x32_bf16 v[212:215], v[44:47], v[32:35], v[212:215]
    v_mfma_f32_16x16x32_bf16 v[244:247], v[44:47], v[36:39], v[244:247]
    ds_read_b128 v[44:47], v7 offset:1024
    s_waitcnt lgkmcnt(3)
    v_mfma_f32_16x16x32_bf16 v[88:91], v[16:19], v[48:51], v[88:91]
    v_mfma_f32_16x16x32_bf16 v[120:123], v[20:23], v[48:51], v[120:123]
    v_mfma_f32_16x16x32_bf16 v[152:155], v[24:27], v[48:51], v[152:155]
    v_mfma_f32_16x16x32_bf16 v[184:187], v[28:31], v[48:51], v[184:187]
    v_mfma_f32_16x16x32_bf16 v[216:219], v[48:51], v[32:35], v[216:219]
    v_mfma_f32_16x16x32_bf16 v[248:251], v[48:51], v[36:39], v[248:251]
    ds_read_b128 v[48:51], v7 offset:2048
    s_waitcnt lgkmcnt(3)
    v_mfma_f32_16x16x32_bf16 v[92:95], v[16:19], v[10:13], v[92:95]
    ds_read_b64_tr_b16 v[16:17], v52 offset:0
    ds_read_b64_tr_b16 v[18:19], v52 offset:768
    v_mfma_f32_16x16x32_bf16 v[124:127], v[20:23], v[10:13], v[124:127]
    ds_read_b64_tr_b16 v[20:21], v53 offset:0
    ds_read_b64_tr_b16 v[22:23], v53 offset:768
    v_mfma_f32_16x16x32_bf16 v[156:159], v[24:27], v[10:13], v[156:159]
    ds_read_b64_tr_b16 v[24:25], v54 offset:0
    ds_read_b64_tr_b16 v[26:27], v54 offset:768
    v_mfma_f32_16x16x32_bf16 v[188:191], v[28:31], v[10:13], v[188:191]
    ds_read_b64_tr_b16 v[28:29], v55 offset:0
    ds_read_b64_tr_b16 v[30:31], v55 offset:768
    v_mfma_f32_16x16x32_bf16 v[220:223], v[10:13], v[32:35], v[220:223]
    ds_read_b64_tr_b16 v[32:33], v56 offset:0
    ds_read_b64_tr_b16 v[34:35], v56 offset:768
    v_mfma_f32_16x16x32_bf16 v[252:255], v[10:13], v[36:39], v[252:255]
    ds_read_b64_tr_b16 v[36:37], v57 offset:0
    ds_read_b64_tr_b16 v[38:39], v57 offset:768
    ds_read_b128 v[10:13], v7 offset:3072
    s_waitcnt vmcnt(0)
    s_barrier
    s_waitcnt lgkmcnt(11)
    v_mfma_f32_16x16x32_bf16 v[64:67], v[16:19], v[40:43], v[64:67]
    s_waitcnt lgkmcnt(9)
    v_mfma_f32_16x16x32_bf16 v[96:99], v[20:23], v[40:43], v[96:99]
    s_waitcnt lgkmcnt(7)
    v_mfma_f32_16x16x32_bf16 v[128:131], v[24:27], v[40:43], v[128:131]
    s_waitcnt lgkmcnt(5)
    v_mfma_f32_16x16x32_bf16 v[160:163], v[28:31], v[40:43], v[160:163]
    s_waitcnt lgkmcnt(3)
    v_mfma_f32_16x16x32_bf16 v[192:195], v[40:43], v[32:35], v[192:195]
    s_waitcnt lgkmcnt(1)
    v_mfma_f32_16x16x32_bf16 v[224:227], v[40:43], v[36:39], v[224:227]
    ds_read_b128 v[40:43], v7 offset:4096
    v_mfma_f32_16x16x32_bf16 v[68:71], v[16:19], v[44:47], v[68:71]
    v_mfma_f32_16x16x32_bf16 v[100:103], v[20:23], v[44:47], v[100:103]
    v_mfma_f32_16x16x32_bf16 v[132:135], v[24:27], v[44:47], v[132:135]
    v_mfma_f32_16x16x32_bf16 v[164:167], v[28:31], v[44:47], v[164:167]
    v_mfma_f32_16x16x32_bf16 v[196:199], v[44:47], v[32:35], v[196:199]
    v_mfma_f32_16x16x32_bf16 v[228:231], v[44:47], v[36:39], v[228:231]
    ds_read_b128 v[44:47], v7 offset:5120
    v_mfma_f32_16x16x32_bf16 v[72:75], v[16:19], v[48:51], v[72:75]
    v_mfma_f32_16x16x32_bf16 v[104:107], v[20:23], v[48:51], v[104:107]
    v_mfma_f32_16x16x32_bf16 v[136:139], v[24:27], v[48:51], v[136:139]
    v_mfma_f32_16x16x32_bf16 v[168:171], v[28:31], v[48:51], v[168:171]
    v_mfma_f32_16x16x32_bf16 v[200:203], v[48:51], v[32:35], v[200:203]
    v_mfma_f32_16x16x32_bf16 v[232:235], v[48:51], v[36:39], v[232:235]
    ds_read_b128 v[48:51], v7 offset:6144
    s_waitcnt lgkmcnt(3)
    v_mfma_f32_16x16x32_bf16 v[76:79], v[16:19], v[10:13], v[76:79]
    v_mfma_f32_16x16x32_bf16 v[108:111], v[20:23], v[10:13], v[108:111]
    v_mfma_f32_16x16x32_bf16 v[140:143], v[24:27], v[10:13], v[140:143]
    v_mfma_f32_16x16x32_bf16 v[172:175], v[28:31], v[10:13], v[172:175]
    v_mfma_f32_16x16x32_bf16 v[204:207], v[10:13], v[32:35], v[204:207]
    v_mfma_f32_16x16x32_bf16 v[236:239], v[10:13], v[36:39], v[236:239]
    ds_read_b128 v[10:13], v7 offset:7168
    s_waitcnt lgkmcnt(3)
    v_mfma_f32_16x16x32_bf16 v[80:83], v[16:19], v[40:43], v[80:83]
    v_mfma_f32_16x16x32_bf16 v[112:115], v[20:23], v[40:43], v[112:115]
    v_mfma_f32_16x16x32_bf16 v[144:147], v[24:27], v[40:43], v[144:147]
    v_mfma_f32_16x16x32_bf16 v[176:179], v[28:31], v[40:43], v[176:179]
    v_mfma_f32_16x16x32_bf16 v[208:211], v[40:43], v[32:35], v[208:211]
    v_mfma_f32_16x16x32_bf16 v[240:243], v[40:43], v[36:39], v[240:243]
    ds_read_b128 v[40:43], v7 offset:40960
    s_waitcnt lgkmcnt(3)
    v_mfma_f32_16x16x32_bf16 v[84:87], v[16:19], v[44:47], v[84:87]
    v_mfma_f32_16x16x32_bf16 v[116:119], v[20:23], v[44:47], v[116:119]
    v_mfma_f32_16x16x32_bf16 v[148:151], v[24:27], v[44:47], v[148:151]
    v_mfma_f32_16x16x32_bf16 v[180:183], v[28:31], v[44:47], v[180:183]
    v_mfma_f32_16x16x32_bf16 v[212:215], v[44:47], v[32:35], v[212:215]
    v_mfma_f32_16x16x32_bf16 v[244:247], v[44:47], v[36:39], v[244:247]
    ds_read_b128 v[44:47], v7 offset:41984
    s_waitcnt lgkmcnt(3)
    v_mfma_f32_16x16x32_bf16 v[88:91], v[16:19], v[48:51], v[88:91]
    v_mfma_f32_16x16x32_bf16 v[120:123], v[20:23], v[48:51], v[120:123]
    v_mfma_f32_16x16x32_bf16 v[152:155], v[24:27], v[48:51], v[152:155]
    v_mfma_f32_16x16x32_bf16 v[184:187], v[28:31], v[48:51], v[184:187]
    v_mfma_f32_16x16x32_bf16 v[216:219], v[48:51], v[32:35], v[216:219]
    v_mfma_f32_16x16x32_bf16 v[248:251], v[48:51], v[36:39], v[248:251]
    ds_read_b128 v[48:51], v7 offset:43008
    s_waitcnt lgkmcnt(3)
    v_mfma_f32_16x16x32_bf16 v[92:95], v[16:19], v[10:13], v[92:95]
    ds_read_b64_tr_b16 v[16:17], v52 offset:40960
    ds_read_b64_tr_b16 v[18:19], v52 offset:41728
    v_mfma_f32_16x16x32_bf16 v[124:127], v[20:23], v[10:13], v[124:127]
    ds_read_b64_tr_b16 v[20:21], v53 offset:40960
    ds_read_b64_tr_b16 v[22:23], v53 offset:41728
    v_mfma_f32_16x16x32_bf16 v[156:159], v[24:27], v[10:13], v[156:159]
    ds_read_b64_tr_b16 v[24:25], v54 offset:40960
    ds_read_b64_tr_b16 v[26:27], v54 offset:41728
    v_mfma_f32_16x16x32_bf16 v[188:191], v[28:31], v[10:13], v[188:191]
    ds_read_b64_tr_b16 v[28:29], v55 offset:40960
    ds_read_b64_tr_b16 v[30:31], v55 offset:41728
    v_mfma_f32_16x16x32_bf16 v[220:223], v[10:13], v[32:35], v[220:223]
    ds_read_b64_tr_b16 v[32:33], v56 offset:40960
    ds_read_b64_tr_b16 v[34:35], v56 offset:41728
    v_mfma_f32_16x16x32_bf16 v[252:255], v[10:13], v[36:39], v[252:255]
    ds_read_b64_tr_b16 v[36:37], v57 offset:40960
    ds_read_b64_tr_b16 v[38:39], v57 offset:41728
    ds_read_b128 v[10:13], v7 offset:44032
    s_waitcnt lgkmcnt(11)
    v_mfma_f32_16x16x32_bf16 v[64:67], v[16:19], v[40:43], v[64:67]
    s_waitcnt lgkmcnt(9)
    v_mfma_f32_16x16x32_bf16 v[96:99], v[20:23], v[40:43], v[96:99]
    s_waitcnt lgkmcnt(7)
    v_mfma_f32_16x16x32_bf16 v[128:131], v[24:27], v[40:43], v[128:131]
    s_waitcnt lgkmcnt(5)
    v_mfma_f32_16x16x32_bf16 v[160:163], v[28:31], v[40:43], v[160:163]
    s_waitcnt lgkmcnt(3)
    v_mfma_f32_16x16x32_bf16 v[192:195], v[40:43], v[32:35], v[192:195]
    s_waitcnt lgkmcnt(1)
    v_mfma_f32_16x16x32_bf16 v[224:227], v[40:43], v[36:39], v[224:227]
    ds_read_b128 v[40:43], v7 offset:45056
    v_mfma_f32_16x16x32_bf16 v[68:71], v[16:19], v[44:47], v[68:71]
    v_mfma_f32_16x16x32_bf16 v[100:103], v[20:23], v[44:47], v[100:103]
    v_mfma_f32_16x16x32_bf16 v[132:135], v[24:27], v[44:47], v[132:135]
    v_mfma_f32_16x16x32_bf16 v[164:167], v[28:31], v[44:47], v[164:167]
    v_mfma_f32_16x16x32_bf16 v[196:199], v[44:47], v[32:35], v[196:199]
    v_mfma_f32_16x16x32_bf16 v[228:231], v[44:47], v[36:39], v[228:231]
    ds_read_b128 v[44:47], v7 offset:46080
    v_mfma_f32_16x16x32_bf16 v[72:75], v[16:19], v[48:51], v[72:75]
    v_mfma_f32_16x16x32_bf16 v[104:107], v[20:23], v[48:51], v[104:107]
    v_mfma_f32_16x16x32_bf16 v[136:139], v[24:27], v[48:51], v[136:139]
    v_mfma_f32_16x16x32_bf16 v[168:171], v[28:31], v[48:51], v[168:171]
    v_mfma_f32_16x16x32_bf16 v[200:203], v[48:51], v[32:35], v[200:203]
    v_mfma_f32_16x16x32_bf16 v[232:235], v[48:51], v[36:39], v[232:235]
    ds_read_b128 v[48:51], v7 offset:47104
    s_waitcnt lgkmcnt(3)
    v_mfma_f32_16x16x32_bf16 v[76:79], v[16:19], v[10:13], v[76:79]
    v_mfma_f32_16x16x32_bf16 v[108:111], v[20:23], v[10:13], v[108:111]
    v_mfma_f32_16x16x32_bf16 v[140:143], v[24:27], v[10:13], v[140:143]
    v_mfma_f32_16x16x32_bf16 v[172:175], v[28:31], v[10:13], v[172:175]
    v_mfma_f32_16x16x32_bf16 v[204:207], v[10:13], v[32:35], v[204:207]
    v_mfma_f32_16x16x32_bf16 v[236:239], v[10:13], v[36:39], v[236:239]
    ds_read_b128 v[10:13], v7 offset:48128
    s_waitcnt lgkmcnt(3)
    v_mfma_f32_16x16x32_bf16 v[80:83], v[16:19], v[40:43], v[80:83]
    v_mfma_f32_16x16x32_bf16 v[112:115], v[20:23], v[40:43], v[112:115]
    v_mfma_f32_16x16x32_bf16 v[144:147], v[24:27], v[40:43], v[144:147]
    v_mfma_f32_16x16x32_bf16 v[176:179], v[28:31], v[40:43], v[176:179]
    v_mfma_f32_16x16x32_bf16 v[208:211], v[40:43], v[32:35], v[208:211]
    v_mfma_f32_16x16x32_bf16 v[240:243], v[40:43], v[36:39], v[240:243]
    s_waitcnt lgkmcnt(2)
    v_mfma_f32_16x16x32_bf16 v[84:87], v[16:19], v[44:47], v[84:87]
    v_mfma_f32_16x16x32_bf16 v[116:119], v[20:23], v[44:47], v[116:119]
    v_mfma_f32_16x16x32_bf16 v[148:151], v[24:27], v[44:47], v[148:151]
    v_mfma_f32_16x16x32_bf16 v[180:183], v[28:31], v[44:47], v[180:183]
    v_mfma_f32_16x16x32_bf16 v[212:215], v[44:47], v[32:35], v[212:215]
    v_mfma_f32_16x16x32_bf16 v[244:247], v[44:47], v[36:39], v[244:247]
    s_waitcnt lgkmcnt(1)
    v_mfma_f32_16x16x32_bf16 v[88:91], v[16:19], v[48:51], v[88:91]
    v_mfma_f32_16x16x32_bf16 v[120:123], v[20:23], v[48:51], v[120:123]
    v_mfma_f32_16x16x32_bf16 v[152:155], v[24:27], v[48:51], v[152:155]
    v_mfma_f32_16x16x32_bf16 v[184:187], v[28:31], v[48:51], v[184:187]
    v_mfma_f32_16x16x32_bf16 v[216:219], v[48:51], v[32:35], v[216:219]
    v_mfma_f32_16x16x32_bf16 v[248:251], v[48:51], v[36:39], v[248:251]
    s_waitcnt lgkmcnt(0)
    v_mfma_f32_16x16x32_bf16 v[92:95], v[16:19], v[10:13], v[92:95]
    v_mfma_f32_16x16x32_bf16 v[124:127], v[20:23], v[10:13], v[124:127]
    v_mfma_f32_16x16x32_bf16 v[156:159], v[24:27], v[10:13], v[156:159]
    v_mfma_f32_16x16x32_bf16 v[188:191], v[28:31], v[10:13], v[188:191]
    v_mfma_f32_16x16x32_bf16 v[220:223], v[10:13], v[32:35], v[220:223]
    v_mfma_f32_16x16x32_bf16 v[252:255], v[10:13], v[36:39], v[252:255]
    s_nop 7
    s_nop 1
    s_barrier
    v_and_b32 v1, 15, v0
    s_lshl_b32 s47, s49, 7
    s_add_u32 s47, s47, s37
    v_add_u32 v1, s47, v1
    v_lshlrev_b32 v2, 4, v1
    v_lshrrev_b32 v3, 5, v0
    v_lshl_add_u32 v2, v3, 15, v2
    v_bfe_u32 v3, v0, 4, 1
    v_lshl_add_u32 v2, v3, 3, v2
    v_lshlrev_b32 v3, 2, v1
    s_mov_b32 s63, 0x3eae1a93
    v_cmp_gt_u32 vcc, 16, v0
    s_lshl_b32 s56, s33, 16
    s_add_u32 s56, s56, 0
    s_lshl_b32 s57, s33, 13
    s_add_u32 s57, s57, 4194304
    v_mul_f32 v64, s63, v64
    v_mul_f32 v65, s63, v65
    v_mul_f32 v66, s63, v66
    v_mul_f32 v67, s63, v67
    v_mul_f32 v96, s63, v96
    v_mul_f32 v97, s63, v97
    v_cvt_pk_bf16_f32 v16, v64, v65
    v_cvt_pk_bf16_f32 v17, v66, v67
    v_cvt_pk_bf16_f32 v18, v96, v97
    v_mul_f32 v68, s63, v68
    v_mul_f32 v69, s63, v69
    v_mul_f32 v70, s63, v70
    v_mul_f32 v71, s63, v71
    v_mul_f32 v100, s63, v100
    v_mul_f32 v101, s63, v101
    v_cvt_pk_bf16_f32 v20, v68, v69
    v_cvt_pk_bf16_f32 v21, v70, v71
    v_cvt_pk_bf16_f32 v22, v100, v101
    v_mul_f32 v72, s63, v72
    v_mul_f32 v73, s63, v73
    v_mul_f32 v74, s63, v74
    v_mul_f32 v75, s63, v75
    v_mul_f32 v104, s63, v104
    v_mul_f32 v105, s63, v105
    v_cvt_pk_bf16_f32 v24, v72, v73
    v_cvt_pk_bf16_f32 v25, v74, v75
    v_cvt_pk_bf16_f32 v26, v104, v105
    v_mul_f32 v76, s63, v76
    v_mul_f32 v77, s63, v77
    v_mul_f32 v78, s63, v78
    v_mul_f32 v79, s63, v79
    v_mul_f32 v108, s63, v108
    v_mul_f32 v109, s63, v109
    v_cvt_pk_bf16_f32 v28, v76, v77
    v_cvt_pk_bf16_f32 v29, v78, v79
    v_cvt_pk_bf16_f32 v30, v108, v109
    v_mul_f32 v80, s63, v80
    v_mul_f32 v81, s63, v81
    v_mul_f32 v82, s63, v82
    v_mul_f32 v83, s63, v83
    v_mul_f32 v112, s63, v112
    v_mul_f32 v113, s63, v113
    v_cvt_pk_bf16_f32 v32, v80, v81
    v_cvt_pk_bf16_f32 v33, v82, v83
    v_cvt_pk_bf16_f32 v34, v112, v113
    v_mul_f32 v84, s63, v84
    v_mul_f32 v85, s63, v85
    v_mul_f32 v86, s63, v86
    v_mul_f32 v87, s63, v87
    v_mul_f32 v116, s63, v116
    v_mul_f32 v117, s63, v117
    v_cvt_pk_bf16_f32 v36, v84, v85
    v_cvt_pk_bf16_f32 v37, v86, v87
    v_cvt_pk_bf16_f32 v38, v116, v117
    v_mul_f32 v88, s63, v88
    v_mul_f32 v89, s63, v89
    v_mul_f32 v90, s63, v90
    v_mul_f32 v91, s63, v91
    v_mul_f32 v120, s63, v120
    v_mul_f32 v121, s63, v121
    v_cvt_pk_bf16_f32 v40, v88, v89
    v_cvt_pk_bf16_f32 v41, v90, v91
    v_cvt_pk_bf16_f32 v42, v120, v121
    v_mul_f32 v92, s63, v92
    v_mul_f32 v93, s63, v93
    v_mul_f32 v94, s63, v94
    v_mul_f32 v95, s63, v95
    v_mul_f32 v124, s63, v124
    v_mul_f32 v125, s63, v125
    v_cvt_pk_bf16_f32 v44, v92, v93
    v_cvt_pk_bf16_f32 v45, v94, v95
    v_cvt_pk_bf16_f32 v46, v124, v125
    buffer_store_dwordx2 v[16:17], v2, s[16:19], s56 offen offset:0
    buffer_store_dwordx2 v[20:21], v2, s[16:19], s56 offen offset:256
    buffer_store_dwordx2 v[24:25], v2, s[16:19], s56 offen offset:512
    buffer_store_dwordx2 v[28:29], v2, s[16:19], s56 offen offset:768
    buffer_store_dwordx2 v[32:33], v2, s[16:19], s56 offen offset:1024
    buffer_store_dwordx2 v[36:37], v2, s[16:19], s56 offen offset:1280
    buffer_store_dwordx2 v[40:41], v2, s[16:19], s56 offen offset:1536
    buffer_store_dwordx2 v[44:45], v2, s[16:19], s56 offen offset:1792
    s_and_saveexec_b64 s[58:59], vcc
    buffer_store_dword v18, v3, s[16:19], s57 offen offset:0
    buffer_store_dword v22, v3, s[16:19], s57 offen offset:64
    buffer_store_dword v26, v3, s[16:19], s57 offen offset:128
    buffer_store_dword v30, v3, s[16:19], s57 offen offset:192
    buffer_store_dword v34, v3, s[16:19], s57 offen offset:256
    buffer_store_dword v38, v3, s[16:19], s57 offen offset:320
    buffer_store_dword v42, v3, s[16:19], s57 offen offset:384
    buffer_store_dword v46, v3, s[16:19], s57 offen offset:448
    s_mov_b64 exec, s[58:59]
    s_nop 1
    s_lshl_b32 s56, s33, 16
    s_add_u32 s56, s56, 2097152
    s_lshl_b32 s57, s33, 13
    s_add_u32 s57, s57, 4456448
    v_cvt_pk_bf16_f32 v16, v128, v129
    v_cvt_pk_bf16_f32 v17, v130, v131
    v_cvt_pk_bf16_f32 v18, v160, v161
    v_cvt_pk_bf16_f32 v20, v132, v133
    v_cvt_pk_bf16_f32 v21, v134, v135
    v_cvt_pk_bf16_f32 v22, v164, v165
    v_cvt_pk_bf16_f32 v24, v136, v137
    v_cvt_pk_bf16_f32 v25, v138, v139
    v_cvt_pk_bf16_f32 v26, v168, v169
    v_cvt_pk_bf16_f32 v28, v140, v141
    v_cvt_pk_bf16_f32 v29, v142, v143
    v_cvt_pk_bf16_f32 v30, v172, v173
    v_cvt_pk_bf16_f32 v32, v144, v145
    v_cvt_pk_bf16_f32 v33, v146, v147
    v_cvt_pk_bf16_f32 v34, v176, v177
    v_cvt_pk_bf16_f32 v36, v148, v149
    v_cvt_pk_bf16_f32 v37, v150, v151
    v_cvt_pk_bf16_f32 v38, v180, v181
    v_cvt_pk_bf16_f32 v40, v152, v153
    v_cvt_pk_bf16_f32 v41, v154, v155
    v_cvt_pk_bf16_f32 v42, v184, v185
    v_cvt_pk_bf16_f32 v44, v156, v157
    v_cvt_pk_bf16_f32 v45, v158, v159
    v_cvt_pk_bf16_f32 v46, v188, v189
    buffer_store_dwordx2 v[16:17], v2, s[16:19], s56 offen offset:0
    buffer_store_dwordx2 v[20:21], v2, s[16:19], s56 offen offset:256
    buffer_store_dwordx2 v[24:25], v2, s[16:19], s56 offen offset:512
    buffer_store_dwordx2 v[28:29], v2, s[16:19], s56 offen offset:768
    buffer_store_dwordx2 v[32:33], v2, s[16:19], s56 offen offset:1024
    buffer_store_dwordx2 v[36:37], v2, s[16:19], s56 offen offset:1280
    buffer_store_dwordx2 v[40:41], v2, s[16:19], s56 offen offset:1536
    buffer_store_dwordx2 v[44:45], v2, s[16:19], s56 offen offset:1792
    s_and_saveexec_b64 s[58:59], vcc
    buffer_store_dword v18, v3, s[16:19], s57 offen offset:0
    buffer_store_dword v22, v3, s[16:19], s57 offen offset:64
    buffer_store_dword v26, v3, s[16:19], s57 offen offset:128
    buffer_store_dword v30, v3, s[16:19], s57 offen offset:192
    buffer_store_dword v34, v3, s[16:19], s57 offen offset:256
    buffer_store_dword v38, v3, s[16:19], s57 offen offset:320
    buffer_store_dword v42, v3, s[16:19], s57 offen offset:384
    buffer_store_dword v46, v3, s[16:19], s57 offen offset:448
    s_mov_b64 exec, s[58:59]
    s_nop 1
    v_bfe_u32 v1, v0, 4, 1
    v_lshlrev_b32 v1, 3, v1
    v_bfe_u32 v2, v0, 5, 1
    v_lshl_add_u32 v1, v2, 2, v1
    s_lshl_b32 s47, s49, 7
    s_add_u32 s47, s47, s37
    v_add_u32 v1, s47, v1
    v_lshlrev_b32 v1, 1, v1
    v_and_b32 v2, 15, v0
    v_lshl_add_u32 v1, v2, 12, v1
    s_mul_i32 s56, s33, 73728
    s_add_u32 s56, s56, 4718592
    s_add_u32 s57, s56, 65536
    v_cvt_pk_bf16_f32 v16, v192, v193
    v_cvt_pk_bf16_f32 v17, v194, v195
    v_cvt_pk_bf16_f32 v18, v196, v197
    v_cvt_pk_bf16_f32 v19, v198, v199
    v_cvt_pk_bf16_f32 v20, v200, v201
    v_cvt_pk_bf16_f32 v21, v202, v203
    v_cvt_pk_bf16_f32 v22, v204, v205
    v_cvt_pk_bf16_f32 v23, v206, v207
    v_cvt_pk_bf16_f32 v24, v208, v209
    v_cvt_pk_bf16_f32 v25, v210, v211
    v_cvt_pk_bf16_f32 v26, v212, v213
    v_cvt_pk_bf16_f32 v27, v214, v215
    v_cvt_pk_bf16_f32 v28, v216, v217
    v_cvt_pk_bf16_f32 v29, v218, v219
    v_cvt_pk_bf16_f32 v30, v220, v221
    v_cvt_pk_bf16_f32 v31, v222, v223
    v_cvt_pk_bf16_f32 v32, v224, v225
    v_cvt_pk_bf16_f32 v33, v226, v227
    v_cvt_pk_bf16_f32 v34, v228, v229
    v_cvt_pk_bf16_f32 v35, v230, v231
    v_cvt_pk_bf16_f32 v36, v232, v233
    v_cvt_pk_bf16_f32 v37, v234, v235
    v_cvt_pk_bf16_f32 v38, v236, v237
    v_cvt_pk_bf16_f32 v39, v238, v239
    v_cvt_pk_bf16_f32 v40, v240, v241
    v_cvt_pk_bf16_f32 v41, v242, v243
    v_cvt_pk_bf16_f32 v42, v244, v245
    v_cvt_pk_bf16_f32 v43, v246, v247
    v_cvt_pk_bf16_f32 v44, v248, v249
    v_cvt_pk_bf16_f32 v45, v250, v251
    v_cvt_pk_bf16_f32 v46, v252, v253
    v_cvt_pk_bf16_f32 v47, v254, v255
    buffer_store_dwordx2 v[16:17], v1, s[16:19], s56 offen offset:0
    buffer_store_dwordx2 v[18:19], v1, s[16:19], s56 offen offset:32
    buffer_store_dwordx2 v[20:21], v1, s[16:19], s56 offen offset:64
    buffer_store_dwordx2 v[22:23], v1, s[16:19], s56 offen offset:96
    buffer_store_dwordx2 v[24:25], v1, s[16:19], s56 offen offset:128
    buffer_store_dwordx2 v[26:27], v1, s[16:19], s56 offen offset:160
    buffer_store_dwordx2 v[28:29], v1, s[16:19], s56 offen offset:192
    buffer_store_dwordx2 v[30:31], v1, s[16:19], s56 offen offset:224
    v_cmp_gt_u32 vcc, 2, v2
    s_and_saveexec_b64 s[58:59], vcc
    buffer_store_dwordx2 v[32:33], v1, s[16:19], s57 offen offset:0
    buffer_store_dwordx2 v[34:35], v1, s[16:19], s57 offen offset:32
    buffer_store_dwordx2 v[36:37], v1, s[16:19], s57 offen offset:64
    buffer_store_dwordx2 v[38:39], v1, s[16:19], s57 offen offset:96
    buffer_store_dwordx2 v[40:41], v1, s[16:19], s57 offen offset:128
    buffer_store_dwordx2 v[42:43], v1, s[16:19], s57 offen offset:160
    buffer_store_dwordx2 v[44:45], v1, s[16:19], s57 offen offset:192
    buffer_store_dwordx2 v[46:47], v1, s[16:19], s57 offen offset:224
    s_mov_b64 exec, s[58:59]
    s_load_dwordx2 s[28:29], s[0:1], 56
    s_lshl_b32 s38, s2, 3
    s_lshl_b32 s39, s49, 2
    s_add_u32 s38, s38, s39
    s_mul_i32 s39, s38, 1152
    s_waitcnt lgkmcnt(0)
    s_mov_b32 s12, s28
    s_and_b32 s13, s29, 0xffff
    s_mov_b32 s14, 1152
    s_mov_b32 s15, 0x20000
    v_lshlrev_b32 v1, 3, v0
    s_mov_b32 s57, 0xffff0000
    v_cmp_gt_u32 s[40:41], 16, v0
    s_mov_b64 s[42:43], exec
    buffer_load_dwordx2 v[64:65], v1, s[12:15], 0 offen offset:0
    s_add_u32 s47, s39, 0
    buffer_load_dwordx2 v[70:71], v1, s[4:7], s47 offen offset:0
    s_add_u32 s47, s39, 1152
    buffer_load_dwordx2 v[76:77], v1, s[4:7], s47 offen offset:0
    s_add_u32 s47, s39, 2304
    buffer_load_dwordx2 v[82:83], v1, s[4:7], s47 offen offset:0
    s_add_u32 s47, s39, 3456
    buffer_load_dwordx2 v[88:89], v1, s[4:7], s47 offen offset:0
    buffer_load_dwordx2 v[66:67], v1, s[12:15], 0 offen offset:512
    s_add_u32 s47, s39, 0
    buffer_load_dwordx2 v[72:73], v1, s[4:7], s47 offen offset:512
    s_add_u32 s47, s39, 1152
    buffer_load_dwordx2 v[78:79], v1, s[4:7], s47 offen offset:512
    s_add_u32 s47, s39, 2304
    buffer_load_dwordx2 v[84:85], v1, s[4:7], s47 offen offset:512
    s_add_u32 s47, s39, 3456
    buffer_load_dwordx2 v[90:91], v1, s[4:7], s47 offen offset:512
    s_mov_b64 exec, s[40:41]
    buffer_load_dwordx2 v[68:69], v1, s[12:15], 0 offen offset:1024
    s_add_u32 s47, s39, 0
    buffer_load_dwordx2 v[74:75], v1, s[4:7], s47 offen offset:1024
    s_add_u32 s47, s39, 1152
    buffer_load_dwordx2 v[80:81], v1, s[4:7], s47 offen offset:1024
    s_add_u32 s47, s39, 2304
    buffer_load_dwordx2 v[86:87], v1, s[4:7], s47 offen offset:1024
    s_add_u32 s47, s39, 3456
    buffer_load_dwordx2 v[92:93], v1, s[4:7], s47 offen offset:1024
    s_mov_b64 exec, s[42:43]
    v_mov_b32 v100, 0
    v_mov_b32 v101, 0
    v_mov_b32 v102, 0
    v_mov_b32 v103, 0
    s_waitcnt vmcnt(0)
    v_lshlrev_b32 v110, 16, v64
    v_and_b32 v111, s57, v64
    v_lshlrev_b32 v112, 16, v70
    v_and_b32 v113, s57, v70
    v_mul_f32 v112, v112, v110
    v_mul_f32 v113, v113, v111
    v_cvt_pk_bf16_f32 v112, v112, v113
    v_lshlrev_b32 v113, 16, v112
    v_and_b32 v112, s57, v112
    v_add_f32 v100, v100, v113
    v_add_f32 v100, v100, v112
    v_lshlrev_b32 v112, 16, v76
    v_and_b32 v113, s57, v76
    v_mul_f32 v112, v112, v110
    v_mul_f32 v113, v113, v111
    v_cvt_pk_bf16_f32 v112, v112, v113
    v_lshlrev_b32 v113, 16, v112
    v_and_b32 v112, s57, v112
    v_add_f32 v101, v101, v113
    v_add_f32 v101, v101, v112
    v_lshlrev_b32 v112, 16, v82
    v_and_b32 v113, s57, v82
    v_mul_f32 v112, v112, v110
    v_mul_f32 v113, v113, v111
    v_cvt_pk_bf16_f32 v112, v112, v113
    v_lshlrev_b32 v113, 16, v112
    v_and_b32 v112, s57, v112
    v_add_f32 v102, v102, v113
    v_add_f32 v102, v102, v112
    v_lshlrev_b32 v112, 16, v88
    v_and_b32 v113, s57, v88
    v_mul_f32 v112, v112, v110
    v_mul_f32 v113, v113, v111
    v_cvt_pk_bf16_f32 v112, v112, v113
    v_lshlrev_b32 v113, 16, v112
    v_and_b32 v112, s57, v112
    v_add_f32 v103, v103, v113
    v_add_f32 v103, v103, v112
    v_lshlrev_b32 v110, 16, v65
    v_and_b32 v111, s57, v65
    v_lshlrev_b32 v112, 16, v71
    v_and_b32 v113, s57, v71
    v_mul_f32 v112, v112, v110
    v_mul_f32 v113, v113, v111
    v_cvt_pk_bf16_f32 v112, v112, v113
    v_lshlrev_b32 v113, 16, v112
    v_and_b32 v112, s57, v112
    v_add_f32 v100, v100, v113
    v_add_f32 v100, v100, v112
    v_lshlrev_b32 v112, 16, v77
    v_and_b32 v113, s57, v77
    v_mul_f32 v112, v112, v110
    v_mul_f32 v113, v113, v111
    v_cvt_pk_bf16_f32 v112, v112, v113
    v_lshlrev_b32 v113, 16, v112
    v_and_b32 v112, s57, v112
    v_add_f32 v101, v101, v113
    v_add_f32 v101, v101, v112
    v_lshlrev_b32 v112, 16, v83
    v_and_b32 v113, s57, v83
    v_mul_f32 v112, v112, v110
    v_mul_f32 v113, v113, v111
    v_cvt_pk_bf16_f32 v112, v112, v113
    v_lshlrev_b32 v113, 16, v112
    v_and_b32 v112, s57, v112
    v_add_f32 v102, v102, v113
    v_add_f32 v102, v102, v112
    v_lshlrev_b32 v112, 16, v89
    v_and_b32 v113, s57, v89
    v_mul_f32 v112, v112, v110
    v_mul_f32 v113, v113, v111
    v_cvt_pk_bf16_f32 v112, v112, v113
    v_lshlrev_b32 v113, 16, v112
    v_and_b32 v112, s57, v112
    v_add_f32 v103, v103, v113
    v_add_f32 v103, v103, v112
    v_lshlrev_b32 v110, 16, v66
    v_and_b32 v111, s57, v66
    v_lshlrev_b32 v112, 16, v72
    v_and_b32 v113, s57, v72
    v_mul_f32 v112, v112, v110
    v_mul_f32 v113, v113, v111
    v_cvt_pk_bf16_f32 v112, v112, v113
    v_lshlrev_b32 v113, 16, v112
    v_and_b32 v112, s57, v112
    v_add_f32 v100, v100, v113
    v_add_f32 v100, v100, v112
    v_lshlrev_b32 v112, 16, v78
    v_and_b32 v113, s57, v78
    v_mul_f32 v112, v112, v110
    v_mul_f32 v113, v113, v111
    v_cvt_pk_bf16_f32 v112, v112, v113
    v_lshlrev_b32 v113, 16, v112
    v_and_b32 v112, s57, v112
    v_add_f32 v101, v101, v113
    v_add_f32 v101, v101, v112
    v_lshlrev_b32 v112, 16, v84
    v_and_b32 v113, s57, v84
    v_mul_f32 v112, v112, v110
    v_mul_f32 v113, v113, v111
    v_cvt_pk_bf16_f32 v112, v112, v113
    v_lshlrev_b32 v113, 16, v112
    v_and_b32 v112, s57, v112
    v_add_f32 v102, v102, v113
    v_add_f32 v102, v102, v112
    v_lshlrev_b32 v112, 16, v90
    v_and_b32 v113, s57, v90
    v_mul_f32 v112, v112, v110
    v_mul_f32 v113, v113, v111
    v_cvt_pk_bf16_f32 v112, v112, v113
    v_lshlrev_b32 v113, 16, v112
    v_and_b32 v112, s57, v112
    v_add_f32 v103, v103, v113
    v_add_f32 v103, v103, v112
    v_lshlrev_b32 v110, 16, v67
    v_and_b32 v111, s57, v67
    v_lshlrev_b32 v112, 16, v73
    v_and_b32 v113, s57, v73
    v_mul_f32 v112, v112, v110
    v_mul_f32 v113, v113, v111
    v_cvt_pk_bf16_f32 v112, v112, v113
    v_lshlrev_b32 v113, 16, v112
    v_and_b32 v112, s57, v112
    v_add_f32 v100, v100, v113
    v_add_f32 v100, v100, v112
    v_lshlrev_b32 v112, 16, v79
    v_and_b32 v113, s57, v79
    v_mul_f32 v112, v112, v110
    v_mul_f32 v113, v113, v111
    v_cvt_pk_bf16_f32 v112, v112, v113
    v_lshlrev_b32 v113, 16, v112
    v_and_b32 v112, s57, v112
    v_add_f32 v101, v101, v113
    v_add_f32 v101, v101, v112
    v_lshlrev_b32 v112, 16, v85
    v_and_b32 v113, s57, v85
    v_mul_f32 v112, v112, v110
    v_mul_f32 v113, v113, v111
    v_cvt_pk_bf16_f32 v112, v112, v113
    v_lshlrev_b32 v113, 16, v112
    v_and_b32 v112, s57, v112
    v_add_f32 v102, v102, v113
    v_add_f32 v102, v102, v112
    v_lshlrev_b32 v112, 16, v91
    v_and_b32 v113, s57, v91
    v_mul_f32 v112, v112, v110
    v_mul_f32 v113, v113, v111
    v_cvt_pk_bf16_f32 v112, v112, v113
    v_lshlrev_b32 v113, 16, v112
    v_and_b32 v112, s57, v112
    v_add_f32 v103, v103, v113
    v_add_f32 v103, v103, v112
    s_mov_b64 exec, s[40:41]
    v_lshlrev_b32 v110, 16, v68
    v_and_b32 v111, s57, v68
    v_lshlrev_b32 v112, 16, v74
    v_and_b32 v113, s57, v74
    v_mul_f32 v112, v112, v110
    v_mul_f32 v113, v113, v111
    v_cvt_pk_bf16_f32 v112, v112, v113
    v_lshlrev_b32 v113, 16, v112
    v_and_b32 v112, s57, v112
    v_add_f32 v100, v100, v113
    v_add_f32 v100, v100, v112
    v_lshlrev_b32 v112, 16, v80
    v_and_b32 v113, s57, v80
    v_mul_f32 v112, v112, v110
    v_mul_f32 v113, v113, v111
    v_cvt_pk_bf16_f32 v112, v112, v113
    v_lshlrev_b32 v113, 16, v112
    v_and_b32 v112, s57, v112
    v_add_f32 v101, v101, v113
    v_add_f32 v101, v101, v112
    v_lshlrev_b32 v112, 16, v86
    v_and_b32 v113, s57, v86
    v_mul_f32 v112, v112, v110
    v_mul_f32 v113, v113, v111
    v_cvt_pk_bf16_f32 v112, v112, v113
    v_lshlrev_b32 v113, 16, v112
    v_and_b32 v112, s57, v112
    v_add_f32 v102, v102, v113
    v_add_f32 v102, v102, v112
    v_lshlrev_b32 v112, 16, v92
    v_and_b32 v113, s57, v92
    v_mul_f32 v112, v112, v110
    v_mul_f32 v113, v113, v111
    v_cvt_pk_bf16_f32 v112, v112, v113
    v_lshlrev_b32 v113, 16, v112
    v_and_b32 v112, s57, v112
    v_add_f32 v103, v103, v113
    v_add_f32 v103, v103, v112
    v_lshlrev_b32 v110, 16, v69
    v_and_b32 v111, s57, v69
    v_lshlrev_b32 v112, 16, v75
    v_and_b32 v113, s57, v75
    v_mul_f32 v112, v112, v110
    v_mul_f32 v113, v113, v111
    v_cvt_pk_bf16_f32 v112, v112, v113
    v_lshlrev_b32 v113, 16, v112
    v_and_b32 v112, s57, v112
    v_add_f32 v100, v100, v113
    v_add_f32 v100, v100, v112
    v_lshlrev_b32 v112, 16, v81
    v_and_b32 v113, s57, v81
    v_mul_f32 v112, v112, v110
    v_mul_f32 v113, v113, v111
    v_cvt_pk_bf16_f32 v112, v112, v113
    v_lshlrev_b32 v113, 16, v112
    v_and_b32 v112, s57, v112
    v_add_f32 v101, v101, v113
    v_add_f32 v101, v101, v112
    v_lshlrev_b32 v112, 16, v87
    v_and_b32 v113, s57, v87
    v_mul_f32 v112, v112, v110
    v_mul_f32 v113, v113, v111
    v_cvt_pk_bf16_f32 v112, v112, v113
    v_lshlrev_b32 v113, 16, v112
    v_and_b32 v112, s57, v112
    v_add_f32 v102, v102, v113
    v_add_f32 v102, v102, v112
    v_lshlrev_b32 v112, 16, v93
    v_and_b32 v113, s57, v93
    v_mul_f32 v112, v112, v110
    v_mul_f32 v113, v113, v111
    v_cvt_pk_bf16_f32 v112, v112, v113
    v_lshlrev_b32 v113, 16, v112
    v_and_b32 v112, s57, v112
    v_add_f32 v103, v103, v113
    v_add_f32 v103, v103, v112
    s_mov_b64 exec, s[42:43]
    ds_swizzle_b32 v104, v100 offset:0x041f
    ds_swizzle_b32 v105, v101 offset:0x041f
    ds_swizzle_b32 v106, v102 offset:0x041f
    ds_swizzle_b32 v107, v103 offset:0x041f
    s_waitcnt lgkmcnt(0)
    v_add_f32 v100, v100, v104
    v_add_f32 v101, v101, v105
    v_add_f32 v102, v102, v106
    v_add_f32 v103, v103, v107
    ds_swizzle_b32 v104, v100 offset:0x081f
    ds_swizzle_b32 v105, v101 offset:0x081f
    ds_swizzle_b32 v106, v102 offset:0x081f
    ds_swizzle_b32 v107, v103 offset:0x081f
    s_waitcnt lgkmcnt(0)
    v_add_f32 v100, v100, v104
    v_add_f32 v101, v101, v105
    v_add_f32 v102, v102, v106
    v_add_f32 v103, v103, v107
    ds_swizzle_b32 v104, v100 offset:0x101f
    ds_swizzle_b32 v105, v101 offset:0x101f
    ds_swizzle_b32 v106, v102 offset:0x101f
    ds_swizzle_b32 v107, v103 offset:0x101f
    s_waitcnt lgkmcnt(0)
    v_add_f32 v100, v100, v104
    v_add_f32 v101, v101, v105
    v_add_f32 v102, v102, v106
    v_add_f32 v103, v103, v107
    ds_swizzle_b32 v104, v100 offset:0x201f
    ds_swizzle_b32 v105, v101 offset:0x201f
    ds_swizzle_b32 v106, v102 offset:0x201f
    ds_swizzle_b32 v107, v103 offset:0x201f
    s_waitcnt lgkmcnt(0)
    v_add_f32 v100, v100, v104
    v_add_f32 v101, v101, v105
    v_add_f32 v102, v102, v106
    v_add_f32 v103, v103, v107
    ds_swizzle_b32 v104, v100 offset:0x401f
    ds_swizzle_b32 v105, v101 offset:0x401f
    ds_swizzle_b32 v106, v102 offset:0x401f
    ds_swizzle_b32 v107, v103 offset:0x401f
    s_waitcnt lgkmcnt(0)
    v_add_f32 v100, v100, v104
    v_add_f32 v101, v101, v105
    v_add_f32 v102, v102, v106
    v_add_f32 v103, v103, v107
    v_mov_b32 v104, v100
    v_mov_b32 v105, v101
    v_mov_b32 v106, v102
    v_mov_b32 v107, v103
    s_nop 1
    v_permlane32_swap_b32 v100, v104
    v_permlane32_swap_b32 v101, v105
    v_permlane32_swap_b32 v102, v106
    v_permlane32_swap_b32 v103, v107
    s_nop 1
    v_add_f32 v100, v100, v104
    v_cvt_pk_bf16_f32 v100, v100, v100
    v_and_b32 v100, s57, v100
    v_mul_f32 v100, 0xbfb8aa3b, v100
    v_exp_f32 v100, v100
    s_nop 0
    v_add_f32 v100, 1.0, v100
    v_rcp_f32 v100, v100
    s_nop 0
    v_cvt_pk_bf16_f32 v100, v100, v100
    v_and_b32 v120, s57, v100
    v_sub_f32 v121, 1.0, v120
    v_cvt_pk_bf16_f32 v121, v121, v121
    v_and_b32 v121, s57, v121
    v_add_f32 v101, v101, v105
    v_cvt_pk_bf16_f32 v101, v101, v101
    v_and_b32 v101, s57, v101
    v_mul_f32 v101, 0xbfb8aa3b, v101
    v_exp_f32 v101, v101
    s_nop 0
    v_add_f32 v101, 1.0, v101
    v_rcp_f32 v101, v101
    s_nop 0
    v_cvt_pk_bf16_f32 v101, v101, v101
    v_and_b32 v122, s57, v101
    v_sub_f32 v123, 1.0, v122
    v_cvt_pk_bf16_f32 v123, v123, v123
    v_and_b32 v123, s57, v123
    v_add_f32 v102, v102, v106
    v_cvt_pk_bf16_f32 v102, v102, v102
    v_and_b32 v102, s57, v102
    v_mul_f32 v102, 0xbfb8aa3b, v102
    v_exp_f32 v102, v102
    s_nop 0
    v_add_f32 v102, 1.0, v102
    v_rcp_f32 v102, v102
    s_nop 0
    v_cvt_pk_bf16_f32 v102, v102, v102
    v_and_b32 v124, s57, v102
    v_sub_f32 v125, 1.0, v124
    v_cvt_pk_bf16_f32 v125, v125, v125
    v_and_b32 v125, s57, v125
    v_add_f32 v103, v103, v107
    v_cvt_pk_bf16_f32 v103, v103, v103
    v_and_b32 v103, s57, v103
    v_mul_f32 v103, 0xbfb8aa3b, v103
    v_exp_f32 v103, v103
    s_nop 0
    v_add_f32 v103, 1.0, v103
    v_rcp_f32 v103, v103
    s_nop 0
    v_cvt_pk_bf16_f32 v103, v103, v103
    v_and_b32 v126, s57, v103
    v_sub_f32 v127, 1.0, v126
    v_cvt_pk_bf16_f32 v127, v127, v127
    v_and_b32 v127, s57, v127
    s_lshl_b32 s38, s38, 3
    s_add_u32 s38, s38, 7208960
    v_mov_b32 v1, 0
    v_cmp_eq_u32 vcc, 0, v0
    s_and_saveexec_b64 s[42:43], vcc
    buffer_store_dwordx4 v[120:123], v1, s[16:19], s38 offen
    buffer_store_dwordx4 v[124:127], v1, s[16:19], s38 offen offset:16
    s_mov_b64 exec, s[42:43]
L_gm_k1_kernel_hstore:
    s_waitcnt lgkmcnt(0)
    s_barrier
    s_lshl_b32 s47, s36, 6
    v_add_u32 v1, s47, v0
    s_mul_i32 s56, s33, 288
    s_add_u32 s56, s56, 16777216
    s_mul_i32 s57, s37, 9216
    s_add_u32 s56, s56, s57
    s_mov_b32 s57, 9216
    s_mov_b32 s58, 0x38e38e39
    v_add_u32 v2, 0, v1
    v_mul_hi_u32 v3, v2, s58
    v_lshrrev_b32 v3, 2, v3
    v_mul_u32_u24 v4, 18, v3
    v_sub_u32 v4, v2, v4
    v_mul_u32_u24 v5, 304, v3
    v_lshl_add_u32 v5, v4, 4, v5
    ds_read_b128 v[64:67], v5
    v_mul_lo_u32 v3, v3, s57
    v_lshl_add_u32 v50, v4, 4, v3
    v_add_u32 v2, 512, v1
    v_mul_hi_u32 v3, v2, s58
    v_lshrrev_b32 v3, 2, v3
    v_mul_u32_u24 v4, 18, v3
    v_sub_u32 v4, v2, v4
    v_mul_u32_u24 v5, 304, v3
    v_lshl_add_u32 v5, v4, 4, v5
    ds_read_b128 v[68:71], v5
    v_mul_lo_u32 v3, v3, s57
    v_lshl_add_u32 v51, v4, 4, v3
    v_add_u32 v2, 1024, v1
    v_mul_hi_u32 v3, v2, s58
    v_lshrrev_b32 v3, 2, v3
    v_mul_u32_u24 v4, 18, v3
    v_sub_u32 v4, v2, v4
    v_mul_u32_u24 v5, 304, v3
    v_lshl_add_u32 v5, v4, 4, v5
    ds_read_b128 v[72:75], v5
    v_mul_lo_u32 v3, v3, s57
    v_lshl_add_u32 v52, v4, 4, v3
    v_add_u32 v2, 1536, v1
    v_mul_hi_u32 v3, v2, s58
    v_lshrrev_b32 v3, 2, v3
    v_mul_u32_u24 v4, 18, v3
    v_sub_u32 v4, v2, v4
    v_mul_u32_u24 v5, 304, v3
    v_lshl_add_u32 v5, v4, 4, v5
    ds_read_b128 v[76:79], v5
    v_mul_lo_u32 v3, v3, s57
    v_lshl_add_u32 v53, v4, 4, v3
    v_add_u32 v2, 2048, v1
    v_mul_hi_u32 v3, v2, s58
    v_lshrrev_b32 v3, 2, v3
    v_mul_u32_u24 v4, 18, v3
    v_sub_u32 v4, v2, v4
    v_mul_u32_u24 v5, 304, v3
    v_lshl_add_u32 v5, v4, 4, v5
    ds_read_b128 v[80:83], v5
    v_mul_lo_u32 v3, v3, s57
    v_lshl_add_u32 v54, v4, 4, v3
    v_add_u32 v2, 2560, v1
    v_mul_hi_u32 v3, v2, s58
    v_lshrrev_b32 v3, 2, v3
    v_mul_u32_u24 v4, 18, v3
    v_sub_u32 v4, v2, v4
    v_mul_u32_u24 v5, 304, v3
    v_lshl_add_u32 v5, v4, 4, v5
    ds_read_b128 v[84:87], v5
    v_mul_lo_u32 v3, v3, s57
    v_lshl_add_u32 v55, v4, 4, v3
    v_add_u32 v2, 3072, v1
    v_mul_hi_u32 v3, v2, s58
    v_lshrrev_b32 v3, 2, v3
    v_mul_u32_u24 v4, 18, v3
    v_sub_u32 v4, v2, v4
    v_mul_u32_u24 v5, 304, v3
    v_lshl_add_u32 v5, v4, 4, v5
    ds_read_b128 v[88:91], v5
    v_mul_lo_u32 v3, v3, s57
    v_lshl_add_u32 v56, v4, 4, v3
    v_add_u32 v2, 3584, v1
    v_mul_hi_u32 v3, v2, s58
    v_lshrrev_b32 v3, 2, v3
    v_mul_u32_u24 v4, 18, v3
    v_sub_u32 v4, v2, v4
    v_mul_u32_u24 v5, 304, v3
    v_lshl_add_u32 v5, v4, 4, v5
    ds_read_b128 v[92:95], v5
    v_mul_lo_u32 v3, v3, s57
    v_lshl_add_u32 v57, v4, 4, v3
    v_add_u32 v2, 4096, v1
    v_mul_hi_u32 v3, v2, s58
    v_lshrrev_b32 v3, 2, v3
    v_mul_u32_u24 v4, 18, v3
    v_sub_u32 v4, v2, v4
    v_mul_u32_u24 v5, 304, v3
    v_lshl_add_u32 v5, v4, 4, v5
    ds_read_b128 v[96:99], v5
    v_mul_lo_u32 v3, v3, s57
    v_lshl_add_u32 v58, v4, 4, v3
    s_waitcnt lgkmcnt(8)
    buffer_store_dwordx4 v[64:67], v50, s[16:19], s56 offen
    s_waitcnt lgkmcnt(7)
    buffer_store_dwordx4 v[68:71], v51, s[16:19], s56 offen
    s_waitcnt lgkmcnt(6)
    buffer_store_dwordx4 v[72:75], v52, s[16:19], s56 offen
    s_waitcnt lgkmcnt(5)
    buffer_store_dwordx4 v[76:79], v53, s[16:19], s56 offen
    s_waitcnt lgkmcnt(4)
    buffer_store_dwordx4 v[80:83], v54, s[16:19], s56 offen
    s_waitcnt lgkmcnt(3)
    buffer_store_dwordx4 v[84:87], v55, s[16:19], s56 offen
    s_waitcnt lgkmcnt(2)
    buffer_store_dwordx4 v[88:91], v56, s[16:19], s56 offen
    s_waitcnt lgkmcnt(1)
    buffer_store_dwordx4 v[92:95], v57, s[16:19], s56 offen
    s_waitcnt lgkmcnt(0)
    buffer_store_dwordx4 v[96:99], v58, s[16:19], s56 offen
L_gm_k1_kernel_end:
    s_endpgm
.section .rodata,"a"
.p2align 6
.amdhsa_kernel gm_k1_kernel
  .amdhsa_next_free_vgpr 256
  .amdhsa_next_free_sgpr 102
  .amdhsa_accum_offset 256
  .amdhsa_group_segment_fixed_size 0
  .amdhsa_kernarg_size 88
  .amdhsa_user_sgpr_count 2
  .amdhsa_user_sgpr_kernarg_segment_ptr 1
  .amdhsa_system_sgpr_workgroup_id_x 1
.end_amdhsa_kernel
.text
.globl gm_k2_kernel
.p2align 8
.type gm_k2_kernel,@function
gm_k2_kernel:
    s_cmp_ge_u32 s2, 400
    s_cbranch_scc1 L_gm_k2_kernel_end
    v_lshrrev_b32 v1, 6, v0
    v_and_b32 v0, 63, v0
    s_nop 0
    v_readfirstlane_b32 s36, v1
    s_cmp_lt_u32 s2, 256
    s_cbranch_scc0 L_gm_k2_kernel_gemm
    s_load_dwordx2 s[24:25], s[0:1], 80
    s_and_b32 s32, s2, 31
    s_lshr_b32 s33, s2, 5
    v_lshlrev_b32 v1, 4, v0
    s_waitcnt lgkmcnt(0)
    s_mov_b32 s4, s24
    s_and_b32 s5, s25, 0xffff
    s_mov_b32 s6, 268435456
    s_mov_b32 s7, 0x20000
    s_add_u32 s60, s36, 0
    s_lshl_b32 s61, s32, 16
    s_add_u32 s61, s61, 2097152
    s_lshl_b32 s62, s36, 10
    s_add_u32 s40, s61, s62
    s_mov_b32 s46, 8192
    s_add_u32 s52, s62, 0
    s_add_u32 s60, s36, 8
    s_lshl_b32 s61, s32, 16
    s_add_u32 s61, s61, 2129920
    s_lshl_b32 s62, s36, 10
    s_add_u32 s41, s61, s62
    s_mov_b32 s47, 8192
    s_add_u32 s53, s62, 8192
    s_add_u32 s60, s36, 16
    s_sub_u32 s60, s60, 16
    s_mul_i32 s61, s32, 73728
    s_add_u32 s61, s61, 4718592
    s_lshl_b32 s62, s60, 12
    s_add_u32 s42, s61, s62
    s_mov_b32 s48, 1024
    s_mul_i32 s54, s60, 1040
    s_add_u32 s54, s54, 16384
    s_add_u32 s60, s36, 24
    s_sub_u32 s60, s60, 16
    s_mul_i32 s61, s32, 73728
    s_add_u32 s61, s61, 4718592
    s_lshl_b32 s62, s60, 12
    s_add_u32 s43, s61, s62
    s_mov_b32 s49, 1024
    s_mul_i32 s55, s60, 1040
    s_add_u32 s55, s55, 16384
    s_add_u32 s60, s36, 32
    s_mul_i32 s61, s32, 73728
    s_add_u32 s61, s61, 4784128
    s_lshl_b32 s62, s36, 12
    s_add_u32 s61, s61, s62
    s_mul_i32 s63, s36, 1040
    s_add_u32 s63, s63, 33024
    s_lshl_b32 s64, s32, 13
    s_add_u32 s64, s64, 4454400
    s_lshl_b32 s62, s36, 10
    s_add_u32 s64, s64, s62
    s_add_u32 s65, s62, 34096
    s_cmp_lt_u32 s36, 2
    s_cselect_b32 s44, s61, s64
    s_cselect_b32 s56, s63, s65
    s_mov_b32 s66, 1024
    s_cselect_b32 s50, s66, 2048
    s_cmp_lt_u32 s36, 4
    s_cselect_b32 s56, s56, 83968
    s_setprio 2
    v_and_b32 v2, 31, v0
    s_lshl_b32 s60, s33, 8
    s_lshl_b32 s61, s36, 5
    s_add_u32 s60, s60, s61
    v_add_u32 v2, s60, v2
    v_lshrrev_b32 v3, 5, v0
    v_lshlrev_b32 v4, 4, v2
    v_lshl_add_u32 v4, v3, 15, v4
    s_lshl_b32 s60, s32, 16
    s_add_u32 s60, s60, 0
    buffer_load_dwordx4 v[8:11], v4, s[4:7], s60 offen
    v_lshlrev_b32 v4, 2, v2
    s_lshl_b32 s60, s32, 13
    s_add_u32 s60, s60, 4194304
    buffer_load_dword v12, v4, s[4:7], s60 offen
    s_add_u32 m0, s52, 0
    s_nop 0
    buffer_load_dwordx4 v1, s[4:7], s40 offen lds
    s_add_u32 s40, s40, s46
    s_add_u32 m0, s53, 0
    s_nop 0
    buffer_load_dwordx4 v1, s[4:7], s41 offen lds
    s_add_u32 s41, s41, s47
    s_add_u32 m0, s54, 0
    s_nop 0
    buffer_load_dwordx4 v1, s[4:7], s42 offen lds
    s_add_u32 s42, s42, s48
    s_add_u32 m0, s55, 0
    s_nop 0
    buffer_load_dwordx4 v1, s[4:7], s43 offen lds
    s_add_u32 s43, s43, s49
    s_add_u32 m0, s56, 0
    s_nop 0
    buffer_load_dwordx4 v1, s[4:7], s44 offen lds
    s_add_u32 s44, s44, s50
    s_add_u32 m0, s52, 38192
    s_nop 0
    buffer_load_dwordx4 v1, s[4:7], s40 offen lds
    s_add_u32 s40, s40, s46
    s_add_u32 m0, s53, 38192
    s_nop 0
    buffer_load_dwordx4 v1, s[4:7], s41 offen lds
    s_add_u32 s41, s41, s47
    s_add_u32 m0, s54, 38192
    s_nop 0
    buffer_load_dwordx4 v1, s[4:7], s42 offen lds
    s_add_u32 s42, s42, s48
    s_add_u32 m0, s55, 38192
    s_nop 0
    buffer_load_dwordx4 v1, s[4:7], s43 offen lds
    s_add_u32 s43, s43, s49
    s_add_u32 m0, s56, 38192
    s_nop 0
    buffer_load_dwordx4 v1, s[4:7], s44 offen lds
    s_add_u32 s44, s44, s50
    v_mov_b32 v13, 0
    v_mov_b32 v14, 0
    v_mov_b32 v15, 0
    v_mov_b32 v110, 0x3f803f80
    v_mov_b32 v111, 0x3f803f80
    s_and_b32 s60, s36, 1
    s_lshl_b32 s60, s60, 9
    s_lshr_b32 s61, s36, 1
    s_and_b32 s61, s61, 1
    s_mul_i32 s61, s61, 38192
    s_add_u32 s60, s60, s61
    v_lshlrev_b32 v4, 3, v0
    v_add_u32 v4, s60, v4
    v_add_u32 v4, 35104, v4
    ds_write_b64 v4, v[110:111]
    v_and_b32 v4, 31, v0
    v_lshlrev_b32 v5, 4, v4
    v_lshl_add_u32 v5, v3, 13, v5
    v_lshlrev_b32 v6, 2, v4
    v_add_u32 v6, 36144, v6
    v_min_u32 v7, 18, v4
    v_mul_u32_u24 v7, 1040, v7
    v_lshl_add_u32 v7, v3, 4, v7
    v_add_u32 v7, 16384, v7
    v_add_u32 v120, 38192, v5
    v_add_u32 v121, 38192, v6
    v_add_u32 v122, 38192, v7
    v_mov_b32 v21, 0
    v_mov_b32 v22, 0
    v_mov_b32 v23, 0
    v_mov_b32 v72, 0
    v_mov_b32 v73, 0
    v_mov_b32 v74, 0
    v_mov_b32 v75, 0
    v_mov_b32 v76, 0
    v_mov_b32 v77, 0
    v_mov_b32 v78, 0
    v_mov_b32 v79, 0
    v_mov_b32 v80, 0
    v_mov_b32 v81, 0
    v_mov_b32 v82, 0
    v_mov_b32 v83, 0
    v_mov_b32 v84, 0
    v_mov_b32 v85, 0
    v_mov_b32 v86, 0
    v_mov_b32 v87, 0
    v_mov_b32 v64, 0
    v_mov_b32 v65, 0
    v_mov_b32 v66, 0
    v_mov_b32 v67, 0
    v_mov_b32 v68, 0
    v_mov_b32 v69, 0
    v_mov_b32 v70, 0
    v_mov_b32 v71, 0
    s_waitcnt vmcnt(5) lgkmcnt(0)
    v_cmp_gt_u32 vcc, 32, v0
    s_nop 1
    v_cndmask_b32 v12, 0, v12, vcc
    s_barrier
    ds_read_b128 v[16:19], v5 offset:0
    ds_read_b32 v20, v6 offset:0
    s_waitcnt lgkmcnt(0)
    v_mfma_f32_32x32x16_bf16 v[32:47], v[16:19], v[8:11], 0
    v_mfma_f32_32x32x16_bf16 v[32:47], v[20:23], v[12:15], v[32:47]
    ds_read_b128 v[24:27], v7 offset:0
    ds_read_b128 v[28:31], v7 offset:32
    ds_read_b128 v[16:19], v5 offset:512
    ds_read_b32 v20, v6 offset:128
    s_nop 15
    v_max3_f32 v104, v32, v33, v34
    v_max3_f32 v104, v35, v36, v104
    v_max3_f32 v104, v37, v38, v104
    v_max3_f32 v104, v39, v40, v104
    v_max3_f32 v104, v41, v42, v104
    v_max3_f32 v104, v43, v44, v104
    v_max3_f32 v104, v45, v46, v104
    v_max_f32 v104, v47, v104
    v_mov_b32 v105, v104
    s_nop 1
    v_permlane32_swap_b32 v104, v105
    s_nop 1
    v_max_f32 v104, v104, v105
    v_sub_f32 v32, v32, v104
    v_sub_f32 v33, v33, v104
    v_sub_f32 v34, v34, v104
    v_sub_f32 v35, v35, v104
    v_sub_f32 v36, v36, v104
    v_sub_f32 v37, v37, v104
    v_sub_f32 v38, v38, v104
    v_sub_f32 v39, v39, v104
    v_sub_f32 v40, v40, v104
    v_sub_f32 v41, v41, v104
    v_sub_f32 v42, v42, v104
    v_sub_f32 v43, v43, v104
    v_sub_f32 v44, v44, v104
    v_sub_f32 v45, v45, v104
    v_sub_f32 v46, v46, v104
    v_sub_f32 v47, v47, v104
    v_sub_f32 v88, 0, v104
    v_sub_f32 v89, 0, v104
    v_sub_f32 v90, 0, v104
    v_sub_f32 v91, 0, v104
    v_sub_f32 v92, 0, v104
    v_sub_f32 v93, 0, v104
    v_sub_f32 v94, 0, v104
    v_sub_f32 v95, 0, v104
    v_sub_f32 v96, 0, v104
    v_sub_f32 v97, 0, v104
    v_sub_f32 v98, 0, v104
    v_sub_f32 v99, 0, v104
    v_sub_f32 v100, 0, v104
    v_sub_f32 v101, 0, v104
    v_sub_f32 v102, 0, v104
    v_sub_f32 v103, 0, v104
    s_mov_b32 s58, 0
    s_mov_b32 s59, 0
L_gm_k2_kernel_loop:
    s_waitcnt lgkmcnt(2)
    v_mfma_f32_32x32x16_bf16 v[72:87], v[24:27], v[64:67], v[72:87]
    v_max3_f32 v104, v32, v33, v34
    v_max3_f32 v104, v35, v36, v104
    v_max3_f32 v104, v37, v38, v104
    v_max3_f32 v104, v39, v40, v104
    v_mfma_f32_32x32x16_bf16 v[72:87], v[28:31], v[68:71], v[72:87]
    v_max3_f32 v104, v41, v42, v104
    v_max3_f32 v104, v43, v44, v104
    v_max3_f32 v104, v45, v46, v104
    v_max_f32 v104, v47, v104
    ds_read_b128 v[24:27], v7 offset:0
    ds_read_b128 v[28:31], v7 offset:32
    v_cmp_lt_f32 vcc, 0x41000000, v104
    s_cbranch_vccnz L_gm_k2_kernel_rs0
L_gm_k2_kernel_ct0:
    s_waitcnt lgkmcnt(2)
    v_mfma_f32_32x32x16_bf16 v[48:63], v[16:19], v[8:11], v[88:103]
    v_exp_f32 v32, v32
    v_exp_f32 v33, v33
    v_exp_f32 v34, v34
    v_exp_f32 v35, v35
    v_exp_f32 v36, v36
    v_exp_f32 v37, v37
    v_exp_f32 v38, v38
    v_exp_f32 v39, v39
    v_mfma_f32_32x32x16_bf16 v[48:63], v[20:23], v[12:15], v[48:63]
    v_exp_f32 v40, v40
    v_exp_f32 v41, v41
    v_exp_f32 v42, v42
    v_exp_f32 v43, v43
    v_exp_f32 v44, v44
    v_exp_f32 v45, v45
    v_exp_f32 v46, v46
    v_exp_f32 v47, v47
    ds_read_b128 v[16:19], v5 offset:1024
    ds_read_b32 v20, v6 offset:256
    v_cvt_pk_bf16_f32 v64, v32, v33
    v_cvt_pk_bf16_f32 v65, v34, v35
    v_cvt_pk_bf16_f32 v66, v36, v37
    v_cvt_pk_bf16_f32 v67, v38, v39
    v_cvt_pk_bf16_f32 v68, v40, v41
    v_cvt_pk_bf16_f32 v69, v42, v43
    v_cvt_pk_bf16_f32 v70, v44, v45
    v_cvt_pk_bf16_f32 v71, v46, v47
    s_waitcnt lgkmcnt(2)
    v_mfma_f32_32x32x16_bf16 v[72:87], v[24:27], v[64:67], v[72:87]
    v_max3_f32 v104, v48, v49, v50
    v_max3_f32 v104, v51, v52, v104
    v_max3_f32 v104, v53, v54, v104
    v_max3_f32 v104, v55, v56, v104
    v_mfma_f32_32x32x16_bf16 v[72:87], v[28:31], v[68:71], v[72:87]
    v_max3_f32 v104, v57, v58, v104
    v_max3_f32 v104, v59, v60, v104
    v_max3_f32 v104, v61, v62, v104
    v_max_f32 v104, v63, v104
    ds_read_b128 v[24:27], v7 offset:64
    ds_read_b128 v[28:31], v7 offset:96
    v_cmp_lt_f32 vcc, 0x41000000, v104
    s_cbranch_vccnz L_gm_k2_kernel_rs1
L_gm_k2_kernel_ct1:
    s_waitcnt lgkmcnt(2)
    v_mfma_f32_32x32x16_bf16 v[32:47], v[16:19], v[8:11], v[88:103]
    v_exp_f32 v48, v48
    v_exp_f32 v49, v49
    v_exp_f32 v50, v50
    v_exp_f32 v51, v51
    v_exp_f32 v52, v52
    v_exp_f32 v53, v53
    v_exp_f32 v54, v54
    v_exp_f32 v55, v55
    v_mfma_f32_32x32x16_bf16 v[32:47], v[20:23], v[12:15], v[32:47]
    v_exp_f32 v56, v56
    v_exp_f32 v57, v57
    v_exp_f32 v58, v58
    v_exp_f32 v59, v59
    v_exp_f32 v60, v60
    v_exp_f32 v61, v61
    v_exp_f32 v62, v62
    v_exp_f32 v63, v63
    ds_read_b128 v[16:19], v5 offset:1536
    ds_read_b32 v20, v6 offset:384
    v_cvt_pk_bf16_f32 v64, v48, v49
    v_cvt_pk_bf16_f32 v65, v50, v51
    v_cvt_pk_bf16_f32 v66, v52, v53
    v_cvt_pk_bf16_f32 v67, v54, v55
    v_cvt_pk_bf16_f32 v68, v56, v57
    v_cvt_pk_bf16_f32 v69, v58, v59
    v_cvt_pk_bf16_f32 v70, v60, v61
    v_cvt_pk_bf16_f32 v71, v62, v63
    s_barrier
    s_cmp_eq_u32 s58, 0
    s_cbranch_scc1 L_gm_k2_kernel_nf
    s_cmp_eq_u32 s58, 3
    s_cbranch_scc1 L_gm_k2_kernel_nf
    s_add_u32 m0, s52, s59
    s_nop 0
    buffer_load_dwordx4 v1, s[4:7], s40 offen lds
    s_add_u32 s40, s40, s46
    s_add_u32 m0, s53, s59
    s_nop 0
    buffer_load_dwordx4 v1, s[4:7], s41 offen lds
    s_add_u32 s41, s41, s47
    s_add_u32 m0, s54, s59
    s_nop 0
    buffer_load_dwordx4 v1, s[4:7], s42 offen lds
    s_add_u32 s42, s42, s48
    s_add_u32 m0, s55, s59
    s_nop 0
    buffer_load_dwordx4 v1, s[4:7], s43 offen lds
    s_add_u32 s43, s43, s49
    s_add_u32 m0, s56, s59
    s_nop 0
    buffer_load_dwordx4 v1, s[4:7], s44 offen lds
    s_add_u32 s44, s44, s50
L_gm_k2_kernel_nf:
    s_waitcnt lgkmcnt(2)
    v_mfma_f32_32x32x16_bf16 v[72:87], v[24:27], v[64:67], v[72:87]
    v_max3_f32 v104, v32, v33, v34
    v_max3_f32 v104, v35, v36, v104
    v_max3_f32 v104, v37, v38, v104
    v_max3_f32 v104, v39, v40, v104
    v_mfma_f32_32x32x16_bf16 v[72:87], v[28:31], v[68:71], v[72:87]
    v_max3_f32 v104, v41, v42, v104
    v_max3_f32 v104, v43, v44, v104
    v_max3_f32 v104, v45, v46, v104
    v_max_f32 v104, v47, v104
    ds_read_b128 v[24:27], v7 offset:128
    ds_read_b128 v[28:31], v7 offset:160
    v_cmp_lt_f32 vcc, 0x41000000, v104
    s_cbranch_vccnz L_gm_k2_kernel_rs2
L_gm_k2_kernel_ct2:
    s_waitcnt lgkmcnt(2)
    v_mfma_f32_32x32x16_bf16 v[48:63], v[16:19], v[8:11], v[88:103]
    v_exp_f32 v32, v32
    v_exp_f32 v33, v33
    v_exp_f32 v34, v34
    v_exp_f32 v35, v35
    v_exp_f32 v36, v36
    v_exp_f32 v37, v37
    v_exp_f32 v38, v38
    v_exp_f32 v39, v39
    v_mfma_f32_32x32x16_bf16 v[48:63], v[20:23], v[12:15], v[48:63]
    v_exp_f32 v40, v40
    v_exp_f32 v41, v41
    v_exp_f32 v42, v42
    v_exp_f32 v43, v43
    v_exp_f32 v44, v44
    v_exp_f32 v45, v45
    v_exp_f32 v46, v46
    v_exp_f32 v47, v47
    ds_read_b128 v[16:19], v5 offset:2048
    ds_read_b32 v20, v6 offset:512
    v_cvt_pk_bf16_f32 v64, v32, v33
    v_cvt_pk_bf16_f32 v65, v34, v35
    v_cvt_pk_bf16_f32 v66, v36, v37
    v_cvt_pk_bf16_f32 v67, v38, v39
    v_cvt_pk_bf16_f32 v68, v40, v41
    v_cvt_pk_bf16_f32 v69, v42, v43
    v_cvt_pk_bf16_f32 v70, v44, v45
    v_cvt_pk_bf16_f32 v71, v46, v47
    s_waitcnt lgkmcnt(2)
    v_mfma_f32_32x32x16_bf16 v[72:87], v[24:27], v[64:67], v[72:87]
    v_max3_f32 v104, v48, v49, v50
    v_max3_f32 v104, v51, v52, v104
    v_max3_f32 v104, v53, v54, v104
    v_max3_f32 v104, v55, v56, v104
    v_mfma_f32_32x32x16_bf16 v[72:87], v[28:31], v[68:71], v[72:87]
    v_max3_f32 v104, v57, v58, v104
    v_max3_f32 v104, v59, v60, v104
    v_max3_f32 v104, v61, v62, v104
    v_max_f32 v104, v63, v104
    ds_read_b128 v[24:27], v7 offset:192
    ds_read_b128 v[28:31], v7 offset:224
    v_cmp_lt_f32 vcc, 0x41000000, v104
    s_cbranch_vccnz L_gm_k2_kernel_rs3
L_gm_k2_kernel_ct3:
    s_waitcnt lgkmcnt(2)
    v_mfma_f32_32x32x16_bf16 v[32:47], v[16:19], v[8:11], v[88:103]
    v_exp_f32 v48, v48
    v_exp_f32 v49, v49
    v_exp_f32 v50, v50
    v_exp_f32 v51, v51
    v_exp_f32 v52, v52
    v_exp_f32 v53, v53
    v_exp_f32 v54, v54
    v_exp_f32 v55, v55
    v_mfma_f32_32x32x16_bf16 v[32:47], v[20:23], v[12:15], v[32:47]
    v_exp_f32 v56, v56
    v_exp_f32 v57, v57
    v_exp_f32 v58, v58
    v_exp_f32 v59, v59
    v_exp_f32 v60, v60
    v_exp_f32 v61, v61
    v_exp_f32 v62, v62
    v_exp_f32 v63, v63
    ds_read_b128 v[16:19], v5 offset:2560
    ds_read_b32 v20, v6 offset:640
    v_cvt_pk_bf16_f32 v64, v48, v49
    v_cvt_pk_bf16_f32 v65, v50, v51
    v_cvt_pk_bf16_f32 v66, v52, v53
    v_cvt_pk_bf16_f32 v67, v54, v55
    v_cvt_pk_bf16_f32 v68, v56, v57
    v_cvt_pk_bf16_f32 v69, v58, v59
    v_cvt_pk_bf16_f32 v70, v60, v61
    v_cvt_pk_bf16_f32 v71, v62, v63
    s_waitcnt lgkmcnt(2)
    v_mfma_f32_32x32x16_bf16 v[72:87], v[24:27], v[64:67], v[72:87]
    v_max3_f32 v104, v32, v33, v34
    v_max3_f32 v104, v35, v36, v104
    v_max3_f32 v104, v37, v38, v104
    v_max3_f32 v104, v39, v40, v104
    v_mfma_f32_32x32x16_bf16 v[72:87], v[28:31], v[68:71], v[72:87]
    v_max3_f32 v104, v41, v42, v104
    v_max3_f32 v104, v43, v44, v104
    v_max3_f32 v104, v45, v46, v104
    v_max_f32 v104, v47, v104
    ds_read_b128 v[24:27], v7 offset:256
    ds_read_b128 v[28:31], v7 offset:288
    v_cmp_lt_f32 vcc, 0x41000000, v104
    s_cbranch_vccnz L_gm_k2_kernel_rs4
L_gm_k2_kernel_ct4:
    s_waitcnt lgkmcnt(2)
    v_mfma_f32_32x32x16_bf16 v[48:63], v[16:19], v[8:11], v[88:103]
    v_exp_f32 v32, v32
    v_exp_f32 v33, v33
    v_exp_f32 v34, v34
    v_exp_f32 v35, v35
    v_exp_f32 v36, v36
    v_exp_f32 v37, v37
    v_exp_f32 v38, v38
    v_exp_f32 v39, v39
    v_mfma_f32_32x32x16_bf16 v[48:63], v[20:23], v[12:15], v[48:63]
    v_exp_f32 v40, v40
    v_exp_f32 v41, v41
    v_exp_f32 v42, v42
    v_exp_f32 v43, v43
    v_exp_f32 v44, v44
    v_exp_f32 v45, v45
    v_exp_f32 v46, v46
    v_exp_f32 v47, v47
    ds_read_b128 v[16:19], v5 offset:3072
    ds_read_b32 v20, v6 offset:768
    v_cvt_pk_bf16_f32 v64, v32, v33
    v_cvt_pk_bf16_f32 v65, v34, v35
    v_cvt_pk_bf16_f32 v66, v36, v37
    v_cvt_pk_bf16_f32 v67, v38, v39
    v_cvt_pk_bf16_f32 v68, v40, v41
    v_cvt_pk_bf16_f32 v69, v42, v43
    v_cvt_pk_bf16_f32 v70, v44, v45
    v_cvt_pk_bf16_f32 v71, v46, v47
    s_waitcnt lgkmcnt(2)
    v_mfma_f32_32x32x16_bf16 v[72:87], v[24:27], v[64:67], v[72:87]
    v_max3_f32 v104, v48, v49, v50
    v_max3_f32 v104, v51, v52, v104
    v_max3_f32 v104, v53, v54, v104
    v_max3_f32 v104, v55, v56, v104
    v_mfma_f32_32x32x16_bf16 v[72:87], v[28:31], v[68:71], v[72:87]
    v_max3_f32 v104, v57, v58, v104
    v_max3_f32 v104, v59, v60, v104
    v_max3_f32 v104, v61, v62, v104
    v_max_f32 v104, v63, v104
    ds_read_b128 v[24:27], v7 offset:320
    ds_read_b128 v[28:31], v7 offset:352
    v_cmp_lt_f32 vcc, 0x41000000, v104
    s_cbranch_vccnz L_gm_k2_kernel_rs5
L_gm_k2_kernel_ct5:
    s_waitcnt lgkmcnt(2)
    v_mfma_f32_32x32x16_bf16 v[32:47], v[16:19], v[8:11], v[88:103]
    v_exp_f32 v48, v48
    v_exp_f32 v49, v49
    v_exp_f32 v50, v50
    v_exp_f32 v51, v51
    v_exp_f32 v52, v52
    v_exp_f32 v53, v53
    v_exp_f32 v54, v54
    v_exp_f32 v55, v55
    v_mfma_f32_32x32x16_bf16 v[32:47], v[20:23], v[12:15], v[32:47]
    v_exp_f32 v56, v56
    v_exp_f32 v57, v57
    v_exp_f32 v58, v58
    v_exp_f32 v59, v59
    v_exp_f32 v60, v60
    v_exp_f32 v61, v61
    v_exp_f32 v62, v62
    v_exp_f32 v63, v63
    ds_read_b128 v[16:19], v5 offset:3584
    ds_read_b32 v20, v6 offset:896
    v_cvt_pk_bf16_f32 v64, v48, v49
    v_cvt_pk_bf16_f32 v65, v50, v51
    v_cvt_pk_bf16_f32 v66, v52, v53
    v_cvt_pk_bf16_f32 v67, v54, v55
    v_cvt_pk_bf16_f32 v68, v56, v57
    v_cvt_pk_bf16_f32 v69, v58, v59
    v_cvt_pk_bf16_f32 v70, v60, v61
    v_cvt_pk_bf16_f32 v71, v62, v63
    s_waitcnt lgkmcnt(2)
    v_mfma_f32_32x32x16_bf16 v[72:87], v[24:27], v[64:67], v[72:87]
    v_max3_f32 v104, v32, v33, v34
    v_max3_f32 v104, v35, v36, v104
    v_max3_f32 v104, v37, v38, v104
    v_max3_f32 v104, v39, v40, v104
    v_mfma_f32_32x32x16_bf16 v[72:87], v[28:31], v[68:71], v[72:87]
    v_max3_f32 v104, v41, v42, v104
    v_max3_f32 v104, v43, v44, v104
    v_max3_f32 v104, v45, v46, v104
    v_max_f32 v104, v47, v104
    ds_read_b128 v[24:27], v7 offset:384
    ds_read_b128 v[28:31], v7 offset:416
    v_cmp_lt_f32 vcc, 0x41000000, v104
    s_cbranch_vccnz L_gm_k2_kernel_rs6
L_gm_k2_kernel_ct6:
    s_waitcnt lgkmcnt(2)
    v_mfma_f32_32x32x16_bf16 v[48:63], v[16:19], v[8:11], v[88:103]
    v_exp_f32 v32, v32
    v_exp_f32 v33, v33
    v_exp_f32 v34, v34
    v_exp_f32 v35, v35
    v_exp_f32 v36, v36
    v_exp_f32 v37, v37
    v_exp_f32 v38, v38
    v_exp_f32 v39, v39
    v_mfma_f32_32x32x16_bf16 v[48:63], v[20:23], v[12:15], v[48:63]
    v_exp_f32 v40, v40
    v_exp_f32 v41, v41
    v_exp_f32 v42, v42
    v_exp_f32 v43, v43
    v_exp_f32 v44, v44
    v_exp_f32 v45, v45
    v_exp_f32 v46, v46
    v_exp_f32 v47, v47
    ds_read_b128 v[16:19], v5 offset:4096
    ds_read_b32 v20, v6 offset:1024
    v_cvt_pk_bf16_f32 v64, v32, v33
    v_cvt_pk_bf16_f32 v65, v34, v35
    v_cvt_pk_bf16_f32 v66, v36, v37
    v_cvt_pk_bf16_f32 v67, v38, v39
    v_cvt_pk_bf16_f32 v68, v40, v41
    v_cvt_pk_bf16_f32 v69, v42, v43
    v_cvt_pk_bf16_f32 v70, v44, v45
    v_cvt_pk_bf16_f32 v71, v46, v47
    s_waitcnt lgkmcnt(2)
    v_mfma_f32_32x32x16_bf16 v[72:87], v[24:27], v[64:67], v[72:87]
    v_max3_f32 v104, v48, v49, v50
    v_max3_f32 v104, v51, v52, v104
    v_max3_f32 v104, v53, v54, v104
    v_max3_f32 v104, v55, v56, v104
    v_mfma_f32_32x32x16_bf16 v[72:87], v[28:31], v[68:71], v[72:87]
    v_max3_f32 v104, v57, v58, v104
    v_max3_f32 v104, v59, v60, v104
    v_max3_f32 v104, v61, v62, v104
    v_max_f32 v104, v63, v104
    ds_read_b128 v[24:27], v7 offset:448
    ds_read_b128 v[28:31], v7 offset:480
    v_cmp_lt_f32 vcc, 0x41000000, v104
    s_cbranch_vccnz L_gm_k2_kernel_rs7
L_gm_k2_kernel_ct7:
    s_waitcnt lgkmcnt(2)
    v_mfma_f32_32x32x16_bf16 v[32:47], v[16:19], v[8:11], v[88:103]
    v_exp_f32 v48, v48
    v_exp_f32 v49, v49
    v_exp_f32 v50, v50
    v_exp_f32 v51, v51
    v_exp_f32 v52, v52
    v_exp_f32 v53, v53
    v_exp_f32 v54, v54
    v_exp_f32 v55, v55
    v_mfma_f32_32x32x16_bf16 v[32:47], v[20:23], v[12:15], v[32:47]
    v_exp_f32 v56, v56
    v_exp_f32 v57, v57
    v_exp_f32 v58, v58
    v_exp_f32 v59, v59
    v_exp_f32 v60, v60
    v_exp_f32 v61, v61
    v_exp_f32 v62, v62
    v_exp_f32 v63, v63
    ds_read_b128 v[16:19], v5 offset:4608
    ds_read_b32 v20, v6 offset:1152
    v_cvt_pk_bf16_f32 v64, v48, v49
    v_cvt_pk_bf16_f32 v65, v50, v51
    v_cvt_pk_bf16_f32 v66, v52, v53
    v_cvt_pk_bf16_f32 v67, v54, v55
    v_cvt_pk_bf16_f32 v68, v56, v57
    v_cvt_pk_bf16_f32 v69, v58, v59
    v_cvt_pk_bf16_f32 v70, v60, v61
    v_cvt_pk_bf16_f32 v71, v62, v63
    s_waitcnt lgkmcnt(2)
    v_mfma_f32_32x32x16_bf16 v[72:87], v[24:27], v[64:67], v[72:87]
    v_max3_f32 v104, v32, v33, v34
    v_max3_f32 v104, v35, v36, v104
    v_max3_f32 v104, v37, v38, v104
    v_max3_f32 v104, v39, v40, v104
    v_mfma_f32_32x32x16_bf16 v[72:87], v[28:31], v[68:71], v[72:87]
    v_max3_f32 v104, v41, v42, v104
    v_max3_f32 v104, v43, v44, v104
    v_max3_f32 v104, v45, v46, v104
    v_max_f32 v104, v47, v104
    ds_read_b128 v[24:27], v7 offset:512
    ds_read_b128 v[28:31], v7 offset:544
    v_cmp_lt_f32 vcc, 0x41000000, v104
    s_cbranch_vccnz L_gm_k2_kernel_rs8
L_gm_k2_kernel_ct8:
    s_waitcnt lgkmcnt(2)
    v_mfma_f32_32x32x16_bf16 v[48:63], v[16:19], v[8:11], v[88:103]
    v_exp_f32 v32, v32
    v_exp_f32 v33, v33
    v_exp_f32 v34, v34
    v_exp_f32 v35, v35
    v_exp_f32 v36, v36
    v_exp_f32 v37, v37
    v_exp_f32 v38, v38
    v_exp_f32 v39, v39
    v_mfma_f32_32x32x16_bf16 v[48:63], v[20:23], v[12:15], v[48:63]
    v_exp_f32 v40, v40
    v_exp_f32 v41, v41
    v_exp_f32 v42, v42
    v_exp_f32 v43, v43
    v_exp_f32 v44, v44
    v_exp_f32 v45, v45
    v_exp_f32 v46, v46
    v_exp_f32 v47, v47
    ds_read_b128 v[16:19], v5 offset:5120
    ds_read_b32 v20, v6 offset:1280
    v_cvt_pk_bf16_f32 v64, v32, v33
    v_cvt_pk_bf16_f32 v65, v34, v35
    v_cvt_pk_bf16_f32 v66, v36, v37
    v_cvt_pk_bf16_f32 v67, v38, v39
    v_cvt_pk_bf16_f32 v68, v40, v41
    v_cvt_pk_bf16_f32 v69, v42, v43
    v_cvt_pk_bf16_f32 v70, v44, v45
    v_cvt_pk_bf16_f32 v71, v46, v47
    s_waitcnt lgkmcnt(2)
    v_mfma_f32_32x32x16_bf16 v[72:87], v[24:27], v[64:67], v[72:87]
    v_max3_f32 v104, v48, v49, v50
    v_max3_f32 v104, v51, v52, v104
    v_max3_f32 v104, v53, v54, v104
    v_max3_f32 v104, v55, v56, v104
    v_mfma_f32_32x32x16_bf16 v[72:87], v[28:31], v[68:71], v[72:87]
    v_max3_f32 v104, v57, v58, v104
    v_max3_f32 v104, v59, v60, v104
    v_max3_f32 v104, v61, v62, v104
    v_max_f32 v104, v63, v104
    ds_read_b128 v[24:27], v7 offset:576
    ds_read_b128 v[28:31], v7 offset:608
    v_cmp_lt_f32 vcc, 0x41000000, v104
    s_cbranch_vccnz L_gm_k2_kernel_rs9
L_gm_k2_kernel_ct9:
    s_waitcnt lgkmcnt(2)
    v_mfma_f32_32x32x16_bf16 v[32:47], v[16:19], v[8:11], v[88:103]
    v_exp_f32 v48, v48
    v_exp_f32 v49, v49
    v_exp_f32 v50, v50
    v_exp_f32 v51, v51
    v_exp_f32 v52, v52
    v_exp_f32 v53, v53
    v_exp_f32 v54, v54
    v_exp_f32 v55, v55
    v_mfma_f32_32x32x16_bf16 v[32:47], v[20:23], v[12:15], v[32:47]
    v_exp_f32 v56, v56
    v_exp_f32 v57, v57
    v_exp_f32 v58, v58
    v_exp_f32 v59, v59
    v_exp_f32 v60, v60
    v_exp_f32 v61, v61
    v_exp_f32 v62, v62
    v_exp_f32 v63, v63
    ds_read_b128 v[16:19], v5 offset:5632
    ds_read_b32 v20, v6 offset:1408
    v_cvt_pk_bf16_f32 v64, v48, v49
    v_cvt_pk_bf16_f32 v65, v50, v51
    v_cvt_pk_bf16_f32 v66, v52, v53
    v_cvt_pk_bf16_f32 v67, v54, v55
    v_cvt_pk_bf16_f32 v68, v56, v57
    v_cvt_pk_bf16_f32 v69, v58, v59
    v_cvt_pk_bf16_f32 v70, v60, v61
    v_cvt_pk_bf16_f32 v71, v62, v63
    s_waitcnt lgkmcnt(2)
    v_mfma_f32_32x32x16_bf16 v[72:87], v[24:27], v[64:67], v[72:87]
    v_max3_f32 v104, v32, v33, v34
    v_max3_f32 v104, v35, v36, v104
    v_max3_f32 v104, v37, v38, v104
    v_max3_f32 v104, v39, v40, v104
    v_mfma_f32_32x32x16_bf16 v[72:87], v[28:31], v[68:71], v[72:87]
    v_max3_f32 v104, v41, v42, v104
    v_max3_f32 v104, v43, v44, v104
    v_max3_f32 v104, v45, v46, v104
    v_max_f32 v104, v47, v104
    ds_read_b128 v[24:27], v7 offset:640
    ds_read_b128 v[28:31], v7 offset:672
    v_cmp_lt_f32 vcc, 0x41000000, v104
    s_cbranch_vccnz L_gm_k2_kernel_rs10
L_gm_k2_kernel_ct10:
    s_waitcnt lgkmcnt(2)
    v_mfma_f32_32x32x16_bf16 v[48:63], v[16:19], v[8:11], v[88:103]
    v_exp_f32 v32, v32
    v_exp_f32 v33, v33
    v_exp_f32 v34, v34
    v_exp_f32 v35, v35
    v_exp_f32 v36, v36
    v_exp_f32 v37, v37
    v_exp_f32 v38, v38
    v_exp_f32 v39, v39
    v_mfma_f32_32x32x16_bf16 v[48:63], v[20:23], v[12:15], v[48:63]
    v_exp_f32 v40, v40
    v_exp_f32 v41, v41
    v_exp_f32 v42, v42
    v_exp_f32 v43, v43
    v_exp_f32 v44, v44
    v_exp_f32 v45, v45
    v_exp_f32 v46, v46
    v_exp_f32 v47, v47
    ds_read_b128 v[16:19], v5 offset:6144
    ds_read_b32 v20, v6 offset:1536
    v_cvt_pk_bf16_f32 v64, v32, v33
    v_cvt_pk_bf16_f32 v65, v34, v35
    v_cvt_pk_bf16_f32 v66, v36, v37
    v_cvt_pk_bf16_f32 v67, v38, v39
    v_cvt_pk_bf16_f32 v68, v40, v41
    v_cvt_pk_bf16_f32 v69, v42, v43
    v_cvt_pk_bf16_f32 v70, v44, v45
    v_cvt_pk_bf16_f32 v71, v46, v47
    s_waitcnt lgkmcnt(2)
    v_mfma_f32_32x32x16_bf16 v[72:87], v[24:27], v[64:67], v[72:87]
    v_max3_f32 v104, v48, v49, v50
    v_max3_f32 v104, v51, v52, v104
    v_max3_f32 v104, v53, v54, v104
    v_max3_f32 v104, v55, v56, v104
    v_mfma_f32_32x32x16_bf16 v[72:87], v[28:31], v[68:71], v[72:87]
    v_max3_f32 v104, v57, v58, v104
    v_max3_f32 v104, v59, v60, v104
    v_max3_f32 v104, v61, v62, v104
    v_max_f32 v104, v63, v104
    ds_read_b128 v[24:27], v7 offset:704
    ds_read_b128 v[28:31], v7 offset:736
    v_cmp_lt_f32 vcc, 0x41000000, v104
    s_cbranch_vccnz L_gm_k2_kernel_rs11
L_gm_k2_kernel_ct11:
    s_waitcnt lgkmcnt(2)
    v_mfma_f32_32x32x16_bf16 v[32:47], v[16:19], v[8:11], v[88:103]
    v_exp_f32 v48, v48
    v_exp_f32 v49, v49
    v_exp_f32 v50, v50
    v_exp_f32 v51, v51
    v_exp_f32 v52, v52
    v_exp_f32 v53, v53
    v_exp_f32 v54, v54
    v_exp_f32 v55, v55
    v_mfma_f32_32x32x16_bf16 v[32:47], v[20:23], v[12:15], v[32:47]
    v_exp_f32 v56, v56
    v_exp_f32 v57, v57
    v_exp_f32 v58, v58
    v_exp_f32 v59, v59
    v_exp_f32 v60, v60
    v_exp_f32 v61, v61
    v_exp_f32 v62, v62
    v_exp_f32 v63, v63
    ds_read_b128 v[16:19], v5 offset:6656
    ds_read_b32 v20, v6 offset:1664
    v_cvt_pk_bf16_f32 v64, v48, v49
    v_cvt_pk_bf16_f32 v65, v50, v51
    v_cvt_pk_bf16_f32 v66, v52, v53
    v_cvt_pk_bf16_f32 v67, v54, v55
    v_cvt_pk_bf16_f32 v68, v56, v57
    v_cvt_pk_bf16_f32 v69, v58, v59
    v_cvt_pk_bf16_f32 v70, v60, v61
    v_cvt_pk_bf16_f32 v71, v62, v63
    s_waitcnt lgkmcnt(2)
    v_mfma_f32_32x32x16_bf16 v[72:87], v[24:27], v[64:67], v[72:87]
    v_max3_f32 v104, v32, v33, v34
    v_max3_f32 v104, v35, v36, v104
    v_max3_f32 v104, v37, v38, v104
    v_max3_f32 v104, v39, v40, v104
    v_mfma_f32_32x32x16_bf16 v[72:87], v[28:31], v[68:71], v[72:87]
    v_max3_f32 v104, v41, v42, v104
    v_max3_f32 v104, v43, v44, v104
    v_max3_f32 v104, v45, v46, v104
    v_max_f32 v104, v47, v104
    ds_read_b128 v[24:27], v7 offset:768
    ds_read_b128 v[28:31], v7 offset:800
    v_cmp_lt_f32 vcc, 0x41000000, v104
    s_cbranch_vccnz L_gm_k2_kernel_rs12
L_gm_k2_kernel_ct12:
    s_waitcnt lgkmcnt(2)
    v_mfma_f32_32x32x16_bf16 v[48:63], v[16:19], v[8:11], v[88:103]
    v_exp_f32 v32, v32
    v_exp_f32 v33, v33
    v_exp_f32 v34, v34
    v_exp_f32 v35, v35
    v_exp_f32 v36, v36
    v_exp_f32 v37, v37
    v_exp_f32 v38, v38
    v_exp_f32 v39, v39
    v_mfma_f32_32x32x16_bf16 v[48:63], v[20:23], v[12:15], v[48:63]
    v_exp_f32 v40, v40
    v_exp_f32 v41, v41
    v_exp_f32 v42, v42
    v_exp_f32 v43, v43
    v_exp_f32 v44, v44
    v_exp_f32 v45, v45
    v_exp_f32 v46, v46
    v_exp_f32 v47, v47
    ds_read_b128 v[16:19], v5 offset:7168
    ds_read_b32 v20, v6 offset:1792
    v_cvt_pk_bf16_f32 v64, v32, v33
    v_cvt_pk_bf16_f32 v65, v34, v35
    v_cvt_pk_bf16_f32 v66, v36, v37
    v_cvt_pk_bf16_f32 v67, v38, v39
    v_cvt_pk_bf16_f32 v68, v40, v41
    v_cvt_pk_bf16_f32 v69, v42, v43
    v_cvt_pk_bf16_f32 v70, v44, v45
    v_cvt_pk_bf16_f32 v71, v46, v47
    s_waitcnt lgkmcnt(2)
    v_mfma_f32_32x32x16_bf16 v[72:87], v[24:27], v[64:67], v[72:87]
    v_max3_f32 v104, v48, v49, v50
    v_max3_f32 v104, v51, v52, v104
    v_max3_f32 v104, v53, v54, v104
    v_max3_f32 v104, v55, v56, v104
    v_mfma_f32_32x32x16_bf16 v[72:87], v[28:31], v[68:71], v[72:87]
    v_max3_f32 v104, v57, v58, v104
    v_max3_f32 v104, v59, v60, v104
    v_max3_f32 v104, v61, v62, v104
    v_max_f32 v104, v63, v104
    ds_read_b128 v[24:27], v7 offset:832
    ds_read_b128 v[28:31], v7 offset:864
    v_cmp_lt_f32 vcc, 0x41000000, v104
    s_cbranch_vccnz L_gm_k2_kernel_rs13
L_gm_k2_kernel_ct13:
    s_waitcnt lgkmcnt(2)
    v_mfma_f32_32x32x16_bf16 v[32:47], v[16:19], v[8:11], v[88:103]
    v_exp_f32 v48, v48
    v_exp_f32 v49, v49
    v_exp_f32 v50, v50
    v_exp_f32 v51, v51
    v_exp_f32 v52, v52
    v_exp_f32 v53, v53
    v_exp_f32 v54, v54
    v_exp_f32 v55, v55
    v_mfma_f32_32x32x16_bf16 v[32:47], v[20:23], v[12:15], v[32:47]
    v_exp_f32 v56, v56
    v_exp_f32 v57, v57
    v_exp_f32 v58, v58
    v_exp_f32 v59, v59
    v_exp_f32 v60, v60
    v_exp_f32 v61, v61
    v_exp_f32 v62, v62
    v_exp_f32 v63, v63
    ds_read_b128 v[16:19], v5 offset:7680
    ds_read_b32 v20, v6 offset:1920
    v_cvt_pk_bf16_f32 v64, v48, v49
    v_cvt_pk_bf16_f32 v65, v50, v51
    v_cvt_pk_bf16_f32 v66, v52, v53
    v_cvt_pk_bf16_f32 v67, v54, v55
    v_cvt_pk_bf16_f32 v68, v56, v57
    v_cvt_pk_bf16_f32 v69, v58, v59
    v_cvt_pk_bf16_f32 v70, v60, v61
    v_cvt_pk_bf16_f32 v71, v62, v63
    s_waitcnt vmcnt(0)
    s_barrier
    s_waitcnt lgkmcnt(2)
    v_mfma_f32_32x32x16_bf16 v[72:87], v[24:27], v[64:67], v[72:87]
    v_max3_f32 v104, v32, v33, v34
    v_max3_f32 v104, v35, v36, v104
    v_max3_f32 v104, v37, v38, v104
    v_max3_f32 v104, v39, v40, v104
    v_mfma_f32_32x32x16_bf16 v[72:87], v[28:31], v[68:71], v[72:87]
    v_max3_f32 v104, v41, v42, v104
    v_max3_f32 v104, v43, v44, v104
    v_max3_f32 v104, v45, v46, v104
    v_max_f32 v104, v47, v104
    ds_read_b128 v[24:27], v7 offset:896
    ds_read_b128 v[28:31], v7 offset:928
    v_cmp_lt_f32 vcc, 0x41000000, v104
    s_cbranch_vccnz L_gm_k2_kernel_rs14
L_gm_k2_kernel_ct14:
    s_waitcnt lgkmcnt(2)
    v_mfma_f32_32x32x16_bf16 v[48:63], v[16:19], v[8:11], v[88:103]
    v_exp_f32 v32, v32
    v_exp_f32 v33, v33
    v_exp_f32 v34, v34
    v_exp_f32 v35, v35
    v_exp_f32 v36, v36
    v_exp_f32 v37, v37
    v_exp_f32 v38, v38
    v_exp_f32 v39, v39
    v_mfma_f32_32x32x16_bf16 v[48:63], v[20:23], v[12:15], v[48:63]
    v_exp_f32 v40, v40
    v_exp_f32 v41, v41
    v_exp_f32 v42, v42
    v_exp_f32 v43, v43
    v_exp_f32 v44, v44
    v_exp_f32 v45, v45
    v_exp_f32 v46, v46
    v_exp_f32 v47, v47
    ds_read_b128 v[16:19], v120 offset:0
    ds_read_b32 v20, v121 offset:0
    v_cvt_pk_bf16_f32 v64, v32, v33
    v_cvt_pk_bf16_f32 v65, v34, v35
    v_cvt_pk_bf16_f32 v66, v36, v37
    v_cvt_pk_bf16_f32 v67, v38, v39
    v_cvt_pk_bf16_f32 v68, v40, v41
    v_cvt_pk_bf16_f32 v69, v42, v43
    v_cvt_pk_bf16_f32 v70, v44, v45
    v_cvt_pk_bf16_f32 v71, v46, v47
    s_waitcnt lgkmcnt(2)
    v_mfma_f32_32x32x16_bf16 v[72:87], v[24:27], v[64:67], v[72:87]
    v_max3_f32 v104, v48, v49, v50
    v_max3_f32 v104, v51, v52, v104
    v_max3_f32 v104, v53, v54, v104
    v_max3_f32 v104, v55, v56, v104
    v_mfma_f32_32x32x16_bf16 v[72:87], v[28:31], v[68:71], v[72:87]
    v_max3_f32 v104, v57, v58, v104
    v_max3_f32 v104, v59, v60, v104
    v_max3_f32 v104, v61, v62, v104
    v_max_f32 v104, v63, v104
    ds_read_b128 v[24:27], v7 offset:960
    ds_read_b128 v[28:31], v7 offset:992
    v_cmp_lt_f32 vcc, 0x41000000, v104
    s_cbranch_vccnz L_gm_k2_kernel_rs15
L_gm_k2_kernel_ct15:
    s_waitcnt lgkmcnt(2)
    v_mfma_f32_32x32x16_bf16 v[32:47], v[16:19], v[8:11], v[88:103]
    v_exp_f32 v48, v48
    v_exp_f32 v49, v49
    v_exp_f32 v50, v50
    v_exp_f32 v51, v51
    v_exp_f32 v52, v52
    v_exp_f32 v53, v53
    v_exp_f32 v54, v54
    v_exp_f32 v55, v55
    v_mfma_f32_32x32x16_bf16 v[32:47], v[20:23], v[12:15], v[32:47]
    v_exp_f32 v56, v56
    v_exp_f32 v57, v57
    v_exp_f32 v58, v58
    v_exp_f32 v59, v59
    v_exp_f32 v60, v60
    v_exp_f32 v61, v61
    v_exp_f32 v62, v62
    v_exp_f32 v63, v63
    ds_read_b128 v[16:19], v120 offset:512
    ds_read_b32 v20, v121 offset:128
    v_cvt_pk_bf16_f32 v64, v48, v49
    v_cvt_pk_bf16_f32 v65, v50, v51
    v_cvt_pk_bf16_f32 v66, v52, v53
    v_cvt_pk_bf16_f32 v67, v54, v55
    v_cvt_pk_bf16_f32 v68, v56, v57
    v_cvt_pk_bf16_f32 v69, v58, v59
    v_cvt_pk_bf16_f32 v70, v60, v61
    v_cvt_pk_bf16_f32 v71, v62, v63
    v_swap_b32 v5, v120
    v_swap_b32 v6, v121
    v_swap_b32 v7, v122
    s_and_b32 s59, s58, 1
    s_mul_i32 s59, s59, 38192
    s_add_u32 s58, s58, 1
    s_cmp_lt_u32 s58, 4
    s_cbranch_scc1 L_gm_k2_kernel_loop
    s_waitcnt lgkmcnt(0)
    s_nop 0
    v_mfma_f32_32x32x16_bf16 v[72:87], v[24:27], v[64:67], v[72:87]
    v_mfma_f32_32x32x16_bf16 v[72:87], v[28:31], v[68:71], v[72:87]
    s_branch L_gm_k2_kernel_fin
L_gm_k2_kernel_rs0:
    s_nop 15
    v_mov_b32 v105, v104
    s_nop 1
    v_permlane32_swap_b32 v104, v105
    s_nop 1
    v_max_f32 v104, v104, v105
    v_max_f32 v104, 0, v104
    v_sub_f32 v106, 0, v104
    v_exp_f32 v106, v106
    v_sub_f32 v32, v32, v104
    v_sub_f32 v33, v33, v104
    v_sub_f32 v34, v34, v104
    v_sub_f32 v35, v35, v104
    v_sub_f32 v36, v36, v104
    v_sub_f32 v37, v37, v104
    v_sub_f32 v38, v38, v104
    v_sub_f32 v39, v39, v104
    v_sub_f32 v40, v40, v104
    v_sub_f32 v41, v41, v104
    v_sub_f32 v42, v42, v104
    v_sub_f32 v43, v43, v104
    v_sub_f32 v44, v44, v104
    v_sub_f32 v45, v45, v104
    v_sub_f32 v46, v46, v104
    v_sub_f32 v47, v47, v104
    v_sub_f32 v88, v88, v104
    v_sub_f32 v89, v89, v104
    v_sub_f32 v90, v90, v104
    v_sub_f32 v91, v91, v104
    v_sub_f32 v92, v92, v104
    v_sub_f32 v93, v93, v104
    v_sub_f32 v94, v94, v104
    v_sub_f32 v95, v95, v104
    v_sub_f32 v96, v96, v104
    v_sub_f32 v97, v97, v104
    v_sub_f32 v98, v98, v104
    v_sub_f32 v99, v99, v104
    v_sub_f32 v100, v100, v104
    v_sub_f32 v101, v101, v104
    v_sub_f32 v102, v102, v104
    v_sub_f32 v103, v103, v104
    v_mul_f32 v72, v72, v106
    v_mul_f32 v73, v73, v106
    v_mul_f32 v74, v74, v106
    v_mul_f32 v75, v75, v106
    v_mul_f32 v76, v76, v106
    v_mul_f32 v77, v77, v106
    v_mul_f32 v78, v78, v106
    v_mul_f32 v79, v79, v106
    v_mul_f32 v80, v80, v106
    v_mul_f32 v81, v81, v106
    v_mul_f32 v82, v82, v106
    v_mul_f32 v83, v83, v106
    s_nop 1
    s_branch L_gm_k2_kernel_ct0
L_gm_k2_kernel_rs1:
    s_nop 15
    v_mov_b32 v105, v104
    s_nop 1
    v_permlane32_swap_b32 v104, v105
    s_nop 1
    v_max_f32 v104, v104, v105
    v_max_f32 v104, 0, v104
    v_sub_f32 v106, 0, v104
    v_exp_f32 v106, v106
    v_sub_f32 v48, v48, v104
    v_sub_f32 v49, v49, v104
    v_sub_f32 v50, v50, v104
    v_sub_f32 v51, v51, v104
    v_sub_f32 v52, v52, v104
    v_sub_f32 v53, v53, v104
    v_sub_f32 v54, v54, v104
    v_sub_f32 v55, v55, v104
    v_sub_f32 v56, v56, v104
    v_sub_f32 v57, v57, v104
    v_sub_f32 v58, v58, v104
    v_sub_f32 v59, v59, v104
    v_sub_f32 v60, v60, v104
    v_sub_f32 v61, v61, v104
    v_sub_f32 v62, v62, v104
    v_sub_f32 v63, v63, v104
    v_sub_f32 v88, v88, v104
    v_sub_f32 v89, v89, v104
    v_sub_f32 v90, v90, v104
    v_sub_f32 v91, v91, v104
    v_sub_f32 v92, v92, v104
    v_sub_f32 v93, v93, v104
    v_sub_f32 v94, v94, v104
    v_sub_f32 v95, v95, v104
    v_sub_f32 v96, v96, v104
    v_sub_f32 v97, v97, v104
    v_sub_f32 v98, v98, v104
    v_sub_f32 v99, v99, v104
    v_sub_f32 v100, v100, v104
    v_sub_f32 v101, v101, v104
    v_sub_f32 v102, v102, v104
    v_sub_f32 v103, v103, v104
    v_mul_f32 v72, v72, v106
    v_mul_f32 v73, v73, v106
    v_mul_f32 v74, v74, v106
    v_mul_f32 v75, v75, v106
    v_mul_f32 v76, v76, v106
    v_mul_f32 v77, v77, v106
    v_mul_f32 v78, v78, v106
    v_mul_f32 v79, v79, v106
    v_mul_f32 v80, v80, v106
    v_mul_f32 v81, v81, v106
    v_mul_f32 v82, v82, v106
    v_mul_f32 v83, v83, v106
    s_nop 1
    s_branch L_gm_k2_kernel_ct1
L_gm_k2_kernel_rs2:
    s_nop 15
    v_mov_b32 v105, v104
    s_nop 1
    v_permlane32_swap_b32 v104, v105
    s_nop 1
    v_max_f32 v104, v104, v105
    v_max_f32 v104, 0, v104
    v_sub_f32 v106, 0, v104
    v_exp_f32 v106, v106
    v_sub_f32 v32, v32, v104
    v_sub_f32 v33, v33, v104
    v_sub_f32 v34, v34, v104
    v_sub_f32 v35, v35, v104
    v_sub_f32 v36, v36, v104
    v_sub_f32 v37, v37, v104
    v_sub_f32 v38, v38, v104
    v_sub_f32 v39, v39, v104
    v_sub_f32 v40, v40, v104
    v_sub_f32 v41, v41, v104
    v_sub_f32 v42, v42, v104
    v_sub_f32 v43, v43, v104
    v_sub_f32 v44, v44, v104
    v_sub_f32 v45, v45, v104
    v_sub_f32 v46, v46, v104
    v_sub_f32 v47, v47, v104
    v_sub_f32 v88, v88, v104
    v_sub_f32 v89, v89, v104
    v_sub_f32 v90, v90, v104
    v_sub_f32 v91, v91, v104
    v_sub_f32 v92, v92, v104
    v_sub_f32 v93, v93, v104
    v_sub_f32 v94, v94, v104
    v_sub_f32 v95, v95, v104
    v_sub_f32 v96, v96, v104
    v_sub_f32 v97, v97, v104
    v_sub_f32 v98, v98, v104
    v_sub_f32 v99, v99, v104
    v_sub_f32 v100, v100, v104
    v_sub_f32 v101, v101, v104
    v_sub_f32 v102, v102, v104
    v_sub_f32 v103, v103, v104
    v_mul_f32 v72, v72, v106
    v_mul_f32 v73, v73, v106
    v_mul_f32 v74, v74, v106
    v_mul_f32 v75, v75, v106
    v_mul_f32 v76, v76, v106
    v_mul_f32 v77, v77, v106
    v_mul_f32 v78, v78, v106
    v_mul_f32 v79, v79, v106
    v_mul_f32 v80, v80, v106
    v_mul_f32 v81, v81, v106
    v_mul_f32 v82, v82, v106
    v_mul_f32 v83, v83, v106
    s_nop 1
    s_branch L_gm_k2_kernel_ct2
L_gm_k2_kernel_rs3:
    s_nop 15
    v_mov_b32 v105, v104
    s_nop 1
    v_permlane32_swap_b32 v104, v105
    s_nop 1
    v_max_f32 v104, v104, v105
    v_max_f32 v104, 0, v104
    v_sub_f32 v106, 0, v104
    v_exp_f32 v106, v106
    v_sub_f32 v48, v48, v104
    v_sub_f32 v49, v49, v104
    v_sub_f32 v50, v50, v104
    v_sub_f32 v51, v51, v104
    v_sub_f32 v52, v52, v104
    v_sub_f32 v53, v53, v104
    v_sub_f32 v54, v54, v104
    v_sub_f32 v55, v55, v104
    v_sub_f32 v56, v56, v104
    v_sub_f32 v57, v57, v104
    v_sub_f32 v58, v58, v104
    v_sub_f32 v59, v59, v104
    v_sub_f32 v60, v60, v104
    v_sub_f32 v61, v61, v104
    v_sub_f32 v62, v62, v104
    v_sub_f32 v63, v63, v104
    v_sub_f32 v88, v88, v104
    v_sub_f32 v89, v89, v104
    v_sub_f32 v90, v90, v104
    v_sub_f32 v91, v91, v104
    v_sub_f32 v92, v92, v104
    v_sub_f32 v93, v93, v104
    v_sub_f32 v94, v94, v104
    v_sub_f32 v95, v95, v104
    v_sub_f32 v96, v96, v104
    v_sub_f32 v97, v97, v104
    v_sub_f32 v98, v98, v104
    v_sub_f32 v99, v99, v104
    v_sub_f32 v100, v100, v104
    v_sub_f32 v101, v101, v104
    v_sub_f32 v102, v102, v104
    v_sub_f32 v103, v103, v104
    v_mul_f32 v72, v72, v106
    v_mul_f32 v73, v73, v106
    v_mul_f32 v74, v74, v106
    v_mul_f32 v75, v75, v106
    v_mul_f32 v76, v76, v106
    v_mul_f32 v77, v77, v106
    v_mul_f32 v78, v78, v106
    v_mul_f32 v79, v79, v106
    v_mul_f32 v80, v80, v106
    v_mul_f32 v81, v81, v106
    v_mul_f32 v82, v82, v106
    v_mul_f32 v83, v83, v106
    s_nop 1
    s_branch L_gm_k2_kernel_ct3
L_gm_k2_kernel_rs4:
    s_nop 15
    v_mov_b32 v105, v104
    s_nop 1
    v_permlane32_swap_b32 v104, v105
    s_nop 1
    v_max_f32 v104, v104, v105
    v_max_f32 v104, 0, v104
    v_sub_f32 v106, 0, v104
    v_exp_f32 v106, v106
    v_sub_f32 v32, v32, v104
    v_sub_f32 v33, v33, v104
    v_sub_f32 v34, v34, v104
    v_sub_f32 v35, v35, v104
    v_sub_f32 v36, v36, v104
    v_sub_f32 v37, v37, v104
    v_sub_f32 v38, v38, v104
    v_sub_f32 v39, v39, v104
    v_sub_f32 v40, v40, v104
    v_sub_f32 v41, v41, v104
    v_sub_f32 v42, v42, v104
    v_sub_f32 v43, v43, v104
    v_sub_f32 v44, v44, v104
    v_sub_f32 v45, v45, v104
    v_sub_f32 v46, v46, v104
    v_sub_f32 v47, v47, v104
    v_sub_f32 v88, v88, v104
    v_sub_f32 v89, v89, v104
    v_sub_f32 v90, v90, v104
    v_sub_f32 v91, v91, v104
    v_sub_f32 v92, v92, v104
    v_sub_f32 v93, v93, v104
    v_sub_f32 v94, v94, v104
    v_sub_f32 v95, v95, v104
    v_sub_f32 v96, v96, v104
    v_sub_f32 v97, v97, v104
    v_sub_f32 v98, v98, v104
    v_sub_f32 v99, v99, v104
    v_sub_f32 v100, v100, v104
    v_sub_f32 v101, v101, v104
    v_sub_f32 v102, v102, v104
    v_sub_f32 v103, v103, v104
    v_mul_f32 v72, v72, v106
    v_mul_f32 v73, v73, v106
    v_mul_f32 v74, v74, v106
    v_mul_f32 v75, v75, v106
    v_mul_f32 v76, v76, v106
    v_mul_f32 v77, v77, v106
    v_mul_f32 v78, v78, v106
    v_mul_f32 v79, v79, v106
    v_mul_f32 v80, v80, v106
    v_mul_f32 v81, v81, v106
    v_mul_f32 v82, v82, v106
    v_mul_f32 v83, v83, v106
    s_nop 1
    s_branch L_gm_k2_kernel_ct4
L_gm_k2_kernel_rs5:
    s_nop 15
    v_mov_b32 v105, v104
    s_nop 1
    v_permlane32_swap_b32 v104, v105
    s_nop 1
    v_max_f32 v104, v104, v105
    v_max_f32 v104, 0, v104
    v_sub_f32 v106, 0, v104
    v_exp_f32 v106, v106
    v_sub_f32 v48, v48, v104
    v_sub_f32 v49, v49, v104
    v_sub_f32 v50, v50, v104
    v_sub_f32 v51, v51, v104
    v_sub_f32 v52, v52, v104
    v_sub_f32 v53, v53, v104
    v_sub_f32 v54, v54, v104
    v_sub_f32 v55, v55, v104
    v_sub_f32 v56, v56, v104
    v_sub_f32 v57, v57, v104
    v_sub_f32 v58, v58, v104
    v_sub_f32 v59, v59, v104
    v_sub_f32 v60, v60, v104
    v_sub_f32 v61, v61, v104
    v_sub_f32 v62, v62, v104
    v_sub_f32 v63, v63, v104
    v_sub_f32 v88, v88, v104
    v_sub_f32 v89, v89, v104
    v_sub_f32 v90, v90, v104
    v_sub_f32 v91, v91, v104
    v_sub_f32 v92, v92, v104
    v_sub_f32 v93, v93, v104
    v_sub_f32 v94, v94, v104
    v_sub_f32 v95, v95, v104
    v_sub_f32 v96, v96, v104
    v_sub_f32 v97, v97, v104
    v_sub_f32 v98, v98, v104
    v_sub_f32 v99, v99, v104
    v_sub_f32 v100, v100, v104
    v_sub_f32 v101, v101, v104
    v_sub_f32 v102, v102, v104
    v_sub_f32 v103, v103, v104
    v_mul_f32 v72, v72, v106
    v_mul_f32 v73, v73, v106
    v_mul_f32 v74, v74, v106
    v_mul_f32 v75, v75, v106
    v_mul_f32 v76, v76, v106
    v_mul_f32 v77, v77, v106
    v_mul_f32 v78, v78, v106
    v_mul_f32 v79, v79, v106
    v_mul_f32 v80, v80, v106
    v_mul_f32 v81, v81, v106
    v_mul_f32 v82, v82, v106
    v_mul_f32 v83, v83, v106
    s_nop 1
    s_branch L_gm_k2_kernel_ct5
L_gm_k2_kernel_rs6:
    s_nop 15
    v_mov_b32 v105, v104
    s_nop 1
    v_permlane32_swap_b32 v104, v105
    s_nop 1
    v_max_f32 v104, v104, v105
    v_max_f32 v104, 0, v104
    v_sub_f32 v106, 0, v104
    v_exp_f32 v106, v106
    v_sub_f32 v32, v32, v104
    v_sub_f32 v33, v33, v104
    v_sub_f32 v34, v34, v104
    v_sub_f32 v35, v35, v104
    v_sub_f32 v36, v36, v104
    v_sub_f32 v37, v37, v104
    v_sub_f32 v38, v38, v104
    v_sub_f32 v39, v39, v104
    v_sub_f32 v40, v40, v104
    v_sub_f32 v41, v41, v104
    v_sub_f32 v42, v42, v104
    v_sub_f32 v43, v43, v104
    v_sub_f32 v44, v44, v104
    v_sub_f32 v45, v45, v104
    v_sub_f32 v46, v46, v104
    v_sub_f32 v47, v47, v104
    v_sub_f32 v88, v88, v104
    v_sub_f32 v89, v89, v104
    v_sub_f32 v90, v90, v104
    v_sub_f32 v91, v91, v104
    v_sub_f32 v92, v92, v104
    v_sub_f32 v93, v93, v104
    v_sub_f32 v94, v94, v104
    v_sub_f32 v95, v95, v104
    v_sub_f32 v96, v96, v104
    v_sub_f32 v97, v97, v104
    v_sub_f32 v98, v98, v104
    v_sub_f32 v99, v99, v104
    v_sub_f32 v100, v100, v104
    v_sub_f32 v101, v101, v104
    v_sub_f32 v102, v102, v104
    v_sub_f32 v103, v103, v104
    v_mul_f32 v72, v72, v106
    v_mul_f32 v73, v73, v106
    v_mul_f32 v74, v74, v106
    v_mul_f32 v75, v75, v106
    v_mul_f32 v76, v76, v106
    v_mul_f32 v77, v77, v106
    v_mul_f32 v78, v78, v106
    v_mul_f32 v79, v79, v106
    v_mul_f32 v80, v80, v106
    v_mul_f32 v81, v81, v106
    v_mul_f32 v82, v82, v106
    v_mul_f32 v83, v83, v106
    s_nop 1
    s_branch L_gm_k2_kernel_ct6
L_gm_k2_kernel_rs7:
    s_nop 15
    v_mov_b32 v105, v104
    s_nop 1
    v_permlane32_swap_b32 v104, v105
    s_nop 1
    v_max_f32 v104, v104, v105
    v_max_f32 v104, 0, v104
    v_sub_f32 v106, 0, v104
    v_exp_f32 v106, v106
    v_sub_f32 v48, v48, v104
    v_sub_f32 v49, v49, v104
    v_sub_f32 v50, v50, v104
    v_sub_f32 v51, v51, v104
    v_sub_f32 v52, v52, v104
    v_sub_f32 v53, v53, v104
    v_sub_f32 v54, v54, v104
    v_sub_f32 v55, v55, v104
    v_sub_f32 v56, v56, v104
    v_sub_f32 v57, v57, v104
    v_sub_f32 v58, v58, v104
    v_sub_f32 v59, v59, v104
    v_sub_f32 v60, v60, v104
    v_sub_f32 v61, v61, v104
    v_sub_f32 v62, v62, v104
    v_sub_f32 v63, v63, v104
    v_sub_f32 v88, v88, v104
    v_sub_f32 v89, v89, v104
    v_sub_f32 v90, v90, v104
    v_sub_f32 v91, v91, v104
    v_sub_f32 v92, v92, v104
    v_sub_f32 v93, v93, v104
    v_sub_f32 v94, v94, v104
    v_sub_f32 v95, v95, v104
    v_sub_f32 v96, v96, v104
    v_sub_f32 v97, v97, v104
    v_sub_f32 v98, v98, v104
    v_sub_f32 v99, v99, v104
    v_sub_f32 v100, v100, v104
    v_sub_f32 v101, v101, v104
    v_sub_f32 v102, v102, v104
    v_sub_f32 v103, v103, v104
    v_mul_f32 v72, v72, v106
    v_mul_f32 v73, v73, v106
    v_mul_f32 v74, v74, v106
    v_mul_f32 v75, v75, v106
    v_mul_f32 v76, v76, v106
    v_mul_f32 v77, v77, v106
    v_mul_f32 v78, v78, v106
    v_mul_f32 v79, v79, v106
    v_mul_f32 v80, v80, v106
    v_mul_f32 v81, v81, v106
    v_mul_f32 v82, v82, v106
    v_mul_f32 v83, v83, v106
    s_nop 1
    s_branch L_gm_k2_kernel_ct7
L_gm_k2_kernel_rs8:
    s_nop 15
    v_mov_b32 v105, v104
    s_nop 1
    v_permlane32_swap_b32 v104, v105
    s_nop 1
    v_max_f32 v104, v104, v105
    v_max_f32 v104, 0, v104
    v_sub_f32 v106, 0, v104
    v_exp_f32 v106, v106
    v_sub_f32 v32, v32, v104
    v_sub_f32 v33, v33, v104
    v_sub_f32 v34, v34, v104
    v_sub_f32 v35, v35, v104
    v_sub_f32 v36, v36, v104
    v_sub_f32 v37, v37, v104
    v_sub_f32 v38, v38, v104
    v_sub_f32 v39, v39, v104
    v_sub_f32 v40, v40, v104
    v_sub_f32 v41, v41, v104
    v_sub_f32 v42, v42, v104
    v_sub_f32 v43, v43, v104
    v_sub_f32 v44, v44, v104
    v_sub_f32 v45, v45, v104
    v_sub_f32 v46, v46, v104
    v_sub_f32 v47, v47, v104
    v_sub_f32 v88, v88, v104
    v_sub_f32 v89, v89, v104
    v_sub_f32 v90, v90, v104
    v_sub_f32 v91, v91, v104
    v_sub_f32 v92, v92, v104
    v_sub_f32 v93, v93, v104
    v_sub_f32 v94, v94, v104
    v_sub_f32 v95, v95, v104
    v_sub_f32 v96, v96, v104
    v_sub_f32 v97, v97, v104
    v_sub_f32 v98, v98, v104
    v_sub_f32 v99, v99, v104
    v_sub_f32 v100, v100, v104
    v_sub_f32 v101, v101, v104
    v_sub_f32 v102, v102, v104
    v_sub_f32 v103, v103, v104
    v_mul_f32 v72, v72, v106
    v_mul_f32 v73, v73, v106
    v_mul_f32 v74, v74, v106
    v_mul_f32 v75, v75, v106
    v_mul_f32 v76, v76, v106
    v_mul_f32 v77, v77, v106
    v_mul_f32 v78, v78, v106
    v_mul_f32 v79, v79, v106
    v_mul_f32 v80, v80, v106
    v_mul_f32 v81, v81, v106
    v_mul_f32 v82, v82, v106
    v_mul_f32 v83, v83, v106
    s_nop 1
    s_branch L_gm_k2_kernel_ct8
L_gm_k2_kernel_rs9:
    s_nop 15
    v_mov_b32 v105, v104
    s_nop 1
    v_permlane32_swap_b32 v104, v105
    s_nop 1
    v_max_f32 v104, v104, v105
    v_max_f32 v104, 0, v104
    v_sub_f32 v106, 0, v104
    v_exp_f32 v106, v106
    v_sub_f32 v48, v48, v104
    v_sub_f32 v49, v49, v104
    v_sub_f32 v50, v50, v104
    v_sub_f32 v51, v51, v104
    v_sub_f32 v52, v52, v104
    v_sub_f32 v53, v53, v104
    v_sub_f32 v54, v54, v104
    v_sub_f32 v55, v55, v104
    v_sub_f32 v56, v56, v104
    v_sub_f32 v57, v57, v104
    v_sub_f32 v58, v58, v104
    v_sub_f32 v59, v59, v104
    v_sub_f32 v60, v60, v104
    v_sub_f32 v61, v61, v104
    v_sub_f32 v62, v62, v104
    v_sub_f32 v63, v63, v104
    v_sub_f32 v88, v88, v104
    v_sub_f32 v89, v89, v104
    v_sub_f32 v90, v90, v104
    v_sub_f32 v91, v91, v104
    v_sub_f32 v92, v92, v104
    v_sub_f32 v93, v93, v104
    v_sub_f32 v94, v94, v104
    v_sub_f32 v95, v95, v104
    v_sub_f32 v96, v96, v104
    v_sub_f32 v97, v97, v104
    v_sub_f32 v98, v98, v104
    v_sub_f32 v99, v99, v104
    v_sub_f32 v100, v100, v104
    v_sub_f32 v101, v101, v104
    v_sub_f32 v102, v102, v104
    v_sub_f32 v103, v103, v104
    v_mul_f32 v72, v72, v106
    v_mul_f32 v73, v73, v106
    v_mul_f32 v74, v74, v106
    v_mul_f32 v75, v75, v106
    v_mul_f32 v76, v76, v106
    v_mul_f32 v77, v77, v106
    v_mul_f32 v78, v78, v106
    v_mul_f32 v79, v79, v106
    v_mul_f32 v80, v80, v106
    v_mul_f32 v81, v81, v106
    v_mul_f32 v82, v82, v106
    v_mul_f32 v83, v83, v106
    s_nop 1
    s_branch L_gm_k2_kernel_ct9
L_gm_k2_kernel_rs10:
    s_nop 15
    v_mov_b32 v105, v104
    s_nop 1
    v_permlane32_swap_b32 v104, v105
    s_nop 1
    v_max_f32 v104, v104, v105
    v_max_f32 v104, 0, v104
    v_sub_f32 v106, 0, v104
    v_exp_f32 v106, v106
    v_sub_f32 v32, v32, v104
    v_sub_f32 v33, v33, v104
    v_sub_f32 v34, v34, v104
    v_sub_f32 v35, v35, v104
    v_sub_f32 v36, v36, v104
    v_sub_f32 v37, v37, v104
    v_sub_f32 v38, v38, v104
    v_sub_f32 v39, v39, v104
    v_sub_f32 v40, v40, v104
    v_sub_f32 v41, v41, v104
    v_sub_f32 v42, v42, v104
    v_sub_f32 v43, v43, v104
    v_sub_f32 v44, v44, v104
    v_sub_f32 v45, v45, v104
    v_sub_f32 v46, v46, v104
    v_sub_f32 v47, v47, v104
    v_sub_f32 v88, v88, v104
    v_sub_f32 v89, v89, v104
    v_sub_f32 v90, v90, v104
    v_sub_f32 v91, v91, v104
    v_sub_f32 v92, v92, v104
    v_sub_f32 v93, v93, v104
    v_sub_f32 v94, v94, v104
    v_sub_f32 v95, v95, v104
    v_sub_f32 v96, v96, v104
    v_sub_f32 v97, v97, v104
    v_sub_f32 v98, v98, v104
    v_sub_f32 v99, v99, v104
    v_sub_f32 v100, v100, v104
    v_sub_f32 v101, v101, v104
    v_sub_f32 v102, v102, v104
    v_sub_f32 v103, v103, v104
    v_mul_f32 v72, v72, v106
    v_mul_f32 v73, v73, v106
    v_mul_f32 v74, v74, v106
    v_mul_f32 v75, v75, v106
    v_mul_f32 v76, v76, v106
    v_mul_f32 v77, v77, v106
    v_mul_f32 v78, v78, v106
    v_mul_f32 v79, v79, v106
    v_mul_f32 v80, v80, v106
    v_mul_f32 v81, v81, v106
    v_mul_f32 v82, v82, v106
    v_mul_f32 v83, v83, v106
    s_nop 1
    s_branch L_gm_k2_kernel_ct10
L_gm_k2_kernel_rs11:
    s_nop 15
    v_mov_b32 v105, v104
    s_nop 1
    v_permlane32_swap_b32 v104, v105
    s_nop 1
    v_max_f32 v104, v104, v105
    v_max_f32 v104, 0, v104
    v_sub_f32 v106, 0, v104
    v_exp_f32 v106, v106
    v_sub_f32 v48, v48, v104
    v_sub_f32 v49, v49, v104
    v_sub_f32 v50, v50, v104
    v_sub_f32 v51, v51, v104
    v_sub_f32 v52, v52, v104
    v_sub_f32 v53, v53, v104
    v_sub_f32 v54, v54, v104
    v_sub_f32 v55, v55, v104
    v_sub_f32 v56, v56, v104
    v_sub_f32 v57, v57, v104
    v_sub_f32 v58, v58, v104
    v_sub_f32 v59, v59, v104
    v_sub_f32 v60, v60, v104
    v_sub_f32 v61, v61, v104
    v_sub_f32 v62, v62, v104
    v_sub_f32 v63, v63, v104
    v_sub_f32 v88, v88, v104
    v_sub_f32 v89, v89, v104
    v_sub_f32 v90, v90, v104
    v_sub_f32 v91, v91, v104
    v_sub_f32 v92, v92, v104
    v_sub_f32 v93, v93, v104
    v_sub_f32 v94, v94, v104
    v_sub_f32 v95, v95, v104
    v_sub_f32 v96, v96, v104
    v_sub_f32 v97, v97, v104
    v_sub_f32 v98, v98, v104
    v_sub_f32 v99, v99, v104
    v_sub_f32 v100, v100, v104
    v_sub_f32 v101, v101, v104
    v_sub_f32 v102, v102, v104
    v_sub_f32 v103, v103, v104
    v_mul_f32 v72, v72, v106
    v_mul_f32 v73, v73, v106
    v_mul_f32 v74, v74, v106
    v_mul_f32 v75, v75, v106
    v_mul_f32 v76, v76, v106
    v_mul_f32 v77, v77, v106
    v_mul_f32 v78, v78, v106
    v_mul_f32 v79, v79, v106
    v_mul_f32 v80, v80, v106
    v_mul_f32 v81, v81, v106
    v_mul_f32 v82, v82, v106
    v_mul_f32 v83, v83, v106
    s_nop 1
    s_branch L_gm_k2_kernel_ct11
L_gm_k2_kernel_rs12:
    s_nop 15
    v_mov_b32 v105, v104
    s_nop 1
    v_permlane32_swap_b32 v104, v105
    s_nop 1
    v_max_f32 v104, v104, v105
    v_max_f32 v104, 0, v104
    v_sub_f32 v106, 0, v104
    v_exp_f32 v106, v106
    v_sub_f32 v32, v32, v104
    v_sub_f32 v33, v33, v104
    v_sub_f32 v34, v34, v104
    v_sub_f32 v35, v35, v104
    v_sub_f32 v36, v36, v104
    v_sub_f32 v37, v37, v104
    v_sub_f32 v38, v38, v104
    v_sub_f32 v39, v39, v104
    v_sub_f32 v40, v40, v104
    v_sub_f32 v41, v41, v104
    v_sub_f32 v42, v42, v104
    v_sub_f32 v43, v43, v104
    v_sub_f32 v44, v44, v104
    v_sub_f32 v45, v45, v104
    v_sub_f32 v46, v46, v104
    v_sub_f32 v47, v47, v104
    v_sub_f32 v88, v88, v104
    v_sub_f32 v89, v89, v104
    v_sub_f32 v90, v90, v104
    v_sub_f32 v91, v91, v104
    v_sub_f32 v92, v92, v104
    v_sub_f32 v93, v93, v104
    v_sub_f32 v94, v94, v104
    v_sub_f32 v95, v95, v104
    v_sub_f32 v96, v96, v104
    v_sub_f32 v97, v97, v104
    v_sub_f32 v98, v98, v104
    v_sub_f32 v99, v99, v104
    v_sub_f32 v100, v100, v104
    v_sub_f32 v101, v101, v104
    v_sub_f32 v102, v102, v104
    v_sub_f32 v103, v103, v104
    v_mul_f32 v72, v72, v106
    v_mul_f32 v73, v73, v106
    v_mul_f32 v74, v74, v106
    v_mul_f32 v75, v75, v106
    v_mul_f32 v76, v76, v106
    v_mul_f32 v77, v77, v106
    v_mul_f32 v78, v78, v106
    v_mul_f32 v79, v79, v106
    v_mul_f32 v80, v80, v106
    v_mul_f32 v81, v81, v106
    v_mul_f32 v82, v82, v106
    v_mul_f32 v83, v83, v106
    s_nop 1
    s_branch L_gm_k2_kernel_ct12
L_gm_k2_kernel_rs13:
    s_nop 15
    v_mov_b32 v105, v104
    s_nop 1
    v_permlane32_swap_b32 v104, v105
    s_nop 1
    v_max_f32 v104, v104, v105
    v_max_f32 v104, 0, v104
    v_sub_f32 v106, 0, v104
    v_exp_f32 v106, v106
    v_sub_f32 v48, v48, v104
    v_sub_f32 v49, v49, v104
    v_sub_f32 v50, v50, v104
    v_sub_f32 v51, v51, v104
    v_sub_f32 v52, v52, v104
    v_sub_f32 v53, v53, v104
    v_sub_f32 v54, v54, v104
    v_sub_f32 v55, v55, v104
    v_sub_f32 v56, v56, v104
    v_sub_f32 v57, v57, v104
    v_sub_f32 v58, v58, v104
    v_sub_f32 v59, v59, v104
    v_sub_f32 v60, v60, v104
    v_sub_f32 v61, v61, v104
    v_sub_f32 v62, v62, v104
    v_sub_f32 v63, v63, v104
    v_sub_f32 v88, v88, v104
    v_sub_f32 v89, v89, v104
    v_sub_f32 v90, v90, v104
    v_sub_f32 v91, v91, v104
    v_sub_f32 v92, v92, v104
    v_sub_f32 v93, v93, v104
    v_sub_f32 v94, v94, v104
    v_sub_f32 v95, v95, v104
    v_sub_f32 v96, v96, v104
    v_sub_f32 v97, v97, v104
    v_sub_f32 v98, v98, v104
    v_sub_f32 v99, v99, v104
    v_sub_f32 v100, v100, v104
    v_sub_f32 v101, v101, v104
    v_sub_f32 v102, v102, v104
    v_sub_f32 v103, v103, v104
    v_mul_f32 v72, v72, v106
    v_mul_f32 v73, v73, v106
    v_mul_f32 v74, v74, v106
    v_mul_f32 v75, v75, v106
    v_mul_f32 v76, v76, v106
    v_mul_f32 v77, v77, v106
    v_mul_f32 v78, v78, v106
    v_mul_f32 v79, v79, v106
    v_mul_f32 v80, v80, v106
    v_mul_f32 v81, v81, v106
    v_mul_f32 v82, v82, v106
    v_mul_f32 v83, v83, v106
    s_nop 1
    s_branch L_gm_k2_kernel_ct13
L_gm_k2_kernel_rs14:
    s_nop 15
    v_mov_b32 v105, v104
    s_nop 1
    v_permlane32_swap_b32 v104, v105
    s_nop 1
    v_max_f32 v104, v104, v105
    v_max_f32 v104, 0, v104
    v_sub_f32 v106, 0, v104
    v_exp_f32 v106, v106
    v_sub_f32 v32, v32, v104
    v_sub_f32 v33, v33, v104
    v_sub_f32 v34, v34, v104
    v_sub_f32 v35, v35, v104
    v_sub_f32 v36, v36, v104
    v_sub_f32 v37, v37, v104
    v_sub_f32 v38, v38, v104
    v_sub_f32 v39, v39, v104
    v_sub_f32 v40, v40, v104
    v_sub_f32 v41, v41, v104
    v_sub_f32 v42, v42, v104
    v_sub_f32 v43, v43, v104
    v_sub_f32 v44, v44, v104
    v_sub_f32 v45, v45, v104
    v_sub_f32 v46, v46, v104
    v_sub_f32 v47, v47, v104
    v_sub_f32 v88, v88, v104
    v_sub_f32 v89, v89, v104
    v_sub_f32 v90, v90, v104
    v_sub_f32 v91, v91, v104
    v_sub_f32 v92, v92, v104
    v_sub_f32 v93, v93, v104
    v_sub_f32 v94, v94, v104
    v_sub_f32 v95, v95, v104
    v_sub_f32 v96, v96, v104
    v_sub_f32 v97, v97, v104
    v_sub_f32 v98, v98, v104
    v_sub_f32 v99, v99, v104
    v_sub_f32 v100, v100, v104
    v_sub_f32 v101, v101, v104
    v_sub_f32 v102, v102, v104
    v_sub_f32 v103, v103, v104
    v_mul_f32 v72, v72, v106
    v_mul_f32 v73, v73, v106
    v_mul_f32 v74, v74, v106
    v_mul_f32 v75, v75, v106
    v_mul_f32 v76, v76, v106
    v_mul_f32 v77, v77, v106
    v_mul_f32 v78, v78, v106
    v_mul_f32 v79, v79, v106
    v_mul_f32 v80, v80, v106
    v_mul_f32 v81, v81, v106
    v_mul_f32 v82, v82, v106
    v_mul_f32 v83, v83, v106
    s_nop 1
    s_branch L_gm_k2_kernel_ct14
L_gm_k2_kernel_rs15:
    s_nop 15
    v_mov_b32 v105, v104
    s_nop 1
    v_permlane32_swap_b32 v104, v105
    s_nop 1
    v_max_f32 v104, v104, v105
    v_max_f32 v104, 0, v104
    v_sub_f32 v106, 0, v104
    v_exp_f32 v106, v106
    v_sub_f32 v48, v48, v104
    v_sub_f32 v49, v49, v104
    v_sub_f32 v50, v50, v104
    v_sub_f32 v51, v51, v104
    v_sub_f32 v52, v52, v104
    v_sub_f32 v53, v53, v104
    v_sub_f32 v54, v54, v104
    v_sub_f32 v55, v55, v104
    v_sub_f32 v56, v56, v104
    v_sub_f32 v57, v57, v104
    v_sub_f32 v58, v58, v104
    v_sub_f32 v59, v59, v104
    v_sub_f32 v60, v60, v104
    v_sub_f32 v61, v61, v104
    v_sub_f32 v62, v62, v104
    v_sub_f32 v63, v63, v104
    v_sub_f32 v88, v88, v104
    v_sub_f32 v89, v89, v104
    v_sub_f32 v90, v90, v104
    v_sub_f32 v91, v91, v104
    v_sub_f32 v92, v92, v104
    v_sub_f32 v93, v93, v104
    v_sub_f32 v94, v94, v104
    v_sub_f32 v95, v95, v104
    v_sub_f32 v96, v96, v104
    v_sub_f32 v97, v97, v104
    v_sub_f32 v98, v98, v104
    v_sub_f32 v99, v99, v104
    v_sub_f32 v100, v100, v104
    v_sub_f32 v101, v101, v104
    v_sub_f32 v102, v102, v104
    v_sub_f32 v103, v103, v104
    v_mul_f32 v72, v72, v106
    v_mul_f32 v73, v73, v106
    v_mul_f32 v74, v74, v106
    v_mul_f32 v75, v75, v106
    v_mul_f32 v76, v76, v106
    v_mul_f32 v77, v77, v106
    v_mul_f32 v78, v78, v106
    v_mul_f32 v79, v79, v106
    v_mul_f32 v80, v80, v106
    v_mul_f32 v81, v81, v106
    v_mul_f32 v82, v82, v106
    v_mul_f32 v83, v83, v106
    s_nop 1
    s_branch L_gm_k2_kernel_ct15
L_gm_k2_kernel_fin:
    s_nop 15
    s_nop 7
    v_mov_b32 v104, v82
    v_mov_b32 v105, v82
    s_nop 1
    v_permlane32_swap_b32 v104, v105
    s_nop 1
    v_rcp_f32 v104, v104
    s_nop 0
    v_mul_f32 v72, v72, v104
    v_mul_f32 v73, v73, v104
    v_mul_f32 v74, v74, v104
    v_mul_f32 v75, v75, v104
    v_mul_f32 v76, v76, v104
    v_mul_f32 v77, v77, v104
    v_mul_f32 v78, v78, v104
    v_mul_f32 v79, v79, v104
    v_mul_f32 v80, v80, v104
    v_mul_f32 v81, v81, v104
    v_mul_f32 v82, v82, v104
    v_mul_f32 v83, v83, v104
    v_cvt_pk_bf16_f32 v64, v72, v73
    v_cvt_pk_bf16_f32 v65, v74, v75
    v_cvt_pk_bf16_f32 v66, v76, v77
    v_cvt_pk_bf16_f32 v67, v78, v79
    v_cvt_pk_bf16_f32 v68, v80, v81
    v_cvt_pk_bf16_f32 v69, v82, v83
    v_mul_u32_u24 v4, 1152, v2
    v_lshl_add_u32 v4, v3, 3, v4
    s_mul_i32 s60, s32, 36
    s_add_u32 s60, s60, 7340032
    buffer_store_dword v64, v4, s[4:7], s60 offen
    buffer_store_dword v65, v4, s[4:7], s60 offen offset:4
    buffer_store_dword v66, v4, s[4:7], s60 offen offset:16
    buffer_store_dword v67, v4, s[4:7], s60 offen offset:20
    v_cmp_gt_u32 vcc, 32, v0
    s_and_saveexec_b64 s[44:45], vcc
    buffer_store_dword v68, v4, s[4:7], s60 offen offset:32
    s_endpgm
L_gm_k2_kernel_gemm:
    s_load_dwordx2 s[24:25], s[0:1], 80
    s_load_dwordx2 s[26:27], s[0:1], 0
    s_load_dwordx2 s[28:29], s[0:1], 48
    s_sub_u32 s35, s2, 256
    s_and_b32 s32, s35, 15
    s_lshr_b32 s33, s35, 4
    s_mul_i32 s34, s33, 0x5556
    s_lshr_b32 s34, s34, 16
    s_mul_i32 s35, s34, 3
    s_sub_u32 s33, s33, s35
    s_mul_i32 s37, s32, 128
    s_waitcnt lgkmcnt(0)
    s_mul_i32 s42, s34, 3072
    s_add_u32 s42, s42, 16777216
    s_mul_i32 s60, s34, 1769472
    s_sub_u32 s61, 5308416, s60
    s_sub_u32 s43, 268435456, s42
    s_add_u32 s4, s24, s42
    s_addc_u32 s5, s25, 0
    s_and_b32 s5, s5, 0xffff
    s_mov_b32 s6, s43
    s_mov_b32 s7, 0x20000
    s_add_u32 s8, s28, s60
    s_addc_u32 s9, s29, 0
    s_and_b32 s9, s9, 0xffff
    s_mov_b32 s10, s61
    s_mov_b32 s11, 0x20000
    s_add_u32 s12, s28, s60
    s_addc_u32 s13, s29, 0
    s_and_b32 s13, s13, 0xffff
    s_mov_b32 s14, s61
    s_mov_b32 s15, 0x20000
    s_movk_i32 s38, 9216
    s_mov_b32 s39, 1152
    s_mul_i32 s40, s33, 384
    s_add_u32 s41, s40, 192
    s_mov_b32 s62, 11
    s_mov_b32 s16, s24
    s_and_b32 s17, s25, 0xffff
    s_mov_b32 s18, 268435456
    s_mov_b32 s19, 0x20000
    s_add_u32 s47, s36, 0
    s_mov_b32 s84, 0
    s_cmp_lt_u32 s47, 8
    s_cbranch_scc0 L_gm_k2_kernel_fin_w0
    s_mov_b32 s64, s4
    s_mov_b32 s65, s5
    s_mov_b32 s66, s6
    s_mov_b32 s67, s7
    s_mov_b32 s89, 64
    s_lshl_b32 s94, s47, 10
    v_lshrrev_b32 v1, 2, v0
    s_lshl_b32 s48, s47, 4
    s_add_u32 s48, s48, s37
    v_add_u32 v1, s48, v1
    v_mul_lo_u32 v32, v1, s38
    v_and_b32 v2, 3, v0
    v_lshrrev_b32 v3, 5, v0
    v_lshlrev_b32 v3, 1, v3
    v_xor_b32 v2, v2, v3
    v_lshl_add_u32 v32, v2, 4, v32
    s_branch L_gm_k2_kernel_fin_d0
L_gm_k2_kernel_fin_w0:
    s_cmp_lt_u32 s47, 20
    s_cbranch_scc0 L_gm_k2_kernel_fin_z0
    s_sub_u32 s47, s47, 8
    s_lshl_b32 s94, s47, 10
    s_add_u32 s94, s94, 8192
    s_lshl_b32 s89, s39, 5
    s_sub_u32 s48, s47, 6
    s_cmp_lt_u32 s47, 6
    s_cselect_b32 s64, s8, s12
    s_cselect_b32 s65, s9, s13
    s_cselect_b32 s66, s10, s14
    s_cselect_b32 s67, s11, s15
    s_cselect_b32 s46, s40, s41
    s_cselect_b32 s47, s47, s48
    s_lshl_b32 s47, s47, 6
    v_add_u32 v1, s47, v0
    v_mul_u32_u24 v2, 2731, v1
    v_lshrrev_b32 v2, 15, v2
    v_mul_u32_u24 v3, 12, v2
    v_sub_u32 v3, v1, v3
    v_bfe_u32 v4, v2, 3, 1
    v_lshlrev_b32 v4, 1, v4
    v_xor_b32 v3, v3, v4
    v_mul_lo_u32 v2, v2, s39
    v_lshl_add_u32 v2, v3, 4, v2
    v_add_u32 v32, s46, v2
    s_branch L_gm_k2_kernel_fin_d0
L_gm_k2_kernel_fin_z0:
    s_mov_b32 s64, s4
    s_mov_b32 s65, s5
    s_mov_b32 s66, 0
    s_mov_b32 s67, 0x20000
    s_mov_b32 s89, 0
    s_mov_b32 s94, 143360
    v_mov_b32 v32, 0
L_gm_k2_kernel_fin_d0:
    s_add_u32 s47, s36, 8
    s_mov_b32 s85, 0
    s_cmp_lt_u32 s47, 8
    s_cbranch_scc0 L_gm_k2_kernel_fin_w1
    s_mov_b32 s68, s4
    s_mov_b32 s69, s5
    s_mov_b32 s70, s6
    s_mov_b32 s71, s7
    s_mov_b32 s90, 64
    s_lshl_b32 s95, s47, 10
    v_lshrrev_b32 v1, 2, v0
    s_lshl_b32 s48, s47, 4
    s_add_u32 s48, s48, s37
    v_add_u32 v1, s48, v1
    v_mul_lo_u32 v33, v1, s38
    v_and_b32 v2, 3, v0
    v_lshrrev_b32 v3, 5, v0
    v_lshlrev_b32 v3, 1, v3
    v_xor_b32 v2, v2, v3
    v_lshl_add_u32 v33, v2, 4, v33
    s_branch L_gm_k2_kernel_fin_d1
L_gm_k2_kernel_fin_w1:
    s_cmp_lt_u32 s47, 20
    s_cbranch_scc0 L_gm_k2_kernel_fin_z1
    s_sub_u32 s47, s47, 8
    s_lshl_b32 s95, s47, 10
    s_add_u32 s95, s95, 8192
    s_lshl_b32 s90, s39, 5
    s_sub_u32 s48, s47, 6
    s_cmp_lt_u32 s47, 6
    s_cselect_b32 s68, s8, s12
    s_cselect_b32 s69, s9, s13
    s_cselect_b32 s70, s10, s14
    s_cselect_b32 s71, s11, s15
    s_cselect_b32 s46, s40, s41
    s_cselect_b32 s47, s47, s48
    s_lshl_b32 s47, s47, 6
    v_add_u32 v1, s47, v0
    v_mul_u32_u24 v2, 2731, v1
    v_lshrrev_b32 v2, 15, v2
    v_mul_u32_u24 v3, 12, v2
    v_sub_u32 v3, v1, v3
    v_bfe_u32 v4, v2, 3, 1
    v_lshlrev_b32 v4, 1, v4
    v_xor_b32 v3, v3, v4
    v_mul_lo_u32 v2, v2, s39
    v_lshl_add_u32 v2, v3, 4, v2
    v_add_u32 v33, s46, v2
    s_branch L_gm_k2_kernel_fin_d1
L_gm_k2_kernel_fin_z1:
    s_mov_b32 s68, s4
    s_mov_b32 s69, s5
    s_mov_b32 s70, 0
    s_mov_b32 s71, 0x20000
    s_mov_b32 s90, 0
    s_mov_b32 s95, 143360
    v_mov_b32 v33, 0
L_gm_k2_kernel_fin_d1:
    s_add_u32 s47, s36, 16
    s_mov_b32 s86, 0
    s_cmp_lt_u32 s47, 8
    s_cbranch_scc0 L_gm_k2_kernel_fin_w2
    s_mov_b32 s72, s4
    s_mov_b32 s73, s5
    s_mov_b32 s74, s6
    s_mov_b32 s75, s7
    s_mov_b32 s91, 64
    s_lshl_b32 s96, s47, 10
    v_lshrrev_b32 v1, 2, v0
    s_lshl_b32 s48, s47, 4
    s_add_u32 s48, s48, s37
    v_add_u32 v1, s48, v1
    v_mul_lo_u32 v34, v1, s38
    v_and_b32 v2, 3, v0
    v_lshrrev_b32 v3, 5, v0
    v_lshlrev_b32 v3, 1, v3
    v_xor_b32 v2, v2, v3
    v_lshl_add_u32 v34, v2, 4, v34
    s_branch L_gm_k2_kernel_fin_d2
L_gm_k2_kernel_fin_w2:
    s_cmp_lt_u32 s47, 20
    s_cbranch_scc0 L_gm_k2_kernel_fin_z2
    s_sub_u32 s47, s47, 8
    s_lshl_b32 s96, s47, 10
    s_add_u32 s96, s96, 8192
    s_lshl_b32 s91, s39, 5
    s_sub_u32 s48, s47, 6
    s_cmp_lt_u32 s47, 6
    s_cselect_b32 s72, s8, s12
    s_cselect_b32 s73, s9, s13
    s_cselect_b32 s74, s10, s14
    s_cselect_b32 s75, s11, s15
    s_cselect_b32 s46, s40, s41
    s_cselect_b32 s47, s47, s48
    s_lshl_b32 s47, s47, 6
    v_add_u32 v1, s47, v0
    v_mul_u32_u24 v2, 2731, v1
    v_lshrrev_b32 v2, 15, v2
    v_mul_u32_u24 v3, 12, v2
    v_sub_u32 v3, v1, v3
    v_bfe_u32 v4, v2, 3, 1
    v_lshlrev_b32 v4, 1, v4
    v_xor_b32 v3, v3, v4
    v_mul_lo_u32 v2, v2, s39
    v_lshl_add_u32 v2, v3, 4, v2
    v_add_u32 v34, s46, v2
    s_branch L_gm_k2_kernel_fin_d2
L_gm_k2_kernel_fin_z2:
    s_mov_b32 s72, s4
    s_mov_b32 s73, s5
    s_mov_b32 s74, 0
    s_mov_b32 s75, 0x20000
    s_mov_b32 s91, 0
    s_mov_b32 s96, 143360
    v_mov_b32 v34, 0
L_gm_k2_kernel_fin_d2:
    s_and_b32 s49, s36, 3
    s_lshr_b32 s50, s36, 2
    v_and_b32 v1, 15, v0
    s_lshl_b32 s47, s49, 5
    v_add_u32 v1, s47, v1
    v_lshlrev_b32 v1, 6, v1
    v_lshrrev_b32 v2, 4, v0
    v_bfe_u32 v3, v0, 3, 1
    v_lshlrev_b32 v3, 1, v3
    v_xor_b32 v2, v2, v3
    v_lshl_add_u32 v7, v2, 4, v1
    v_lshrrev_b32 v1, 4, v0
    v_bfe_u32 v2, v0, 2, 2
    v_lshl_add_u32 v2, v1, 3, v2
    v_mul_u32_u24 v2, 192, v2
    v_and_b32 v3, 1, v0
    v_lshl_add_u32 v2, v3, 3, v2
    v_add_u32 v2, 8192, v2
    v_and_b32 v1, 1, v1
    v_lshlrev_b32 v1, 1, v1
    v_bfe_u32 v3, v0, 1, 1
    s_mul_i32 s47, s50, 6
    v_add_u32 v3, s47, v3
    v_add_u32 v4, 0, v3
    v_xor_b32 v8, v4, v1
    v_lshl_add_u32 v60, v8, 4, v2
    v_add_u32 v4, 2, v3
    v_xor_b32 v8, v4, v1
    v_lshl_add_u32 v61, v8, 4, v2
    v_add_u32 v4, 4, v3
    v_xor_b32 v8, v4, v1
    v_lshl_add_u32 v62, v8, 4, v2
    v_add_u32 v56, 40960, v60
    v_add_u32 v57, 40960, v61
    v_add_u32 v58, 40960, v62
    v_add_u32 v63, 40960, v7
    s_add_u32 m0, s94, 0
    s_nop 0
    buffer_load_dwordx4 v32, s[64:67], s84 offen lds
    s_add_u32 s84, s84, s89
    s_add_u32 m0, s95, 0
    s_nop 0
    buffer_load_dwordx4 v33, s[68:71], s85 offen lds
    s_add_u32 s85, s85, s90
    s_add_u32 m0, s96, 0
    s_nop 0
    buffer_load_dwordx4 v34, s[72:75], s86 offen lds
    s_add_u32 s86, s86, s91
    s_add_u32 m0, s94, 20480
    s_nop 0
    buffer_load_dwordx4 v32, s[64:67], s84 offen lds
    s_add_u32 s84, s84, s89
    s_add_u32 m0, s95, 20480
    s_nop 0
    buffer_load_dwordx4 v33, s[68:71], s85 offen lds
    s_add_u32 s85, s85, s90
    s_add_u32 m0, s96, 20480
    s_nop 0
    buffer_load_dwordx4 v34, s[72:75], s86 offen lds
    s_add_u32 s86, s86, s91
    s_add_u32 m0, s94, 40960
    s_nop 0
    buffer_load_dwordx4 v32, s[64:67], s84 offen lds
    s_add_u32 s84, s84, s89
    s_add_u32 m0, s95, 40960
    s_nop 0
    buffer_load_dwordx4 v33, s[68:71], s85 offen lds
    s_add_u32 s85, s85, s90
    s_add_u32 m0, s96, 40960
    s_nop 0
    buffer_load_dwordx4 v34, s[72:75], s86 offen lds
    s_add_u32 s86, s86, s91
    v_mov_b32 v72, 0
    v_mov_b32 v73, 0
    v_mov_b32 v74, 0
    v_mov_b32 v75, 0
    v_mov_b32 v76, 0
    v_mov_b32 v77, 0
    v_mov_b32 v78, 0
    v_mov_b32 v79, 0
    v_mov_b32 v80, 0
    v_mov_b32 v81, 0
    v_mov_b32 v82, 0
    v_mov_b32 v83, 0
    v_mov_b32 v84, 0
    v_mov_b32 v85, 0
    v_mov_b32 v86, 0
    v_mov_b32 v87, 0
    v_mov_b32 v88, 0
    v_mov_b32 v89, 0
    v_mov_b32 v90, 0
    v_mov_b32 v91, 0
    v_mov_b32 v92, 0
    v_mov_b32 v93, 0
    v_mov_b32 v94, 0
    v_mov_b32 v95, 0
    v_mov_b32 v96, 0
    v_mov_b32 v97, 0
    v_mov_b32 v98, 0
    v_mov_b32 v99, 0
    v_mov_b32 v100, 0
    v_mov_b32 v101, 0
    v_mov_b32 v102, 0
    v_mov_b32 v103, 0
    v_mov_b32 v104, 0
    v_mov_b32 v105, 0
    v_mov_b32 v106, 0
    v_mov_b32 v107, 0
    v_mov_b32 v108, 0
    v_mov_b32 v109, 0
    v_mov_b32 v110, 0
    v_mov_b32 v111, 0
    v_mov_b32 v112, 0
    v_mov_b32 v113, 0
    v_mov_b32 v114, 0
    v_mov_b32 v115, 0
    v_mov_b32 v116, 0
    v_mov_b32 v117, 0
    v_mov_b32 v118, 0
    v_mov_b32 v119, 0
    s_waitcnt vmcnt(6)
    s_barrier
    ds_read_b64_tr_b16 v[8:9], v60 offset:0
    ds_read_b64_tr_b16 v[10:11], v60 offset:768
    ds_read_b64_tr_b16 v[12:13], v61 offset:0
    ds_read_b64_tr_b16 v[14:15], v61 offset:768
    ds_read_b64_tr_b16 v[16:17], v62 offset:0
    ds_read_b64_tr_b16 v[18:19], v62 offset:768
    ds_read_b64_tr_b16 v[20:21], v60 offset:6144
    ds_read_b64_tr_b16 v[22:23], v60 offset:6912
    ds_read_b64_tr_b16 v[24:25], v61 offset:6144
    ds_read_b64_tr_b16 v[26:27], v61 offset:6912
    ds_read_b128 v[40:43], v7 offset:0
    ds_read_b128 v[44:47], v7 offset:1024
    ds_read_b64_tr_b16 v[28:29], v62 offset:6144
    ds_read_b64_tr_b16 v[30:31], v62 offset:6912
L_gm_k2_kernel_fin_loopa:
    s_waitcnt vmcnt(3)
    s_barrier
    s_waitcnt lgkmcnt(3)
    v_mfma_f32_16x16x32_bf16 v[72:75], v[8:11], v[40:43], v[72:75]
    s_waitcnt lgkmcnt(2)
    v_mfma_f32_16x16x32_bf16 v[76:79], v[8:11], v[44:47], v[76:79]
    s_add_u32 m0, s94, 61440
    s_nop 0
    buffer_load_dwordx4 v32, s[64:67], s84 offen lds
    s_add_u32 s84, s84, s89
    ds_read_b64_tr_b16 v[8:9], v60 offset:20480
    ds_read_b64_tr_b16 v[10:11], v60 offset:21248
    v_mfma_f32_16x16x32_bf16 v[80:83], v[12:15], v[40:43], v[80:83]
    v_mfma_f32_16x16x32_bf16 v[84:87], v[12:15], v[44:47], v[84:87]
    s_add_u32 m0, s95, 61440
    s_nop 0
    buffer_load_dwordx4 v33, s[68:71], s85 offen lds
    s_add_u32 s85, s85, s90
    ds_read_b64_tr_b16 v[12:13], v61 offset:20480
    ds_read_b64_tr_b16 v[14:15], v61 offset:21248
    v_mfma_f32_16x16x32_bf16 v[88:91], v[16:19], v[40:43], v[88:91]
    v_mfma_f32_16x16x32_bf16 v[92:95], v[16:19], v[44:47], v[92:95]
    s_add_u32 m0, s96, 61440
    s_nop 0
    buffer_load_dwordx4 v34, s[72:75], s86 offen lds
    s_add_u32 s86, s86, s91
    ds_read_b64_tr_b16 v[16:17], v62 offset:20480
    ds_read_b64_tr_b16 v[18:19], v62 offset:21248
    v_mfma_f32_16x16x32_bf16 v[96:99], v[20:23], v[40:43], v[96:99]
    v_mfma_f32_16x16x32_bf16 v[100:103], v[20:23], v[44:47], v[100:103]
    ds_read_b64_tr_b16 v[20:21], v60 offset:26624
    ds_read_b64_tr_b16 v[22:23], v60 offset:27392
    v_mfma_f32_16x16x32_bf16 v[104:107], v[24:27], v[40:43], v[104:107]
    v_mfma_f32_16x16x32_bf16 v[108:111], v[24:27], v[44:47], v[108:111]
    ds_read_b64_tr_b16 v[24:25], v61 offset:26624
    ds_read_b64_tr_b16 v[26:27], v61 offset:27392
    s_waitcnt lgkmcnt(10)
    v_mfma_f32_16x16x32_bf16 v[112:115], v[28:31], v[40:43], v[112:115]
    ds_read_b128 v[40:43], v7 offset:20480
    v_mfma_f32_16x16x32_bf16 v[116:119], v[28:31], v[44:47], v[116:119]
    ds_read_b128 v[44:47], v7 offset:21504
    ds_read_b64_tr_b16 v[28:29], v62 offset:26624
    ds_read_b64_tr_b16 v[30:31], v62 offset:27392
    s_waitcnt vmcnt(3)
    s_barrier
    s_waitcnt lgkmcnt(3)
    v_mfma_f32_16x16x32_bf16 v[72:75], v[8:11], v[40:43], v[72:75]
    s_waitcnt lgkmcnt(2)
    v_mfma_f32_16x16x32_bf16 v[76:79], v[8:11], v[44:47], v[76:79]
    s_add_u32 m0, s94, 0
    s_nop 0
    buffer_load_dwordx4 v32, s[64:67], s84 offen lds
    s_add_u32 s84, s84, s89
    ds_read_b64_tr_b16 v[8:9], v56 offset:0
    ds_read_b64_tr_b16 v[10:11], v56 offset:768
    v_mfma_f32_16x16x32_bf16 v[80:83], v[12:15], v[40:43], v[80:83]
    v_mfma_f32_16x16x32_bf16 v[84:87], v[12:15], v[44:47], v[84:87]
    s_add_u32 m0, s95, 0
    s_nop 0
    buffer_load_dwordx4 v33, s[68:71], s85 offen lds
    s_add_u32 s85, s85, s90
    ds_read_b64_tr_b16 v[12:13], v57 offset:0
    ds_read_b64_tr_b16 v[14:15], v57 offset:768
    v_mfma_f32_16x16x32_bf16 v[88:91], v[16:19], v[40:43], v[88:91]
    v_mfma_f32_16x16x32_bf16 v[92:95], v[16:19], v[44:47], v[92:95]
    s_add_u32 m0, s96, 0
    s_nop 0
    buffer_load_dwordx4 v34, s[72:75], s86 offen lds
    s_add_u32 s86, s86, s91
    ds_read_b64_tr_b16 v[16:17], v58 offset:0
    ds_read_b64_tr_b16 v[18:19], v58 offset:768
    v_mfma_f32_16x16x32_bf16 v[96:99], v[20:23], v[40:43], v[96:99]
    v_mfma_f32_16x16x32_bf16 v[100:103], v[20:23], v[44:47], v[100:103]
    ds_read_b64_tr_b16 v[20:21], v56 offset:6144
    ds_read_b64_tr_b16 v[22:23], v56 offset:6912
    v_mfma_f32_16x16x32_bf16 v[104:107], v[24:27], v[40:43], v[104:107]
    v_mfma_f32_16x16x32_bf16 v[108:111], v[24:27], v[44:47], v[108:111]
    ds_read_b64_tr_b16 v[24:25], v57 offset:6144
    ds_read_b64_tr_b16 v[26:27], v57 offset:6912
    s_waitcnt lgkmcnt(10)
    v_mfma_f32_16x16x32_bf16 v[112:115], v[28:31], v[40:43], v[112:115]
    ds_read_b128 v[40:43], v63 offset:0
    v_mfma_f32_16x16x32_bf16 v[116:119], v[28:31], v[44:47], v[116:119]
    ds_read_b128 v[44:47], v63 offset:1024
    ds_read_b64_tr_b16 v[28:29], v58 offset:6144
    ds_read_b64_tr_b16 v[30:31], v58 offset:6912
    s_waitcnt vmcnt(3)
    s_barrier
    s_waitcnt lgkmcnt(3)
    v_mfma_f32_16x16x32_bf16 v[72:75], v[8:11], v[40:43], v[72:75]
    s_waitcnt lgkmcnt(2)
    v_mfma_f32_16x16x32_bf16 v[76:79], v[8:11], v[44:47], v[76:79]
    s_add_u32 m0, s94, 20480
    s_nop 0
    buffer_load_dwordx4 v32, s[64:67], s84 offen lds
    s_add_u32 s84, s84, s89
    ds_read_b64_tr_b16 v[8:9], v56 offset:20480
    ds_read_b64_tr_b16 v[10:11], v56 offset:21248
    v_mfma_f32_16x16x32_bf16 v[80:83], v[12:15], v[40:43], v[80:83]
    v_mfma_f32_16x16x32_bf16 v[84:87], v[12:15], v[44:47], v[84:87]
    s_add_u32 m0, s95, 20480
    s_nop 0
    buffer_load_dwordx4 v33, s[68:71], s85 offen lds
    s_add_u32 s85, s85, s90
    ds_read_b64_tr_b16 v[12:13], v57 offset:20480
    ds_read_b64_tr_b16 v[14:15], v57 offset:21248
    v_mfma_f32_16x16x32_bf16 v[88:91], v[16:19], v[40:43], v[88:91]
    v_mfma_f32_16x16x32_bf16 v[92:95], v[16:19], v[44:47], v[92:95]
    s_add_u32 m0, s96, 20480
    s_nop 0
    buffer_load_dwordx4 v34, s[72:75], s86 offen lds
    s_add_u32 s86, s86, s91
    ds_read_b64_tr_b16 v[16:17], v58 offset:20480
    ds_read_b64_tr_b16 v[18:19], v58 offset:21248
    v_mfma_f32_16x16x32_bf16 v[96:99], v[20:23], v[40:43], v[96:99]
    v_mfma_f32_16x16x32_bf16 v[100:103], v[20:23], v[44:47], v[100:103]
    ds_read_b64_tr_b16 v[20:21], v56 offset:26624
    ds_read_b64_tr_b16 v[22:23], v56 offset:27392
    v_mfma_f32_16x16x32_bf16 v[104:107], v[24:27], v[40:43], v[104:107]
    v_mfma_f32_16x16x32_bf16 v[108:111], v[24:27], v[44:47], v[108:111]
    ds_read_b64_tr_b16 v[24:25], v57 offset:26624
    ds_read_b64_tr_b16 v[26:27], v57 offset:27392
    s_waitcnt lgkmcnt(10)
    v_mfma_f32_16x16x32_bf16 v[112:115], v[28:31], v[40:43], v[112:115]
    ds_read_b128 v[40:43], v63 offset:20480
    v_mfma_f32_16x16x32_bf16 v[116:119], v[28:31], v[44:47], v[116:119]
    ds_read_b128 v[44:47], v63 offset:21504
    ds_read_b64_tr_b16 v[28:29], v58 offset:26624
    ds_read_b64_tr_b16 v[30:31], v58 offset:27392
    s_waitcnt vmcnt(3)
    s_barrier
    s_waitcnt lgkmcnt(3)
    v_mfma_f32_16x16x32_bf16 v[72:75], v[8:11], v[40:43], v[72:75]
    s_waitcnt lgkmcnt(2)
    v_mfma_f32_16x16x32_bf16 v[76:79], v[8:11], v[44:47], v[76:79]
    s_add_u32 m0, s94, 40960
    s_nop 0
    buffer_load_dwordx4 v32, s[64:67], s84 offen lds
    s_add_u32 s84, s84, s89
    ds_read_b64_tr_b16 v[8:9], v60 offset:0
    ds_read_b64_tr_b16 v[10:11], v60 offset:768
    v_mfma_f32_16x16x32_bf16 v[80:83], v[12:15], v[40:43], v[80:83]
    v_mfma_f32_16x16x32_bf16 v[84:87], v[12:15], v[44:47], v[84:87]
    s_add_u32 m0, s95, 40960
    s_nop 0
    buffer_load_dwordx4 v33, s[68:71], s85 offen lds
    s_add_u32 s85, s85, s90
    ds_read_b64_tr_b16 v[12:13], v61 offset:0
    ds_read_b64_tr_b16 v[14:15], v61 offset:768
    v_mfma_f32_16x16x32_bf16 v[88:91], v[16:19], v[40:43], v[88:91]
    v_mfma_f32_16x16x32_bf16 v[92:95], v[16:19], v[44:47], v[92:95]
    s_add_u32 m0, s96, 40960
    s_nop 0
    buffer_load_dwordx4 v34, s[72:75], s86 offen lds
    s_add_u32 s86, s86, s91
    ds_read_b64_tr_b16 v[16:17], v62 offset:0
    ds_read_b64_tr_b16 v[18:19], v62 offset:768
    v_mfma_f32_16x16x32_bf16 v[96:99], v[20:23], v[40:43], v[96:99]
    v_mfma_f32_16x16x32_bf16 v[100:103], v[20:23], v[44:47], v[100:103]
    ds_read_b64_tr_b16 v[20:21], v60 offset:6144
    ds_read_b64_tr_b16 v[22:23], v60 offset:6912
    v_mfma_f32_16x16x32_bf16 v[104:107], v[24:27], v[40:43], v[104:107]
    v_mfma_f32_16x16x32_bf16 v[108:111], v[24:27], v[44:47], v[108:111]
    ds_read_b64_tr_b16 v[24:25], v61 offset:6144
    ds_read_b64_tr_b16 v[26:27], v61 offset:6912
    s_waitcnt lgkmcnt(10)
    v_mfma_f32_16x16x32_bf16 v[112:115], v[28:31], v[40:43], v[112:115]
    ds_read_b128 v[40:43], v7 offset:0
    v_mfma_f32_16x16x32_bf16 v[116:119], v[28:31], v[44:47], v[116:119]
    ds_read_b128 v[44:47], v7 offset:1024
    ds_read_b64_tr_b16 v[28:29], v62 offset:6144
    ds_read_b64_tr_b16 v[30:31], v62 offset:6912
    s_sub_u32 s62, s62, 1
    s_cmp_lg_u32 s62, 0
    s_cbranch_scc1 L_gm_k2_kernel_fin_loopa
    s_waitcnt vmcnt(3)
    s_barrier
    s_waitcnt lgkmcnt(3)
    v_mfma_f32_16x16x32_bf16 v[72:75], v[8:11], v[40:43], v[72:75]
    s_waitcnt lgkmcnt(2)
    v_mfma_f32_16x16x32_bf16 v[76:79], v[8:11], v[44:47], v[76:79]
    s_add_u32 m0, s94, 61440
    s_nop 0
    buffer_load_dwordx4 v32, s[64:67], s84 offen lds
    s_add_u32 s84, s84, s89
    ds_read_b64_tr_b16 v[8:9], v60 offset:20480
    ds_read_b64_tr_b16 v[10:11], v60 offset:21248
    v_mfma_f32_16x16x32_bf16 v[80:83], v[12:15], v[40:43], v[80:83]
    v_mfma_f32_16x16x32_bf16 v[84:87], v[12:15], v[44:47], v[84:87]
    s_add_u32 m0, s95, 61440
    s_nop 0
    buffer_load_dwordx4 v33, s[68:71], s85 offen lds
    s_add_u32 s85, s85, s90
    ds_read_b64_tr_b16 v[12:13], v61 offset:20480
    ds_read_b64_tr_b16 v[14:15], v61 offset:21248
    v_mfma_f32_16x16x32_bf16 v[88:91], v[16:19], v[40:43], v[88:91]
    v_mfma_f32_16x16x32_bf16 v[92:95], v[16:19], v[44:47], v[92:95]
    s_add_u32 m0, s96, 61440
    s_nop 0
    buffer_load_dwordx4 v34, s[72:75], s86 offen lds
    s_add_u32 s86, s86, s91
    ds_read_b64_tr_b16 v[16:17], v62 offset:20480
    ds_read_b64_tr_b16 v[18:19], v62 offset:21248
    v_mfma_f32_16x16x32_bf16 v[96:99], v[20:23], v[40:43], v[96:99]
    v_mfma_f32_16x16x32_bf16 v[100:103], v[20:23], v[44:47], v[100:103]
    ds_read_b64_tr_b16 v[20:21], v60 offset:26624
    ds_read_b64_tr_b16 v[22:23], v60 offset:27392
    v_mfma_f32_16x16x32_bf16 v[104:107], v[24:27], v[40:43], v[104:107]
    v_mfma_f32_16x16x32_bf16 v[108:111], v[24:27], v[44:47], v[108:111]
    ds_read_b64_tr_b16 v[24:25], v61 offset:26624
    ds_read_b64_tr_b16 v[26:27], v61 offset:27392
    s_waitcnt lgkmcnt(10)
    v_mfma_f32_16x16x32_bf16 v[112:115], v[28:31], v[40:43], v[112:115]
    ds_read_b128 v[40:43], v7 offset:20480
    v_mfma_f32_16x16x32_bf16 v[116:119], v[28:31], v[44:47], v[116:119]
    ds_read_b128 v[44:47], v7 offset:21504
    ds_read_b64_tr_b16 v[28:29], v62 offset:26624
    ds_read_b64_tr_b16 v[30:31], v62 offset:27392
    s_waitcnt vmcnt(3)
    s_barrier
    s_waitcnt lgkmcnt(3)
    v_mfma_f32_16x16x32_bf16 v[72:75], v[8:11], v[40:43], v[72:75]
    s_waitcnt lgkmcnt(2)
    v_mfma_f32_16x16x32_bf16 v[76:79], v[8:11], v[44:47], v[76:79]
    ds_read_b64_tr_b16 v[8:9], v56 offset:0
    ds_read_b64_tr_b16 v[10:11], v56 offset:768
    v_mfma_f32_16x16x32_bf16 v[80:83], v[12:15], v[40:43], v[80:83]
    v_mfma_f32_16x16x32_bf16 v[84:87], v[12:15], v[44:47], v[84:87]
    ds_read_b64_tr_b16 v[12:13], v57 offset:0
    ds_read_b64_tr_b16 v[14:15], v57 offset:768
    v_mfma_f32_16x16x32_bf16 v[88:91], v[16:19], v[40:43], v[88:91]
    v_mfma_f32_16x16x32_bf16 v[92:95], v[16:19], v[44:47], v[92:95]
    ds_read_b64_tr_b16 v[16:17], v58 offset:0
    ds_read_b64_tr_b16 v[18:19], v58 offset:768
    v_mfma_f32_16x16x32_bf16 v[96:99], v[20:23], v[40:43], v[96:99]
    v_mfma_f32_16x16x32_bf16 v[100:103], v[20:23], v[44:47], v[100:103]
    ds_read_b64_tr_b16 v[20:21], v56 offset:6144
    ds_read_b64_tr_b16 v[22:23], v56 offset:6912
    v_mfma_f32_16x16x32_bf16 v[104:107], v[24:27], v[40:43], v[104:107]
    v_mfma_f32_16x16x32_bf16 v[108:111], v[24:27], v[44:47], v[108:111]
    ds_read_b64_tr_b16 v[24:25], v57 offset:6144
    ds_read_b64_tr_b16 v[26:27], v57 offset:6912
    s_waitcnt lgkmcnt(10)
    v_mfma_f32_16x16x32_bf16 v[112:115], v[28:31], v[40:43], v[112:115]
    ds_read_b128 v[40:43], v63 offset:0
    v_mfma_f32_16x16x32_bf16 v[116:119], v[28:31], v[44:47], v[116:119]
    ds_read_b128 v[44:47], v63 offset:1024
    ds_read_b64_tr_b16 v[28:29], v58 offset:6144
    ds_read_b64_tr_b16 v[30:31], v58 offset:6912
    s_waitcnt vmcnt(0)
    s_barrier
    s_waitcnt lgkmcnt(3)
    v_mfma_f32_16x16x32_bf16 v[72:75], v[8:11], v[40:43], v[72:75]
    s_waitcnt lgkmcnt(2)
    v_mfma_f32_16x16x32_bf16 v[76:79], v[8:11], v[44:47], v[76:79]
    ds_read_b64_tr_b16 v[8:9], v56 offset:20480
    ds_read_b64_tr_b16 v[10:11], v56 offset:21248
    v_mfma_f32_16x16x32_bf16 v[80:83], v[12:15], v[40:43], v[80:83]
    v_mfma_f32_16x16x32_bf16 v[84:87], v[12:15], v[44:47], v[84:87]
    ds_read_b64_tr_b16 v[12:13], v57 offset:20480
    ds_read_b64_tr_b16 v[14:15], v57 offset:21248
    v_mfma_f32_16x16x32_bf16 v[88:91], v[16:19], v[40:43], v[88:91]
    v_mfma_f32_16x16x32_bf16 v[92:95], v[16:19], v[44:47], v[92:95]
    ds_read_b64_tr_b16 v[16:17], v58 offset:20480
    ds_read_b64_tr_b16 v[18:19], v58 offset:21248
    v_mfma_f32_16x16x32_bf16 v[96:99], v[20:23], v[40:43], v[96:99]
    v_mfma_f32_16x16x32_bf16 v[100:103], v[20:23], v[44:47], v[100:103]
    ds_read_b64_tr_b16 v[20:21], v56 offset:26624
    ds_read_b64_tr_b16 v[22:23], v56 offset:27392
    v_mfma_f32_16x16x32_bf16 v[104:107], v[24:27], v[40:43], v[104:107]
    v_mfma_f32_16x16x32_bf16 v[108:111], v[24:27], v[44:47], v[108:111]
    ds_read_b64_tr_b16 v[24:25], v57 offset:26624
    ds_read_b64_tr_b16 v[26:27], v57 offset:27392
    s_waitcnt lgkmcnt(10)
    v_mfma_f32_16x16x32_bf16 v[112:115], v[28:31], v[40:43], v[112:115]
    ds_read_b128 v[40:43], v63 offset:20480
    v_mfma_f32_16x16x32_bf16 v[116:119], v[28:31], v[44:47], v[116:119]
    ds_read_b128 v[44:47], v63 offset:21504
    ds_read_b64_tr_b16 v[28:29], v58 offset:26624
    ds_read_b64_tr_b16 v[30:31], v58 offset:27392
    s_waitcnt lgkmcnt(3)
    v_mfma_f32_16x16x32_bf16 v[72:75], v[8:11], v[40:43], v[72:75]
    s_waitcnt lgkmcnt(2)
    v_mfma_f32_16x16x32_bf16 v[76:79], v[8:11], v[44:47], v[76:79]
    v_mfma_f32_16x16x32_bf16 v[80:83], v[12:15], v[40:43], v[80:83]
    v_mfma_f32_16x16x32_bf16 v[84:87], v[12:15], v[44:47], v[84:87]
    v_mfma_f32_16x16x32_bf16 v[88:91], v[16:19], v[40:43], v[88:91]
    v_mfma_f32_16x16x32_bf16 v[92:95], v[16:19], v[44:47], v[92:95]
    v_mfma_f32_16x16x32_bf16 v[96:99], v[20:23], v[40:43], v[96:99]
    v_mfma_f32_16x16x32_bf16 v[100:103], v[20:23], v[44:47], v[100:103]
    v_mfma_f32_16x16x32_bf16 v[104:107], v[24:27], v[40:43], v[104:107]
    v_mfma_f32_16x16x32_bf16 v[108:111], v[24:27], v[44:47], v[108:111]
    s_waitcnt lgkmcnt(0)
    v_mfma_f32_16x16x32_bf16 v[112:115], v[28:31], v[40:43], v[112:115]
    v_mfma_f32_16x16x32_bf16 v[116:119], v[28:31], v[44:47], v[116:119]
    s_nop 7
    s_nop 1
    v_and_b32 v1, 15, v0
    s_lshl_b32 s47, s49, 5
    s_add_u32 s47, s47, s37
    v_add_u32 v1, s47, v1
    v_mul_u32_u24 v1, 2304, v1
    v_lshrrev_b32 v2, 4, v0
    v_lshl_add_u32 v1, v2, 4, v1
    s_mul_i32 s56, s50, 192
    s_lshl_b32 s57, s40, 1
    s_add_u32 s56, s56, s57
    s_mul_i32 s57, s34, 4718592
    s_add_u32 s56, s56, s57
    s_add_u32 s56, s56, 50331648
    v_add_u32 v1, s56, v1
    s_mov_b32 s58, 0
    buffer_store_dwordx4 v[72:75], v1, s[16:19], s58 offen offset:0
    buffer_store_dwordx4 v[80:83], v1, s[16:19], s58 offen offset:64
    buffer_store_dwordx4 v[88:91], v1, s[16:19], s58 offen offset:128
    buffer_store_dwordx4 v[96:99], v1, s[16:19], s58 offen offset:384
    buffer_store_dwordx4 v[104:107], v1, s[16:19], s58 offen offset:448
    buffer_store_dwordx4 v[112:115], v1, s[16:19], s58 offen offset:512
    s_mov_b32 s58, 36864
    buffer_store_dwordx4 v[76:79], v1, s[16:19], s58 offen offset:0
    buffer_store_dwordx4 v[84:87], v1, s[16:19], s58 offen offset:64
    buffer_store_dwordx4 v[92:95], v1, s[16:19], s58 offen offset:128
    buffer_store_dwordx4 v[100:103], v1, s[16:19], s58 offen offset:384
    buffer_store_dwordx4 v[108:111], v1, s[16:19], s58 offen offset:448
    buffer_store_dwordx4 v[116:119], v1, s[16:19], s58 offen offset:512
L_gm_k2_kernel_end:
    s_endpgm
.section .rodata,"a"
.p2align 6
.amdhsa_kernel gm_k2_kernel
  .amdhsa_next_free_vgpr 128
  .amdhsa_next_free_sgpr 102
  .amdhsa_accum_offset 128
  .amdhsa_group_segment_fixed_size 0
  .amdhsa_kernarg_size 88
  .amdhsa_user_sgpr_count 2
  .amdhsa_user_sgpr_kernarg_segment_ptr 1
  .amdhsa_system_sgpr_workgroup_id_x 1
.end_amdhsa_kernel
.text
.globl gated_mix__mha_block__glu_gated_bilinear__prompt_kernel
.p2align 8
.type gated_mix__mha_block__glu_gated_bilinear__prompt_kernel,@function
gated_mix__mha_block__glu_gated_bilinear__prompt_kernel:
    s_cmp_ge_u32 s2, 384
    s_cbranch_scc1 L_gated_mix__mha_block__glu_gated_bilinear__prompt_kernel_end
    v_lshrrev_b32 v1, 6, v0
    v_and_b32 v0, 63, v0
    s_nop 0
    v_readfirstlane_b32 s36, v1
    s_load_dwordx2 s[24:25], s[0:1], 80
    s_load_dwordx2 s[26:27], s[0:1], 0
    s_load_dwordx2 s[28:29], s[0:1], 16
    s_and_b32 s32, s2, 63
    s_lshr_b32 s33, s2, 6
    s_mov_b32 s34, 4
    s_mul_i32 s37, s32, 32
    s_waitcnt lgkmcnt(0)
    s_add_u32 s4, s24, 7340032
    s_addc_u32 s5, s25, 0
    s_and_b32 s5, s5, 0xffff
    s_mov_b32 s6, 2359296
    s_mov_b32 s7, 0x20000
    s_mov_b32 s8, s28
    s_and_b32 s9, s29, 0xffff
    s_mov_b32 s10, 663552
    s_mov_b32 s11, 0x20000
    s_mov_b32 s12, s28
    s_and_b32 s13, s29, 0xffff
    s_mov_b32 s14, 663552
    s_mov_b32 s15, 0x20000
    s_mov_b32 s38, 1152
    s_mov_b32 s39, 1152
    s_mul_i32 s40, s33, 192
    s_mov_b32 s41, s40
    s_mov_b32 s62, 2
    s_mov_b32 s16, s24
    s_and_b32 s17, s25, 0xffff
    s_mov_b32 s18, 268435456
    s_mov_b32 s19, 0x20000
    s_add_u32 s47, s36, 0
    s_mov_b32 s84, 0
    s_cmp_lt_u32 s47, 2
    s_cbranch_scc0 L_gated_mix__mha_block__glu_gated_bilinear__prompt_kernel_wo_w0
    s_mov_b32 s64, s4
    s_mov_b32 s65, s5
    s_mov_b32 s66, s6
    s_mov_b32 s67, s7
    s_mov_b32 s89, 64
    s_lshl_b32 s94, s47, 10
    v_lshrrev_b32 v1, 2, v0
    s_lshl_b32 s48, s47, 4
    s_add_u32 s48, s48, s37
    v_add_u32 v1, s48, v1
    v_mul_lo_u32 v32, v1, s38
    v_and_b32 v2, 3, v0
    v_lshrrev_b32 v3, 5, v0
    v_lshlrev_b32 v3, 1, v3
    v_xor_b32 v2, v2, v3
    v_lshl_add_u32 v32, v2, 4, v32
    s_branch L_gated_mix__mha_block__glu_gated_bilinear__prompt_kernel_wo_d0
L_gated_mix__mha_block__glu_gated_bilinear__prompt_kernel_wo_w0:
    s_cmp_lt_u32 s47, 8
    s_cbranch_scc0 L_gated_mix__mha_block__glu_gated_bilinear__prompt_kernel_wo_z0
    s_sub_u32 s47, s47, 2
    s_lshl_b32 s94, s47, 10
    s_add_u32 s94, s94, 2048
    s_lshl_b32 s89, s39, 5
    s_sub_u32 s48, s47, 6
    s_cmp_lt_u32 s47, 6
    s_cselect_b32 s64, s8, s12
    s_cselect_b32 s65, s9, s13
    s_cselect_b32 s66, s10, s14
    s_cselect_b32 s67, s11, s15
    s_cselect_b32 s46, s40, s41
    s_cselect_b32 s47, s47, s48
    s_lshl_b32 s47, s47, 6
    v_add_u32 v1, s47, v0
    v_mul_u32_u24 v2, 2731, v1
    v_lshrrev_b32 v2, 15, v2
    v_mul_u32_u24 v3, 12, v2
    v_sub_u32 v3, v1, v3
    v_bfe_u32 v4, v2, 3, 1
    v_lshlrev_b32 v4, 1, v4
    v_xor_b32 v3, v3, v4
    v_mul_lo_u32 v2, v2, s39
    v_lshl_add_u32 v2, v3, 4, v2
    v_add_u32 v32, s46, v2
    s_branch L_gated_mix__mha_block__glu_gated_bilinear__prompt_kernel_wo_d0
L_gated_mix__mha_block__glu_gated_bilinear__prompt_kernel_wo_z0:
    s_mov_b32 s64, s4
    s_mov_b32 s65, s5
    s_mov_b32 s66, 0
    s_mov_b32 s67, 0x20000
    s_mov_b32 s89, 0
    s_mov_b32 s94, 143360
    v_mov_b32 v32, 0
L_gated_mix__mha_block__glu_gated_bilinear__prompt_kernel_wo_d0:
    s_add_u32 s47, s36, 4
    s_mov_b32 s85, 0
    s_cmp_lt_u32 s47, 2
    s_cbranch_scc0 L_gated_mix__mha_block__glu_gated_bilinear__prompt_kernel_wo_w1
    s_mov_b32 s68, s4
    s_mov_b32 s69, s5
    s_mov_b32 s70, s6
    s_mov_b32 s71, s7
    s_mov_b32 s90, 64
    s_lshl_b32 s95, s47, 10
    v_lshrrev_b32 v1, 2, v0
    s_lshl_b32 s48, s47, 4
    s_add_u32 s48, s48, s37
    v_add_u32 v1, s48, v1
    v_mul_lo_u32 v33, v1, s38
    v_and_b32 v2, 3, v0
    v_lshrrev_b32 v3, 5, v0
    v_lshlrev_b32 v3, 1, v3
    v_xor_b32 v2, v2, v3
    v_lshl_add_u32 v33, v2, 4, v33
    s_branch L_gated_mix__mha_block__glu_gated_bilinear__prompt_kernel_wo_d1
L_gated_mix__mha_block__glu_gated_bilinear__prompt_kernel_wo_w1:
    s_cmp_lt_u32 s47, 8
    s_cbranch_scc0 L_gated_mix__mha_block__glu_gated_bilinear__prompt_kernel_wo_z1
    s_sub_u32 s47, s47, 2
    s_lshl_b32 s95, s47, 10
    s_add_u32 s95, s95, 2048
    s_lshl_b32 s90, s39, 5
    s_sub_u32 s48, s47, 6
    s_cmp_lt_u32 s47, 6
    s_cselect_b32 s68, s8, s12
    s_cselect_b32 s69, s9, s13
    s_cselect_b32 s70, s10, s14
    s_cselect_b32 s71, s11, s15
    s_cselect_b32 s46, s40, s41
    s_cselect_b32 s47, s47, s48
    s_lshl_b32 s47, s47, 6
    v_add_u32 v1, s47, v0
    v_mul_u32_u24 v2, 2731, v1
    v_lshrrev_b32 v2, 15, v2
    v_mul_u32_u24 v3, 12, v2
    v_sub_u32 v3, v1, v3
    v_bfe_u32 v4, v2, 3, 1
    v_lshlrev_b32 v4, 1, v4
    v_xor_b32 v3, v3, v4
    v_mul_lo_u32 v2, v2, s39
    v_lshl_add_u32 v2, v3, 4, v2
    v_add_u32 v33, s46, v2
    s_branch L_gated_mix__mha_block__glu_gated_bilinear__prompt_kernel_wo_d1
L_gated_mix__mha_block__glu_gated_bilinear__prompt_kernel_wo_z1:
    s_mov_b32 s68, s4
    s_mov_b32 s69, s5
    s_mov_b32 s70, 0
    s_mov_b32 s71, 0x20000
    s_mov_b32 s90, 0
    s_mov_b32 s95, 143360
    v_mov_b32 v33, 0
L_gated_mix__mha_block__glu_gated_bilinear__prompt_kernel_wo_d1:
    s_and_b32 s49, s36, 1
    s_lshr_b32 s50, s36, 1
    v_and_b32 v1, 15, v0
    s_lshl_b32 s47, s49, 4
    v_add_u32 v1, s47, v1
    v_lshlrev_b32 v1, 6, v1
    v_lshrrev_b32 v2, 4, v0
    v_bfe_u32 v3, v0, 3, 1
    v_lshlrev_b32 v3, 1, v3
    v_xor_b32 v2, v2, v3
    v_lshl_add_u32 v7, v2, 4, v1
    v_lshrrev_b32 v1, 4, v0
    v_bfe_u32 v2, v0, 2, 2
    v_lshl_add_u32 v2, v1, 3, v2
    v_mul_u32_u24 v2, 192, v2
    v_and_b32 v3, 1, v0
    v_lshl_add_u32 v2, v3, 3, v2
    v_add_u32 v2, 2048, v2
    v_and_b32 v1, 1, v1
    v_lshlrev_b32 v1, 1, v1
    v_bfe_u32 v3, v0, 1, 1
    s_mul_i32 s47, s50, 6
    v_add_u32 v3, s47, v3
    v_add_u32 v4, 0, v3
    v_xor_b32 v8, v4, v1
    v_lshl_add_u32 v60, v8, 4, v2
    v_add_u32 v4, 2, v3
    v_xor_b32 v8, v4, v1
    v_lshl_add_u32 v61, v8, 4, v2
    v_add_u32 v4, 4, v3
    v_xor_b32 v8, v4, v1
    v_lshl_add_u32 v62, v8, 4, v2
    v_add_u32 v56, 16384, v60
    v_add_u32 v57, 16384, v61
    v_add_u32 v58, 16384, v62
    v_add_u32 v63, 16384, v7
    v_add_u32 v64, 32768, v60
    v_add_u32 v65, 32768, v61
    v_add_u32 v66, 32768, v62
    v_add_u32 v67, 32768, v7
    v_and_b32 v1, 15, v0
    s_lshl_b32 s47, s49, 4
    s_add_u32 s47, s47, s37
    v_add_u32 v1, s47, v1
    v_lshlrev_b32 v5, 3, v1
    s_mov_b32 s56, 7208960
    buffer_load_dwordx2 v[100:101], v5, s[16:19], s56 offen offset:0
    v_mul_u32_u24 v2, 2304, v1
    v_lshrrev_b32 v3, 4, v0
    v_lshl_add_u32 v2, v3, 4, v2
    s_mul_i32 s56, s50, 192
    s_lshl_b32 s57, s40, 1
    s_add_u32 s56, s56, s57
    s_add_u32 s56, s56, 50331648
    s_add_u32 s58, s56, 0
    buffer_load_dwordx4 v[104:107], v2, s[16:19], s58 offen offset:0
    s_add_u32 s58, s56, 4718592
    buffer_load_dwordx4 v[108:111], v2, s[16:19], s58 offen offset:0
    s_add_u32 s58, s56, 9437184
    buffer_load_dwordx4 v[112:115], v2, s[16:19], s58 offen offset:0
    s_add_u32 s58, s56, 0
    buffer_load_dwordx4 v[120:123], v2, s[16:19], s58 offen offset:64
    s_add_u32 s58, s56, 4718592
    buffer_load_dwordx4 v[124:127], v2, s[16:19], s58 offen offset:64
    s_add_u32 s58, s56, 9437184
    buffer_load_dwordx4 v[128:131], v2, s[16:19], s58 offen offset:64
    s_add_u32 s58, s56, 0
    buffer_load_dwordx4 v[136:139], v2, s[16:19], s58 offen offset:128
    s_add_u32 s58, s56, 4718592
    buffer_load_dwordx4 v[140:143], v2, s[16:19], s58 offen offset:128
    s_add_u32 s58, s56, 9437184
    buffer_load_dwordx4 v[144:147], v2, s[16:19], s58 offen offset:128
    s_add_u32 m0, s94, 0
    s_nop 0
    buffer_load_dwordx4 v32, s[64:67], s84 offen lds
    s_add_u32 s84, s84, s89
    s_add_u32 m0, s95, 0
    s_nop 0
    buffer_load_dwordx4 v33, s[68:71], s85 offen lds
    s_add_u32 s85, s85, s90
    s_add_u32 m0, s94, 8192
    s_nop 0
    buffer_load_dwordx4 v32, s[64:67], s84 offen lds
    s_add_u32 s84, s84, s89
    s_add_u32 m0, s95, 8192
    s_nop 0
    buffer_load_dwordx4 v33, s[68:71], s85 offen lds
    s_add_u32 s85, s85, s90
    s_add_u32 m0, s94, 16384
    s_nop 0
    buffer_load_dwordx4 v32, s[64:67], s84 offen lds
    s_add_u32 s84, s84, s89
    s_add_u32 m0, s95, 16384
    s_nop 0
    buffer_load_dwordx4 v33, s[68:71], s85 offen lds
    s_add_u32 s85, s85, s90
    s_add_u32 m0, s94, 24576
    s_nop 0
    buffer_load_dwordx4 v32, s[64:67], s84 offen lds
    s_add_u32 s84, s84, s89
    s_add_u32 m0, s95, 24576
    s_nop 0
    buffer_load_dwordx4 v33, s[68:71], s85 offen lds
    s_add_u32 s85, s85, s90
    v_mov_b32 v72, 0
    v_mov_b32 v73, 0
    v_mov_b32 v74, 0
    v_mov_b32 v75, 0
    v_mov_b32 v76, 0
    v_mov_b32 v77, 0
    v_mov_b32 v78, 0
    v_mov_b32 v79, 0
    v_mov_b32 v80, 0
    v_mov_b32 v81, 0
    v_mov_b32 v82, 0
    v_mov_b32 v83, 0
    s_load_dwordx2 s[30:31], s[0:1], 64
    s_waitcnt vmcnt(4)
    s_barrier
    ds_read_b64_tr_b16 v[8:9], v60 offset:0
    ds_read_b64_tr_b16 v[10:11], v60 offset:768
    ds_read_b64_tr_b16 v[12:13], v61 offset:0
    ds_read_b64_tr_b16 v[14:15], v61 offset:768
    ds_read_b128 v[40:43], v7 offset:0
    ds_read_b64_tr_b16 v[16:17], v62 offset:0
    ds_read_b64_tr_b16 v[18:19], v62 offset:768
L_gated_mix__mha_block__glu_gated_bilinear__prompt_kernel_wo_loopa:
    s_waitcnt vmcnt(0)
    s_barrier
    s_waitcnt lgkmcnt(2)
    v_mfma_f32_16x16x32_bf16 v[72:75], v[8:11], v[40:43], v[72:75]
    s_add_u32 m0, s94, 32768
    s_nop 0
    buffer_load_dwordx4 v32, s[64:67], s84 offen lds
    s_add_u32 s84, s84, s89
    s_add_u32 m0, s95, 32768
    s_nop 0
    buffer_load_dwordx4 v33, s[68:71], s85 offen lds
    s_add_u32 s85, s85, s90
    ds_read_b64_tr_b16 v[8:9], v60 offset:8192
    ds_read_b64_tr_b16 v[10:11], v60 offset:8960
    v_mfma_f32_16x16x32_bf16 v[76:79], v[12:15], v[40:43], v[76:79]
    s_add_u32 m0, s94, 40960
    s_nop 0
    buffer_load_dwordx4 v32, s[64:67], s84 offen lds
    s_add_u32 s84, s84, s89
    s_add_u32 m0, s95, 40960
    s_nop 0
    buffer_load_dwordx4 v33, s[68:71], s85 offen lds
    s_add_u32 s85, s85, s90
    ds_read_b64_tr_b16 v[12:13], v61 offset:8192
    ds_read_b64_tr_b16 v[14:15], v61 offset:8960
    s_waitcnt lgkmcnt(4)
    v_mfma_f32_16x16x32_bf16 v[80:83], v[16:19], v[40:43], v[80:83]
    ds_read_b128 v[40:43], v7 offset:8192
    ds_read_b64_tr_b16 v[16:17], v62 offset:8192
    ds_read_b64_tr_b16 v[18:19], v62 offset:8960
    s_waitcnt lgkmcnt(2)
    v_mfma_f32_16x16x32_bf16 v[72:75], v[8:11], v[40:43], v[72:75]
    ds_read_b64_tr_b16 v[8:9], v56 offset:0
    ds_read_b64_tr_b16 v[10:11], v56 offset:768
    v_mfma_f32_16x16x32_bf16 v[76:79], v[12:15], v[40:43], v[76:79]
    ds_read_b64_tr_b16 v[12:13], v57 offset:0
    ds_read_b64_tr_b16 v[14:15], v57 offset:768
    s_waitcnt lgkmcnt(4)
    v_mfma_f32_16x16x32_bf16 v[80:83], v[16:19], v[40:43], v[80:83]
    ds_read_b128 v[40:43], v63 offset:0
    ds_read_b64_tr_b16 v[16:17], v58 offset:0
    ds_read_b64_tr_b16 v[18:19], v58 offset:768
    s_waitcnt vmcnt(0)
    s_barrier
    s_waitcnt lgkmcnt(2)
    v_mfma_f32_16x16x32_bf16 v[72:75], v[8:11], v[40:43], v[72:75]
    s_add_u32 m0, s94, 0
    s_nop 0
    buffer_load_dwordx4 v32, s[64:67], s84 offen lds
    s_add_u32 s84, s84, s89
    s_add_u32 m0, s95, 0
    s_nop 0
    buffer_load_dwordx4 v33, s[68:71], s85 offen lds
    s_add_u32 s85, s85, s90
    ds_read_b64_tr_b16 v[8:9], v56 offset:8192
    ds_read_b64_tr_b16 v[10:11], v56 offset:8960
    v_mfma_f32_16x16x32_bf16 v[76:79], v[12:15], v[40:43], v[76:79]
    s_add_u32 m0, s94, 8192
    s_nop 0
    buffer_load_dwordx4 v32, s[64:67], s84 offen lds
    s_add_u32 s84, s84, s89
    s_add_u32 m0, s95, 8192
    s_nop 0
    buffer_load_dwordx4 v33, s[68:71], s85 offen lds
    s_add_u32 s85, s85, s90
    ds_read_b64_tr_b16 v[12:13], v57 offset:8192
    ds_read_b64_tr_b16 v[14:15], v57 offset:8960
    s_waitcnt lgkmcnt(4)
    v_mfma_f32_16x16x32_bf16 v[80:83], v[16:19], v[40:43], v[80:83]
    ds_read_b128 v[40:43], v63 offset:8192
    ds_read_b64_tr_b16 v[16:17], v58 offset:8192
    ds_read_b64_tr_b16 v[18:19], v58 offset:8960
    s_waitcnt lgkmcnt(2)
    v_mfma_f32_16x16x32_bf16 v[72:75], v[8:11], v[40:43], v[72:75]
    ds_read_b64_tr_b16 v[8:9], v64 offset:0
    ds_read_b64_tr_b16 v[10:11], v64 offset:768
    v_mfma_f32_16x16x32_bf16 v[76:79], v[12:15], v[40:43], v[76:79]
    ds_read_b64_tr_b16 v[12:13], v65 offset:0
    ds_read_b64_tr_b16 v[14:15], v65 offset:768
    s_waitcnt lgkmcnt(4)
    v_mfma_f32_16x16x32_bf16 v[80:83], v[16:19], v[40:43], v[80:83]
    ds_read_b128 v[40:43], v67 offset:0
    ds_read_b64_tr_b16 v[16:17], v66 offset:0
    ds_read_b64_tr_b16 v[18:19], v66 offset:768
    s_waitcnt vmcnt(0)
    s_barrier
    s_waitcnt lgkmcnt(2)
    v_mfma_f32_16x16x32_bf16 v[72:75], v[8:11], v[40:43], v[72:75]
    s_add_u32 m0, s94, 16384
    s_nop 0
    buffer_load_dwordx4 v32, s[64:67], s84 offen lds
    s_add_u32 s84, s84, s89
    s_add_u32 m0, s95, 16384
    s_nop 0
    buffer_load_dwordx4 v33, s[68:71], s85 offen lds
    s_add_u32 s85, s85, s90
    ds_read_b64_tr_b16 v[8:9], v64 offset:8192
    ds_read_b64_tr_b16 v[10:11], v64 offset:8960
    v_mfma_f32_16x16x32_bf16 v[76:79], v[12:15], v[40:43], v[76:79]
    s_add_u32 m0, s94, 24576
    s_nop 0
    buffer_load_dwordx4 v32, s[64:67], s84 offen lds
    s_add_u32 s84, s84, s89
    s_add_u32 m0, s95, 24576
    s_nop 0
    buffer_load_dwordx4 v33, s[68:71], s85 offen lds
    s_add_u32 s85, s85, s90
    ds_read_b64_tr_b16 v[12:13], v65 offset:8192
    ds_read_b64_tr_b16 v[14:15], v65 offset:8960
    s_waitcnt lgkmcnt(4)
    v_mfma_f32_16x16x32_bf16 v[80:83], v[16:19], v[40:43], v[80:83]
    ds_read_b128 v[40:43], v67 offset:8192
    ds_read_b64_tr_b16 v[16:17], v66 offset:8192
    ds_read_b64_tr_b16 v[18:19], v66 offset:8960
    s_waitcnt lgkmcnt(2)
    v_mfma_f32_16x16x32_bf16 v[72:75], v[8:11], v[40:43], v[72:75]
    ds_read_b64_tr_b16 v[8:9], v60 offset:0
    ds_read_b64_tr_b16 v[10:11], v60 offset:768
    v_mfma_f32_16x16x32_bf16 v[76:79], v[12:15], v[40:43], v[76:79]
    ds_read_b64_tr_b16 v[12:13], v61 offset:0
    ds_read_b64_tr_b16 v[14:15], v61 offset:768
    s_waitcnt lgkmcnt(4)
    v_mfma_f32_16x16x32_bf16 v[80:83], v[16:19], v[40:43], v[80:83]
    ds_read_b128 v[40:43], v7 offset:0
    ds_read_b64_tr_b16 v[16:17], v62 offset:0
    ds_read_b64_tr_b16 v[18:19], v62 offset:768
    s_sub_u32 s62, s62, 1
    s_cmp_lg_u32 s62, 0
    s_cbranch_scc1 L_gated_mix__mha_block__glu_gated_bilinear__prompt_kernel_wo_loopa
    s_waitcnt vmcnt(0)
    s_barrier
    s_waitcnt lgkmcnt(2)
    v_mfma_f32_16x16x32_bf16 v[72:75], v[8:11], v[40:43], v[72:75]
    s_add_u32 m0, s94, 32768
    s_nop 0
    buffer_load_dwordx4 v32, s[64:67], s84 offen lds
    s_add_u32 s84, s84, s89
    s_add_u32 m0, s95, 32768
    s_nop 0
    buffer_load_dwordx4 v33, s[68:71], s85 offen lds
    s_add_u32 s85, s85, s90
    ds_read_b64_tr_b16 v[8:9], v60 offset:8192
    ds_read_b64_tr_b16 v[10:11], v60 offset:8960
    v_mfma_f32_16x16x32_bf16 v[76:79], v[12:15], v[40:43], v[76:79]
    s_add_u32 m0, s94, 40960
    s_nop 0
    buffer_load_dwordx4 v32, s[64:67], s84 offen lds
    s_add_u32 s84, s84, s89
    s_add_u32 m0, s95, 40960
    s_nop 0
    buffer_load_dwordx4 v33, s[68:71], s85 offen lds
    s_add_u32 s85, s85, s90
    ds_read_b64_tr_b16 v[12:13], v61 offset:8192
    ds_read_b64_tr_b16 v[14:15], v61 offset:8960
    s_waitcnt lgkmcnt(4)
    v_mfma_f32_16x16x32_bf16 v[80:83], v[16:19], v[40:43], v[80:83]
    ds_read_b128 v[40:43], v7 offset:8192
    ds_read_b64_tr_b16 v[16:17], v62 offset:8192
    ds_read_b64_tr_b16 v[18:19], v62 offset:8960
    s_waitcnt lgkmcnt(2)
    v_mfma_f32_16x16x32_bf16 v[72:75], v[8:11], v[40:43], v[72:75]
    ds_read_b64_tr_b16 v[8:9], v56 offset:0
    ds_read_b64_tr_b16 v[10:11], v56 offset:768
    v_mfma_f32_16x16x32_bf16 v[76:79], v[12:15], v[40:43], v[76:79]
    ds_read_b64_tr_b16 v[12:13], v57 offset:0
    ds_read_b64_tr_b16 v[14:15], v57 offset:768
    s_waitcnt lgkmcnt(4)
    v_mfma_f32_16x16x32_bf16 v[80:83], v[16:19], v[40:43], v[80:83]
    ds_read_b128 v[40:43], v63 offset:0
    ds_read_b64_tr_b16 v[16:17], v58 offset:0
    ds_read_b64_tr_b16 v[18:19], v58 offset:768
    s_waitcnt vmcnt(0)
    s_barrier
    s_waitcnt lgkmcnt(2)
    v_mfma_f32_16x16x32_bf16 v[72:75], v[8:11], v[40:43], v[72:75]
    ds_read_b64_tr_b16 v[8:9], v56 offset:8192
    ds_read_b64_tr_b16 v[10:11], v56 offset:8960
    v_mfma_f32_16x16x32_bf16 v[76:79], v[12:15], v[40:43], v[76:79]
    ds_read_b64_tr_b16 v[12:13], v57 offset:8192
    ds_read_b64_tr_b16 v[14:15], v57 offset:8960
    s_waitcnt lgkmcnt(4)
    v_mfma_f32_16x16x32_bf16 v[80:83], v[16:19], v[40:43], v[80:83]
    ds_read_b128 v[40:43], v63 offset:8192
    ds_read_b64_tr_b16 v[16:17], v58 offset:8192
    ds_read_b64_tr_b16 v[18:19], v58 offset:8960
    s_waitcnt lgkmcnt(2)
    v_mfma_f32_16x16x32_bf16 v[72:75], v[8:11], v[40:43], v[72:75]
    ds_read_b64_tr_b16 v[8:9], v64 offset:0
    ds_read_b64_tr_b16 v[10:11], v64 offset:768
    v_mfma_f32_16x16x32_bf16 v[76:79], v[12:15], v[40:43], v[76:79]
    ds_read_b64_tr_b16 v[12:13], v65 offset:0
    ds_read_b64_tr_b16 v[14:15], v65 offset:768
    s_waitcnt lgkmcnt(4)
    v_mfma_f32_16x16x32_bf16 v[80:83], v[16:19], v[40:43], v[80:83]
    ds_read_b128 v[40:43], v67 offset:0
    ds_read_b64_tr_b16 v[16:17], v66 offset:0
    ds_read_b64_tr_b16 v[18:19], v66 offset:768
    s_waitcnt lgkmcnt(2)
    v_mfma_f32_16x16x32_bf16 v[72:75], v[8:11], v[40:43], v[72:75]
    ds_read_b64_tr_b16 v[8:9], v64 offset:8192
    ds_read_b64_tr_b16 v[10:11], v64 offset:8960
    v_mfma_f32_16x16x32_bf16 v[76:79], v[12:15], v[40:43], v[76:79]
    ds_read_b64_tr_b16 v[12:13], v65 offset:8192
    ds_read_b64_tr_b16 v[14:15], v65 offset:8960
    s_waitcnt lgkmcnt(4)
    v_mfma_f32_16x16x32_bf16 v[80:83], v[16:19], v[40:43], v[80:83]
    ds_read_b128 v[40:43], v67 offset:8192
    ds_read_b64_tr_b16 v[16:17], v66 offset:8192
    ds_read_b64_tr_b16 v[18:19], v66 offset:8960
    s_waitcnt lgkmcnt(2)
    v_mfma_f32_16x16x32_bf16 v[72:75], v[8:11], v[40:43], v[72:75]
    v_mfma_f32_16x16x32_bf16 v[76:79], v[12:15], v[40:43], v[76:79]
    s_waitcnt lgkmcnt(0)
    v_mfma_f32_16x16x32_bf16 v[80:83], v[16:19], v[40:43], v[80:83]
    s_nop 7
    s_nop 1
    v_lshrrev_b32 v3, 4, v0
    v_mul_u32_u24 v4, 1152, v1
    v_lshl_add_u32 v4, v3, 3, v4
    s_mul_i32 s59, s50, 96
    s_add_u32 s59, s59, s40
    s_waitcnt lgkmcnt(0)
    s_mov_b32 s20, s30
    s_and_b32 s21, s31, 0xffff
    s_mov_b32 s22, 2359296
    s_mov_b32 s23, 0x20000
    s_mov_b32 s57, 0xffff0000
    v_add_f32 v104, v104, v108
    v_add_f32 v104, v104, v112
    v_cvt_pk_bf16_f32 v8, v104, v72
    v_lshlrev_b32 v9, 16, v8
    v_and_b32 v8, s57, v8
    v_mul_f32 v8, v8, v100
    v_mul_f32 v9, v9, v101
    v_cvt_pk_bf16_f32 v8, v8, v9
    v_lshlrev_b32 v9, 16, v8
    v_and_b32 v8, s57, v8
    v_add_f32 v104, v8, v9
    v_add_f32 v105, v105, v109
    v_add_f32 v105, v105, v113
    v_cvt_pk_bf16_f32 v8, v105, v73
    v_lshlrev_b32 v9, 16, v8
    v_and_b32 v8, s57, v8
    v_mul_f32 v8, v8, v100
    v_mul_f32 v9, v9, v101
    v_cvt_pk_bf16_f32 v8, v8, v9
    v_lshlrev_b32 v9, 16, v8
    v_and_b32 v8, s57, v8
    v_add_f32 v105, v8, v9
    v_add_f32 v106, v106, v110
    v_add_f32 v106, v106, v114
    v_cvt_pk_bf16_f32 v8, v106, v74
    v_lshlrev_b32 v9, 16, v8
    v_and_b32 v8, s57, v8
    v_mul_f32 v8, v8, v100
    v_mul_f32 v9, v9, v101
    v_cvt_pk_bf16_f32 v8, v8, v9
    v_lshlrev_b32 v9, 16, v8
    v_and_b32 v8, s57, v8
    v_add_f32 v106, v8, v9
    v_add_f32 v107, v107, v111
    v_add_f32 v107, v107, v115
    v_cvt_pk_bf16_f32 v8, v107, v75
    v_lshlrev_b32 v9, 16, v8
    v_and_b32 v8, s57, v8
    v_mul_f32 v8, v8, v100
    v_mul_f32 v9, v9, v101
    v_cvt_pk_bf16_f32 v8, v8, v9
    v_lshlrev_b32 v9, 16, v8
    v_and_b32 v8, s57, v8
    v_add_f32 v107, v8, v9
    v_cvt_pk_bf16_f32 v108, v104, v105
    v_cvt_pk_bf16_f32 v109, v106, v107
    s_add_u32 s58, s59, 0
    buffer_store_dwordx2 v[108:109], v4, s[20:23], s58 offen offset:0
    v_add_f32 v120, v120, v124
    v_add_f32 v120, v120, v128
    v_cvt_pk_bf16_f32 v8, v120, v76
    v_lshlrev_b32 v9, 16, v8
    v_and_b32 v8, s57, v8
    v_mul_f32 v8, v8, v100
    v_mul_f32 v9, v9, v101
    v_cvt_pk_bf16_f32 v8, v8, v9
    v_lshlrev_b32 v9, 16, v8
    v_and_b32 v8, s57, v8
    v_add_f32 v120, v8, v9
    v_add_f32 v121, v121, v125
    v_add_f32 v121, v121, v129
    v_cvt_pk_bf16_f32 v8, v121, v77
    v_lshlrev_b32 v9, 16, v8
    v_and_b32 v8, s57, v8
    v_mul_f32 v8, v8, v100
    v_mul_f32 v9, v9, v101
    v_cvt_pk_bf16_f32 v8, v8, v9
    v_lshlrev_b32 v9, 16, v8
    v_and_b32 v8, s57, v8
    v_add_f32 v121, v8, v9
    v_add_f32 v122, v122, v126
    v_add_f32 v122, v122, v130
    v_cvt_pk_bf16_f32 v8, v122, v78
    v_lshlrev_b32 v9, 16, v8
    v_and_b32 v8, s57, v8
    v_mul_f32 v8, v8, v100
    v_mul_f32 v9, v9, v101
    v_cvt_pk_bf16_f32 v8, v8, v9
    v_lshlrev_b32 v9, 16, v8
    v_and_b32 v8, s57, v8
    v_add_f32 v122, v8, v9
    v_add_f32 v123, v123, v127
    v_add_f32 v123, v123, v131
    v_cvt_pk_bf16_f32 v8, v123, v79
    v_lshlrev_b32 v9, 16, v8
    v_and_b32 v8, s57, v8
    v_mul_f32 v8, v8, v100
    v_mul_f32 v9, v9, v101
    v_cvt_pk_bf16_f32 v8, v8, v9
    v_lshlrev_b32 v9, 16, v8
    v_and_b32 v8, s57, v8
    v_add_f32 v123, v8, v9
    v_cvt_pk_bf16_f32 v124, v120, v121
    v_cvt_pk_bf16_f32 v125, v122, v123
    s_add_u32 s58, s59, 0
    buffer_store_dwordx2 v[124:125], v4, s[20:23], s58 offen offset:32
    v_add_f32 v136, v136, v140
    v_add_f32 v136, v136, v144
    v_cvt_pk_bf16_f32 v8, v136, v80
    v_lshlrev_b32 v9, 16, v8
    v_and_b32 v8, s57, v8
    v_mul_f32 v8, v8, v100
    v_mul_f32 v9, v9, v101
    v_cvt_pk_bf16_f32 v8, v8, v9
    v_lshlrev_b32 v9, 16, v8
    v_and_b32 v8, s57, v8
    v_add_f32 v136, v8, v9
    v_add_f32 v137, v137, v141
    v_add_f32 v137, v137, v145
    v_cvt_pk_bf16_f32 v8, v137, v81
    v_lshlrev_b32 v9, 16, v8
    v_and_b32 v8, s57, v8
    v_mul_f32 v8, v8, v100
    v_mul_f32 v9, v9, v101
    v_cvt_pk_bf16_f32 v8, v8, v9
    v_lshlrev_b32 v9, 16, v8
    v_and_b32 v8, s57, v8
    v_add_f32 v137, v8, v9
    v_add_f32 v138, v138, v142
    v_add_f32 v138, v138, v146
    v_cvt_pk_bf16_f32 v8, v138, v82
    v_lshlrev_b32 v9, 16, v8
    v_and_b32 v8, s57, v8
    v_mul_f32 v8, v8, v100
    v_mul_f32 v9, v9, v101
    v_cvt_pk_bf16_f32 v8, v8, v9
    v_lshlrev_b32 v9, 16, v8
    v_and_b32 v8, s57, v8
    v_add_f32 v138, v8, v9
    v_add_f32 v139, v139, v143
    v_add_f32 v139, v139, v147
    v_cvt_pk_bf16_f32 v8, v139, v83
    v_lshlrev_b32 v9, 16, v8
    v_and_b32 v8, s57, v8
    v_mul_f32 v8, v8, v100
    v_mul_f32 v9, v9, v101
    v_cvt_pk_bf16_f32 v8, v8, v9
    v_lshlrev_b32 v9, 16, v8
    v_and_b32 v8, s57, v8
    v_add_f32 v139, v8, v9
    v_cvt_pk_bf16_f32 v140, v136, v137
    v_cvt_pk_bf16_f32 v141, v138, v139
    s_add_u32 s58, s59, 0
    buffer_store_dwordx2 v[140:141], v4, s[20:23], s58 offen offset:64
L_gated_mix__mha_block__glu_gated_bilinear__prompt_kernel_end:
    s_endpgm
.section .rodata,"a"
.p2align 6
.amdhsa_kernel gated_mix__mha_block__glu_gated_bilinear__prompt_kernel
  .amdhsa_next_free_vgpr 208
  .amdhsa_next_free_sgpr 102
  .amdhsa_accum_offset 208
  .amdhsa_group_segment_fixed_size 0
  .amdhsa_kernarg_size 88
  .amdhsa_user_sgpr_count 2
  .amdhsa_user_sgpr_kernarg_segment_ptr 1
  .amdhsa_system_sgpr_workgroup_id_x 1
.end_amdhsa_kernel
```
